```python
import torch

def _softmax(x, axis=-1):
    return torch.softmax(x, dim=axis)
def _gelu(x):
    return torch.nn.functional.gelu(x, approximate="tanh")
def _silu(x):
    return torch.nn.functional.silu(x)
def _sigmoid(x):
    return torch.sigmoid(x)
def _layernorm(x, axis=-1, eps=1e-5):
    m = x.mean(dim=axis, keepdim=True)
    v = x.var(dim=axis, keepdim=True, unbiased=False)
    return (x - m) / torch.sqrt(v + eps)
def _scatter_add(tgt, idx, src, axis=0):
    return tgt.clone().index_add_(axis, idx, src)
def _segment_sum(src, seg, n):
    out = torch.zeros((n,) + src.shape[1:], dtype=src.dtype)
    return out.index_add_(0, seg, src)
def _pad(x, pw):
    flat = tuple(v for pair in reversed(pw) for v in pair)
    return torch.nn.functional.pad(x, flat)

kernel_name = 'interleave_layers__ssm_conv_h3__dense_activation_relu__prompt'

def setup_inputs():

    _w = (lambda a: (lambda t: t.to(torch.bfloat16) if t.is_floating_point() else t)(torch.as_tensor(a)))
    def _A_setup():
        B, S, D = 1, 2048, 640
        ks = 4
        return {
            "q": _w((lambda *s: torch.randn(*s, dtype=torch.bfloat16) * 0.05)(B, S, D)),
            "k": _w((lambda *s: torch.randn(*s, dtype=torch.bfloat16) * 0.8)(B, S, D)),
            "v": _w((lambda *s: torch.randn(*s, dtype=torch.bfloat16) * 0.8)(B, S, D)),
            "shift_k": _w((lambda *s: torch.randn(*s, dtype=torch.bfloat16) * 0.8)(D, ks) * 0.5),
            "ssm_k": _w((lambda *s: torch.randn(*s, dtype=torch.bfloat16) * 0.8)(D, S) * (1.0 / S ** 0.5)),
            "ssm_D": _w((lambda *s: torch.randn(*s, dtype=torch.bfloat16) * 0.8)(D)),
        }
    _A_in = _A_setup()

    def _B_setup():
        B, S, D, Dff = 1, 2048, 640, 1728
        return {
            "x": _w((lambda *s: torch.randn(*s, dtype=torch.bfloat16) * 0.05)(B, S, D)),
            "w1": _w((lambda *s: torch.randn(*s, dtype=torch.bfloat16) * 0.1)(D, Dff)),
            "w2": _w((lambda *s: torch.randn(*s, dtype=torch.bfloat16) * 0.1)(Dff, D)),
        }
    _B_in = _B_setup()

    return {
        "A_q": _A_in["q"],
        "A_k": _A_in["k"],
        "A_v": _A_in["v"],
        "A_shift_k": _A_in["shift_k"],
        "A_ssm_k": _A_in["ssm_k"],
        "A_ssm_D": _A_in["ssm_D"],
        "B_x": _B_in["x"],
        "B_w1": _B_in["w1"],
        "B_w2": _B_in["w2"],
    }

def reference(A_q, A_k, A_v, A_shift_k, A_ssm_k, A_ssm_D, B_x, B_w1, B_w2):
    def _A_ref(q, k, v, shift_k, ssm_k, ssm_D):
        B, S, D = q.shape
        ks = shift_k.shape[-1]
        k_pad = _pad(k, ((0, 0), (ks - 1, 0), (0, 0)))
        k_shift = torch.zeros_like(k)
        for t in range(ks):
            k_shift = k_shift + k_pad[:, t:t + S, :] * shift_k[:, ks - 1 - t][None, None, :]
        kv = k_shift * v
        L = 2 * S
        kv_pad = _pad(kv, ((0, 0), (0, S), (0, 0)))
        kf_pad = _pad(ssm_k, ((0, 0), (0, S)))
        kv_f = (lambda x, axes=(-2,-1): torch.fft.rfft2(x.float(), dim=axes))(kv_pad[:, None, :, :], axes=(1, 2))
        kf_f = (lambda x, axes=(-2,-1): torch.fft.rfft2(x.float(), dim=axes))(kf_pad[:, None, :], axes=(1, 2))
        kf_f = (lambda x, *d: x.permute(*d))(kf_f, 1, 2, 0)
        y_f = kv_f * kf_f[None, :, :, :]
        y = (lambda x, s, axes=(-2,-1): torch.fft.irfft2(x, s=s, dim=axes).to(torch.bfloat16))(y_f, (1, L), axes=(1, 2))[:, 0, :S, :]
        y = y + kv * ssm_D[None, None, :]
        return q * y

    def _B_ref(x, w1, w2):
        h = torch.einsum("bsd,df->bsf", x, w1)
        zero = torch.zeros_like(h)
        h = torch.maximum(h, zero)
        return torch.einsum("bsf,fd->bsd", h, w2)

    x = A_q
    x = x + _A_ref(_layernorm(x, axis=-1), A_k, A_v, A_shift_k, A_ssm_k, A_ssm_D)
    x = x + _B_ref(_layernorm(x, axis=-1), B_w1, B_w2)
    x = x + _A_ref(_layernorm(x, axis=-1), A_k, A_v, A_shift_k, A_ssm_k, A_ssm_D)
    x = x + _B_ref(_layernorm(x, axis=-1), B_w1, B_w2)
    return x
```

```asm
; @launch grid=(256,1,1) block=(256,1,1) lds=163840
.amdgcn_target "amdgcn-amd-amdhsa--gfx950"
.text
.globl interleave_layers__ssm_conv_h3__dense_activation_relu__prompt_kernel
.p2align 8
.type interleave_layers__ssm_conv_h3__dense_activation_relu__prompt_kernel,@function
interleave_layers__ssm_conv_h3__dense_activation_relu__prompt_kernel:

    s_cmp_ge_u32 s2, 256
    s_cbranch_scc1 L_exit
    s_load_dwordx16 s[36:51], s[0:1], 0
    s_load_dwordx8 s[52:59], s[0:1], 64
    v_lshrrev_b32 v3, 6, v0
    v_and_b32 v1, 63, v0
    v_readfirstlane_b32 s60, v3
    v_lshlrev_b32 v2, 4, v1
    s_mov_b32 s61, s2
    s_mov_b32 s97, 1048576
    s_and_b32 s62, s61, 7
    s_lshr_b32 s63, s61, 3
    s_lshr_b32 s64, s63, 4
    s_lshl_b32 s65, s62, 1
    s_add_u32 s76, s65, s64
    s_and_b32 s77, s63, 15
    s_lshr_b32 s64, s63, 3
    s_lshl_b32 s65, s62, 2
    s_add_u32 s78, s65, s64
    s_and_b32 s79, s63, 7
    s_lshl_b32 s64, s76, 2
    s_add_u32 s83, s64, s60
    s_and_b32 s85, s60, 1
    s_lshr_b32 s64, s60, 1
    s_lshl_b32 s65, s78, 1
    s_add_u32 s84, s65, s64
    s_mul_i32 s63, s79, 5
    s_mul_i32 s62, s85, 3
    s_add_u32 s62, s62, s63
    s_lshl_b32 s62, s62, 10
    s_mul_i32 s63, s84, 40960
    s_add_u32 s92, s62, s63
    s_cmp_ge_u32 s61, 160
    s_cbranch_scc1 L_roleB
    s_lshr_b32 s62, s61, 4
    s_and_b32 s63, s61, 15
    s_mul_i32 s64, s63, 163840
    s_lshl_b32 s65, s62, 7
    s_add_u32 s64, s64, s65
    v_and_b32 v6, 7, v0
    v_lshrrev_b32 v7, 3, v0
    v_mul_u32_u24 v8, 5120, v7
    v_lshl_add_u32 v8, v6, 4, v8
    v_add_u32 v8, s64, v8
    v_subrev_u32 v9, 3840, v8
    v_subrev_u32 v10, 2560, v8
    v_subrev_u32 v11, 1280, v8
    s_lshl_b32 s65, s62, 9
    v_lshlrev_b32 v12, 6, v6
    v_add_u32 v12, s65, v12
    s_waitcnt lgkmcnt(0)
    s_mov_b32 s20, s42
    s_mov_b32 s21, s43
    s_mov_b32 s22, 5120
    s_mov_b32 s23, 0x20000
    s_mov_b32 s12, s38
    s_mov_b32 s13, s39
    s_mov_b32 s14, 2621440
    s_mov_b32 s15, 0x20000
    s_mov_b32 s16, s40
    s_mov_b32 s17, s41
    s_mov_b32 s18, 2621440
    s_mov_b32 s19, 0x20000
    buffer_load_dwordx4 v[60:63], v12, s[20:23], 0 offen offset:0
    buffer_load_dwordx4 v[64:67], v12, s[20:23], 0 offen offset:16
    buffer_load_dwordx4 v[68:71], v12, s[20:23], 0 offen offset:32
    buffer_load_dwordx4 v[72:75], v12, s[20:23], 0 offen offset:48
    buffer_load_dwordx4 v[16:19], v9, s[12:15], 0 offen
    buffer_load_dwordx4 v[20:23], v10, s[12:15], 0 offen
    buffer_load_dwordx4 v[24:27], v11, s[12:15], 0 offen
    buffer_load_dwordx4 v[28:31], v8, s[12:15], 0 offen offset:0
    buffer_load_dwordx4 v[32:35], v8, s[12:15], 0 offen offset:1280
    buffer_load_dwordx4 v[36:39], v8, s[12:15], 0 offen offset:2560
    buffer_load_dwordx4 v[40:43], v8, s[12:15], 0 offen offset:3840
    buffer_load_dwordx4 v[44:47], v8, s[16:19], 0 offen offset:0
    buffer_load_dwordx4 v[48:51], v8, s[16:19], 0 offen offset:1280
    buffer_load_dwordx4 v[52:55], v8, s[16:19], 0 offen offset:2560
    buffer_load_dwordx4 v[56:59], v8, s[16:19], 0 offen offset:3840
    s_mov_b32 s8, s58
    s_mov_b32 s9, s59
    s_mov_b32 s10, 268435456
    s_mov_b32 s11, 0x20000
    s_mov_b32 s28, s56
    s_mov_b32 s29, s57
    s_mov_b32 s30, 256
    s_mov_b32 s31, 0x20000
    s_mov_b32 s24, s44
    s_mov_b32 s25, s45
    s_mov_b32 s26, 2621440
    s_mov_b32 s27, 0x20000
    s_lshl_b32 s68, s61, 2
    s_add_u32 s68, s68, s60
    s_lshl_b32 s69, s68, 12
    buffer_load_dwordx4 v[200:203], v2, s[24:27], s69 offen offset:0
    buffer_load_dwordx4 v[204:207], v2, s[24:27], s69 offen offset:4
    buffer_load_dwordx4 v[208:211], v2, s[24:27], s69 offen offset:8
    buffer_load_dwordx4 v[212:215], v2, s[24:27], s69 offen offset:1024
    buffer_load_dwordx4 v[216:219], v2, s[24:27], s69 offen offset:1028
    buffer_load_dwordx4 v[220:223], v2, s[24:27], s69 offen offset:1032
    buffer_load_dwordx4 v[224:227], v2, s[24:27], s69 offen offset:2048
    buffer_load_dwordx4 v[228:231], v2, s[24:27], s69 offen offset:2052
    buffer_load_dwordx4 v[232:235], v2, s[24:27], s69 offen offset:2056
    buffer_load_dwordx4 v[236:239], v2, s[24:27], s69 offen offset:3072
    buffer_load_dwordx4 v[240:243], v2, s[24:27], s69 offen offset:3076
    buffer_load_dwordx4 v[244:247], v2, s[24:27], s69 offen offset:3080
    s_lshl_b32 s70, s68, 1
    s_and_b32 s70, s70, 0xfffffffc
    s_add_u32 s72, s46, s70
    s_addc_u32 s73, s47, 0
    s_load_dword s71, s[72:73], 0
    v_lshlrev_b32 v15, 2, v7
    v_sub_u32 v15, 127, v15
    v_mul_u32_u24 v15, 144, v15
    v_lshl_add_u32 v15, v6, 4, v15
    v_add_u32 v15, -432, v15
    v_lshrrev_b32 v3, 4, v1
    v_lshlrev_b32 v3, 5, v3
    v_and_b32 v4, 3, v1
    v_lshl_add_u32 v3, v4, 3, v3
    v_bfe_u32 v4, v1, 2, 2
    v_add_u32 v3, v3, v4
    v_mul_u32_u24 v3, 144, v3
    s_lshl_b32 s65, s60, 5
    s_add_u32 s65, s65, 0
    v_add_u32 v3, s65, v3
    s_lshl_b32 s65, s62, 4
    s_lshl_b32 s66, s60, 2
    s_add_u32 s65, s65, s66
    s_mul_i32 s65, s65, 16384
    s_sub_u32 s66, 15, s63
    s_lshl_b32 s66, s66, 10
    s_add_u32 s65, s65, s66
    s_add_u32 s75, s65, 32768
    s_waitcnt vmcnt(23)
    v_lshlrev_b32 v80, 16, v60
    v_and_b32 v88, 0xffff0000, v60
    v_lshlrev_b32 v96, 16, v61
    v_and_b32 v104, 0xffff0000, v61
    v_lshlrev_b32 v81, 16, v62
    v_and_b32 v89, 0xffff0000, v62
    v_lshlrev_b32 v97, 16, v63
    v_and_b32 v105, 0xffff0000, v63
    v_lshlrev_b32 v82, 16, v64
    v_and_b32 v90, 0xffff0000, v64
    v_lshlrev_b32 v98, 16, v65
    v_and_b32 v106, 0xffff0000, v65
    v_lshlrev_b32 v83, 16, v66
    v_and_b32 v91, 0xffff0000, v66
    v_lshlrev_b32 v99, 16, v67
    v_and_b32 v107, 0xffff0000, v67
    v_lshlrev_b32 v84, 16, v68
    v_and_b32 v92, 0xffff0000, v68
    v_lshlrev_b32 v100, 16, v69
    v_and_b32 v108, 0xffff0000, v69
    v_lshlrev_b32 v85, 16, v70
    v_and_b32 v93, 0xffff0000, v70
    v_lshlrev_b32 v101, 16, v71
    v_and_b32 v109, 0xffff0000, v71
    v_lshlrev_b32 v86, 16, v72
    v_and_b32 v94, 0xffff0000, v72
    v_lshlrev_b32 v102, 16, v73
    v_and_b32 v110, 0xffff0000, v73
    v_lshlrev_b32 v87, 16, v74
    v_and_b32 v95, 0xffff0000, v74
    v_lshlrev_b32 v103, 16, v75
    v_and_b32 v111, 0xffff0000, v75
    s_waitcnt vmcnt(22)
    v_lshlrev_b32 v112, 16, v16
    v_and_b32 v113, 0xffff0000, v16
    v_lshlrev_b32 v114, 16, v17
    v_and_b32 v115, 0xffff0000, v17
    v_lshlrev_b32 v116, 16, v18
    v_and_b32 v117, 0xffff0000, v18
    v_lshlrev_b32 v118, 16, v19
    v_and_b32 v119, 0xffff0000, v19
    s_waitcnt vmcnt(21)
    v_lshlrev_b32 v120, 16, v20
    v_and_b32 v121, 0xffff0000, v20
    v_lshlrev_b32 v122, 16, v21
    v_and_b32 v123, 0xffff0000, v21
    v_lshlrev_b32 v124, 16, v22
    v_and_b32 v125, 0xffff0000, v22
    v_lshlrev_b32 v126, 16, v23
    v_and_b32 v127, 0xffff0000, v23
    s_waitcnt vmcnt(20)
    v_lshlrev_b32 v128, 16, v24
    v_and_b32 v129, 0xffff0000, v24
    v_lshlrev_b32 v130, 16, v25
    v_and_b32 v131, 0xffff0000, v25
    v_lshlrev_b32 v132, 16, v26
    v_and_b32 v133, 0xffff0000, v26
    v_lshlrev_b32 v134, 16, v27
    v_and_b32 v135, 0xffff0000, v27
    s_waitcnt vmcnt(19)
    v_lshlrev_b32 v136, 16, v28
    v_and_b32 v137, 0xffff0000, v28
    v_lshlrev_b32 v138, 16, v29
    v_and_b32 v139, 0xffff0000, v29
    v_lshlrev_b32 v140, 16, v30
    v_and_b32 v141, 0xffff0000, v30
    v_lshlrev_b32 v142, 16, v31
    v_and_b32 v143, 0xffff0000, v31
    s_waitcnt vmcnt(18)
    v_lshlrev_b32 v144, 16, v32
    v_and_b32 v145, 0xffff0000, v32
    v_lshlrev_b32 v146, 16, v33
    v_and_b32 v147, 0xffff0000, v33
    v_lshlrev_b32 v148, 16, v34
    v_and_b32 v149, 0xffff0000, v34
    v_lshlrev_b32 v150, 16, v35
    v_and_b32 v151, 0xffff0000, v35
    s_waitcnt vmcnt(17)
    v_lshlrev_b32 v152, 16, v36
    v_and_b32 v153, 0xffff0000, v36
    v_lshlrev_b32 v154, 16, v37
    v_and_b32 v155, 0xffff0000, v37
    v_lshlrev_b32 v156, 16, v38
    v_and_b32 v157, 0xffff0000, v38
    v_lshlrev_b32 v158, 16, v39
    v_and_b32 v159, 0xffff0000, v39
    s_waitcnt vmcnt(16)
    v_lshlrev_b32 v160, 16, v40
    v_and_b32 v161, 0xffff0000, v40
    v_lshlrev_b32 v162, 16, v41
    v_and_b32 v163, 0xffff0000, v41
    v_lshlrev_b32 v164, 16, v42
    v_and_b32 v165, 0xffff0000, v42
    v_lshlrev_b32 v166, 16, v43
    v_and_b32 v167, 0xffff0000, v43
    s_waitcnt vmcnt(12)
    v_mov_b32 v249, 0
    buffer_load_dword v248, v249, s[28:31], 0 offen sc1
    v_lshlrev_b32 v168, 16, v44
    v_and_b32 v169, 0xffff0000, v44
    v_lshlrev_b32 v170, 16, v45
    v_and_b32 v171, 0xffff0000, v45
    v_lshlrev_b32 v172, 16, v46
    v_and_b32 v173, 0xffff0000, v46
    v_lshlrev_b32 v174, 16, v47
    v_and_b32 v175, 0xffff0000, v47
    v_lshlrev_b32 v176, 16, v48
    v_and_b32 v177, 0xffff0000, v48
    v_lshlrev_b32 v178, 16, v49
    v_and_b32 v179, 0xffff0000, v49
    v_lshlrev_b32 v180, 16, v50
    v_and_b32 v181, 0xffff0000, v50
    v_lshlrev_b32 v182, 16, v51
    v_and_b32 v183, 0xffff0000, v51
    v_lshlrev_b32 v184, 16, v52
    v_and_b32 v185, 0xffff0000, v52
    v_lshlrev_b32 v186, 16, v53
    v_and_b32 v187, 0xffff0000, v53
    v_lshlrev_b32 v188, 16, v54
    v_and_b32 v189, 0xffff0000, v54
    v_lshlrev_b32 v190, 16, v55
    v_and_b32 v191, 0xffff0000, v55
    v_lshlrev_b32 v192, 16, v56
    v_and_b32 v193, 0xffff0000, v56
    v_lshlrev_b32 v194, 16, v57
    v_and_b32 v195, 0xffff0000, v57
    v_lshlrev_b32 v196, 16, v58
    v_and_b32 v197, 0xffff0000, v58
    v_lshlrev_b32 v198, 16, v59
    v_and_b32 v199, 0xffff0000, v59
    v_pk_mul_f32 v[32:33], v[80:81], v[136:137]
    v_pk_mul_f32 v[34:35], v[82:83], v[138:139]
    v_pk_mul_f32 v[36:37], v[84:85], v[140:141]
    v_pk_mul_f32 v[38:39], v[86:87], v[142:143]
    v_pk_fma_f32 v[32:33], v[88:89], v[128:129], v[32:33]
    v_pk_fma_f32 v[34:35], v[90:91], v[130:131], v[34:35]
    v_pk_fma_f32 v[36:37], v[92:93], v[132:133], v[36:37]
    v_pk_fma_f32 v[38:39], v[94:95], v[134:135], v[38:39]
    v_pk_fma_f32 v[32:33], v[96:97], v[120:121], v[32:33]
    v_pk_fma_f32 v[34:35], v[98:99], v[122:123], v[34:35]
    v_pk_fma_f32 v[36:37], v[100:101], v[124:125], v[36:37]
    v_pk_fma_f32 v[38:39], v[102:103], v[126:127], v[38:39]
    v_pk_fma_f32 v[32:33], v[104:105], v[112:113], v[32:33]
    v_pk_fma_f32 v[34:35], v[106:107], v[114:115], v[34:35]
    v_pk_fma_f32 v[36:37], v[108:109], v[116:117], v[36:37]
    v_pk_fma_f32 v[38:39], v[110:111], v[118:119], v[38:39]
    v_pk_mul_f32 v[32:33], v[32:33], v[168:169]
    v_pk_mul_f32 v[34:35], v[34:35], v[170:171]
    v_pk_mul_f32 v[36:37], v[36:37], v[172:173]
    v_pk_mul_f32 v[38:39], v[38:39], v[174:175]
    v_cvt_pk_bf16_f32 v16, v32, v33
    v_cvt_pk_bf16_f32 v17, v34, v35
    v_cvt_pk_bf16_f32 v18, v36, v37
    v_cvt_pk_bf16_f32 v19, v38, v39
    ds_write_b128 v15, v[16:19] offset:432
    v_pk_mul_f32 v[32:33], v[80:81], v[144:145]
    v_pk_mul_f32 v[34:35], v[82:83], v[146:147]
    v_pk_mul_f32 v[36:37], v[84:85], v[148:149]
    v_pk_mul_f32 v[38:39], v[86:87], v[150:151]
    v_pk_fma_f32 v[32:33], v[88:89], v[136:137], v[32:33]
    v_pk_fma_f32 v[34:35], v[90:91], v[138:139], v[34:35]
    v_pk_fma_f32 v[36:37], v[92:93], v[140:141], v[36:37]
    v_pk_fma_f32 v[38:39], v[94:95], v[142:143], v[38:39]
    v_pk_fma_f32 v[32:33], v[96:97], v[128:129], v[32:33]
    v_pk_fma_f32 v[34:35], v[98:99], v[130:131], v[34:35]
    v_pk_fma_f32 v[36:37], v[100:101], v[132:133], v[36:37]
    v_pk_fma_f32 v[38:39], v[102:103], v[134:135], v[38:39]
    v_pk_fma_f32 v[32:33], v[104:105], v[120:121], v[32:33]
    v_pk_fma_f32 v[34:35], v[106:107], v[122:123], v[34:35]
    v_pk_fma_f32 v[36:37], v[108:109], v[124:125], v[36:37]
    v_pk_fma_f32 v[38:39], v[110:111], v[126:127], v[38:39]
    v_pk_mul_f32 v[32:33], v[32:33], v[176:177]
    v_pk_mul_f32 v[34:35], v[34:35], v[178:179]
    v_pk_mul_f32 v[36:37], v[36:37], v[180:181]
    v_pk_mul_f32 v[38:39], v[38:39], v[182:183]
    v_cvt_pk_bf16_f32 v20, v32, v33
    v_cvt_pk_bf16_f32 v21, v34, v35
    v_cvt_pk_bf16_f32 v22, v36, v37
    v_cvt_pk_bf16_f32 v23, v38, v39
    ds_write_b128 v15, v[20:23] offset:288
    v_pk_mul_f32 v[32:33], v[80:81], v[152:153]
    v_pk_mul_f32 v[34:35], v[82:83], v[154:155]
    v_pk_mul_f32 v[36:37], v[84:85], v[156:157]
    v_pk_mul_f32 v[38:39], v[86:87], v[158:159]
    v_pk_fma_f32 v[32:33], v[88:89], v[144:145], v[32:33]
    v_pk_fma_f32 v[34:35], v[90:91], v[146:147], v[34:35]
    v_pk_fma_f32 v[36:37], v[92:93], v[148:149], v[36:37]
    v_pk_fma_f32 v[38:39], v[94:95], v[150:151], v[38:39]
    v_pk_fma_f32 v[32:33], v[96:97], v[136:137], v[32:33]
    v_pk_fma_f32 v[34:35], v[98:99], v[138:139], v[34:35]
    v_pk_fma_f32 v[36:37], v[100:101], v[140:141], v[36:37]
    v_pk_fma_f32 v[38:39], v[102:103], v[142:143], v[38:39]
    v_pk_fma_f32 v[32:33], v[104:105], v[128:129], v[32:33]
    v_pk_fma_f32 v[34:35], v[106:107], v[130:131], v[34:35]
    v_pk_fma_f32 v[36:37], v[108:109], v[132:133], v[36:37]
    v_pk_fma_f32 v[38:39], v[110:111], v[134:135], v[38:39]
    v_pk_mul_f32 v[32:33], v[32:33], v[184:185]
    v_pk_mul_f32 v[34:35], v[34:35], v[186:187]
    v_pk_mul_f32 v[36:37], v[36:37], v[188:189]
    v_pk_mul_f32 v[38:39], v[38:39], v[190:191]
    v_cvt_pk_bf16_f32 v24, v32, v33
    v_cvt_pk_bf16_f32 v25, v34, v35
    v_cvt_pk_bf16_f32 v26, v36, v37
    v_cvt_pk_bf16_f32 v27, v38, v39
    ds_write_b128 v15, v[24:27] offset:144
    v_pk_mul_f32 v[32:33], v[80:81], v[160:161]
    v_pk_mul_f32 v[34:35], v[82:83], v[162:163]
    v_pk_mul_f32 v[36:37], v[84:85], v[164:165]
    v_pk_mul_f32 v[38:39], v[86:87], v[166:167]
    v_pk_fma_f32 v[32:33], v[88:89], v[152:153], v[32:33]
    v_pk_fma_f32 v[34:35], v[90:91], v[154:155], v[34:35]
    v_pk_fma_f32 v[36:37], v[92:93], v[156:157], v[36:37]
    v_pk_fma_f32 v[38:39], v[94:95], v[158:159], v[38:39]
    v_pk_fma_f32 v[32:33], v[96:97], v[144:145], v[32:33]
    v_pk_fma_f32 v[34:35], v[98:99], v[146:147], v[34:35]
    v_pk_fma_f32 v[36:37], v[100:101], v[148:149], v[36:37]
    v_pk_fma_f32 v[38:39], v[102:103], v[150:151], v[38:39]
    v_pk_fma_f32 v[32:33], v[104:105], v[136:137], v[32:33]
    v_pk_fma_f32 v[34:35], v[106:107], v[138:139], v[34:35]
    v_pk_fma_f32 v[36:37], v[108:109], v[140:141], v[36:37]
    v_pk_fma_f32 v[38:39], v[110:111], v[142:143], v[38:39]
    v_pk_mul_f32 v[32:33], v[32:33], v[192:193]
    v_pk_mul_f32 v[34:35], v[34:35], v[194:195]
    v_pk_mul_f32 v[36:37], v[36:37], v[196:197]
    v_pk_mul_f32 v[38:39], v[38:39], v[198:199]
    v_cvt_pk_bf16_f32 v28, v32, v33
    v_cvt_pk_bf16_f32 v29, v34, v35
    v_cvt_pk_bf16_f32 v30, v36, v37
    v_cvt_pk_bf16_f32 v31, v38, v39
    ds_write_b128 v15, v[28:31] offset:0
    s_waitcnt lgkmcnt(0)
    s_barrier
    ds_read_b64_tr_b16 v[16:17], v3 offset:0
    ds_read_b64_tr_b16 v[18:19], v3 offset:576
    ds_read_b64_tr_b16 v[20:21], v3 offset:8
    ds_read_b64_tr_b16 v[22:23], v3 offset:584
    ds_read_b64_tr_b16 v[24:25], v3 offset:16
    ds_read_b64_tr_b16 v[26:27], v3 offset:592
    ds_read_b64_tr_b16 v[28:29], v3 offset:24
    ds_read_b64_tr_b16 v[30:31], v3 offset:600
    s_waitcnt lgkmcnt(6)
    buffer_store_dwordx4 v[16:19], v2, s[8:11], s75 offen sc1
    s_add_u32 s75, s75, 16384
    s_waitcnt lgkmcnt(4)
    buffer_store_dwordx4 v[20:23], v2, s[8:11], s75 offen sc1
    s_add_u32 s75, s75, 16384
    s_waitcnt lgkmcnt(2)
    buffer_store_dwordx4 v[24:27], v2, s[8:11], s75 offen sc1
    s_add_u32 s75, s75, 16384
    s_waitcnt lgkmcnt(0)
    buffer_store_dwordx4 v[28:31], v2, s[8:11], s75 offen sc1
    s_add_u32 s75, s75, 16384
    s_lshr_b32 s64, s61, 4
    s_lshl_b32 s64, s64, 7
    s_add_u32 s64, s64, 0
    s_waitcnt vmcnt(0)
    s_barrier
    s_cmp_lg_u32 s60, 0
    s_cbranch_scc1 L_w0o_1
L_pe_2:
    v_cmp_gt_u32 vcc, 1, v248
    s_nop 1
    s_cbranch_vccz L_pok_3
    s_cmp_eq_u32 s97, 0
    s_cbranch_scc1 L_pok_3
    s_sub_u32 s97, s97, 1
    s_sleep 2
    buffer_load_dword v248, v249, s[28:31], 0 offen sc1
    s_waitcnt vmcnt(0)
    s_branch L_pe_2
L_pok_3:
L_w0o_1:
    s_cmp_lg_u32 s60, 0
    s_cbranch_scc1 L_arr_4
    s_mov_b64 s[98:99], exec
    s_mov_b64 exec, 1
    v_mov_b32 v4, s64
    v_mov_b32 v5, 1
    buffer_atomic_add v5, v4, s[8:11], 0 offen
    s_mov_b64 exec, s[98:99]
L_arr_4:
    s_mul_i32 s72, s60, 16640
    s_add_u32 s72, s72, 76800
    v_add_u32 v6, s72, v2
    v_alignbit_b32 v16, v204, v200, 16
    v_alignbit_b32 v17, v205, v201, 16
    v_alignbit_b32 v18, v206, v202, 16
    v_alignbit_b32 v19, v207, v203, 16
    v_alignbit_b32 v20, v208, v204, 16
    v_alignbit_b32 v21, v209, v205, 16
    v_alignbit_b32 v22, v210, v206, 16
    v_alignbit_b32 v23, v211, v207, 16
    ds_write_b128 v6, v[200:203] offset:32
    ds_write_b128 v6, v[16:19] offset:4192
    ds_write_b128 v6, v[204:207] offset:8352
    ds_write_b128 v6, v[20:23] offset:12512
    v_alignbit_b32 v24, v216, v212, 16
    v_alignbit_b32 v25, v217, v213, 16
    v_alignbit_b32 v26, v218, v214, 16
    v_alignbit_b32 v27, v219, v215, 16
    v_alignbit_b32 v28, v220, v216, 16
    v_alignbit_b32 v29, v221, v217, 16
    v_alignbit_b32 v30, v222, v218, 16
    v_alignbit_b32 v31, v223, v219, 16
    ds_write_b128 v6, v[212:215] offset:1056
    ds_write_b128 v6, v[24:27] offset:5216
    ds_write_b128 v6, v[216:219] offset:9376
    ds_write_b128 v6, v[28:31] offset:13536
    v_alignbit_b32 v16, v228, v224, 16
    v_alignbit_b32 v17, v229, v225, 16
    v_alignbit_b32 v18, v230, v226, 16
    v_alignbit_b32 v19, v231, v227, 16
    v_alignbit_b32 v20, v232, v228, 16
    v_alignbit_b32 v21, v233, v229, 16
    v_alignbit_b32 v22, v234, v230, 16
    v_alignbit_b32 v23, v235, v231, 16
    ds_write_b128 v6, v[224:227] offset:2080
    ds_write_b128 v6, v[16:19] offset:6240
    ds_write_b128 v6, v[228:231] offset:10400
    ds_write_b128 v6, v[20:23] offset:14560
    v_alignbit_b32 v24, v240, v236, 16
    v_alignbit_b32 v25, v241, v237, 16
    v_alignbit_b32 v26, v242, v238, 16
    v_alignbit_b32 v27, v243, v239, 16
    v_alignbit_b32 v28, v244, v240, 16
    v_alignbit_b32 v29, v245, v241, 16
    v_alignbit_b32 v30, v246, v242, 16
    v_alignbit_b32 v31, v247, v243, 16
    ds_write_b128 v6, v[236:239] offset:3104
    ds_write_b128 v6, v[24:27] offset:7264
    ds_write_b128 v6, v[240:243] offset:11424
    ds_write_b128 v6, v[28:31] offset:15584
    v_mov_b32 v32, 0
    v_mov_b32 v33, 0
    v_mov_b32 v34, 0
    v_mov_b32 v35, 0
    v_mov_b32 v36, 0
    v_mov_b32 v37, 0
    v_mov_b32 v38, 0
    v_lshlrev_b32 v39, 16, v200
    v_mov_b32 v40, 0
    v_mov_b32 v41, 0
    v_mov_b32 v42, 0
    v_mov_b32 v43, v200
    v_mov_b32 v44, 0
    v_mov_b32 v45, 0
    v_lshlrev_b32 v46, 16, v200
    v_alignbit_b32 v47, v201, v200, 16
    s_mov_b64 s[98:99], exec
    s_mov_b64 exec, 1
    ds_write_b128 v6, v[32:35] offset:0
    ds_write_b128 v6, v[32:35] offset:16
    ds_write_b128 v6, v[32:35] offset:4160
    ds_write_b128 v6, v[36:39] offset:4176
    ds_write_b128 v6, v[32:35] offset:8320
    ds_write_b128 v6, v[40:43] offset:8336
    ds_write_b128 v6, v[32:35] offset:12480
    ds_write_b128 v6, v[44:47] offset:12496
    s_mov_b64 exec, 0x3fffffff
    s_mul_i32 s72, s60, 4576
    s_add_u32 s72, s72, 147456
    v_add_u32 v7, s72, v2
    ds_write_b128 v7, v[32:35]
    s_mov_b64 exec, s[98:99]
    v_and_b32 v6, 15, v1
    v_lshrrev_b32 v7, 4, v1
    v_lshl_add_u32 v10, v7, 3, v6
    v_add_u32 v10, 1, v10
    v_and_b32 v11, 3, v10
    v_mul_u32_u24 v11, 4160, v11
    v_lshrrev_b32 v10, 2, v10
    v_lshl_add_u32 v11, v10, 3, v11
    s_mul_i32 s72, s60, 16640
    s_add_u32 s72, s72, 76800
    v_add_u32 v8, s72, v11
    v_lshlrev_b32 v10, 5, v6
    v_lshlrev_b32 v11, 4, v7
    v_sub_u32 v11, v11, v10
    s_mul_i32 s72, s60, 4576
    s_add_u32 s72, s72, 143840
    v_add_u32 v9, s72, v11
    v_lshlrev_b32 v10, 5, v6
    v_lshl_add_u32 v10, v7, 3, v10
    s_mul_i32 s72, s60, 4576
    s_add_u32 s72, s72, 143864
    v_sub_u32 v222, s72, v10
    v_lshlrev_b32 v11, 4, v6
    v_lshl_add_u32 v11, v7, 2, v11
    s_mul_i32 s72, s60, 16704
    s_add_u32 s72, s72, 76800
    v_add_u32 v223, s72, v11
    s_waitcnt lgkmcnt(0)
    s_and_b32 s72, s68, 1
    s_lshl_b32 s72, s72, 4
    s_lshr_b32 s71, s71, s72
    s_lshl_b32 s71, s71, 16
    ds_read_b64 v[48:49], v8 offset:0
    ds_read_b64 v[50:51], v8 offset:8
    ds_read_b64 v[52:53], v8 offset:512
    ds_read_b64 v[54:55], v8 offset:520
    ds_read_b64 v[56:57], v8 offset:1024
    ds_read_b64 v[58:59], v8 offset:1032
    ds_read_b64 v[60:61], v8 offset:1536
    ds_read_b64 v[62:63], v8 offset:1544
    ds_read_b64 v[64:65], v8 offset:2048
    ds_read_b64 v[66:67], v8 offset:2056
    ds_read_b64 v[68:69], v8 offset:2560
    ds_read_b64 v[70:71], v8 offset:2568
    ds_read_b64 v[72:73], v8 offset:3072
    ds_read_b64 v[74:75], v8 offset:3080
    ds_read_b64 v[76:77], v8 offset:3584
    ds_read_b64 v[78:79], v8 offset:3592
    s_lshr_b32 s64, s61, 4
    s_lshl_b32 s64, s64, 7
    s_add_u32 s64, s64, 0
    s_cmp_lg_u32 s60, 0
    s_cbranch_scc1 L_wc_5
    v_mov_b32 v4, s64
    buffer_load_dword v5, v4, s[8:11], 0 offen sc1
    s_waitcnt vmcnt(0)
L_pe_6:
    v_cmp_gt_u32 vcc, 16, v5
    s_nop 1
    s_cbranch_vccz L_pok_7
    s_cmp_eq_u32 s97, 0
    s_cbranch_scc1 L_pok_7
    s_sub_u32 s97, s97, 1
    s_sleep 2
    buffer_load_dword v5, v4, s[8:11], 0 offen sc1
    s_waitcnt vmcnt(0)
    s_branch L_pe_6
L_pok_7:
L_wc_5:
    s_barrier
    s_mul_i32 s72, s61, 16384
    s_add_u32 s72, s72, 32768
    s_add_u32 s73, s72, 4096
    s_add_u32 s62, s72, 8192
    s_add_u32 s63, s72, 12288
    v_lshlrev_b32 v6, 4, v0
    v_and_b32 v7, 3, v0
    v_mul_u32_u24 v7, 4576, v7
    v_lshrrev_b32 v10, 2, v0
    v_lshl_add_u32 v7, v10, 4, v7
    v_add_u32 v7, 143360, v7
    buffer_load_dwordx4 v[16:19], v6, s[8:11], s72 offen sc1
    buffer_load_dwordx4 v[20:23], v6, s[8:11], s73 offen sc1
    buffer_load_dwordx4 v[24:27], v6, s[8:11], s62 offen sc1
    buffer_load_dwordx4 v[28:31], v6, s[8:11], s63 offen sc1
    s_waitcnt vmcnt(3)
    ds_write_b128 v7, v[16:19] offset:0
    s_waitcnt vmcnt(2)
    ds_write_b128 v7, v[20:23] offset:1024
    s_waitcnt vmcnt(1)
    ds_write_b128 v7, v[24:27] offset:2048
    s_waitcnt vmcnt(0)
    ds_write_b128 v7, v[28:31] offset:3072
    s_waitcnt lgkmcnt(0)
    s_barrier
    s_and_b32 s62, s61, 15
    s_lshl_b32 s62, s62, 7
    s_add_u32 s62, s62, 8192
    v_mov_b32 v213, s62
    s_and_b32 s62, s61, 15
    s_lshl_b32 s62, s62, 7
    s_add_u32 s62, s62, 10240
    v_mov_b32 v217, s62
    v_lshrrev_b32 v10, 4, v1
    v_mul_u32_u24 v10, 40960, v10
    v_and_b32 v11, 15, v1
    v_lshl_add_u32 v12, v11, 4, v10
    s_lshr_b32 s72, s61, 2
    s_and_b32 s73, s61, 3
    s_lshl_b32 s72, s72, 10
    s_lshl_b32 s73, s73, 8
    s_add_u32 s72, s72, s73
    s_mul_i32 s73, s60, 655360
    s_add_u32 s74, s72, s73
    s_add_u32 s72, s74, 8945664
    s_lshl_b32 s73, s60, 12
    s_add_u32 s73, s73, 11632640
    v_mov_b32 v220, 0
    ds_read_b128 v[112:115], v9 offset:3584
    ds_read_b128 v[116:119], v9 offset:3072
    ds_read_b128 v[120:123], v9 offset:2560
    ds_read_b128 v[124:127], v9 offset:2048
    ds_read_b128 v[128:131], v9 offset:1536
    ds_read_b128 v[132:135], v9 offset:1024
    ds_read_b128 v[136:139], v9 offset:512
    ds_read_b128 v[140:143], v9 offset:0
    s_waitcnt lgkmcnt(0)
    v_mfma_f32_16x16x32_bf16 v[16:19], v[48:51], v[112:115], 0
    ds_read_b64 v[80:81], v8 offset:64
    v_mfma_f32_16x16x32_bf16 v[20:23], v[48:51], v[116:119], 0
    ds_read_b64 v[82:83], v8 offset:72
    v_mfma_f32_16x16x32_bf16 v[24:27], v[48:51], v[120:123], 0
    ds_read_b128 v[144:147], v9 offset:3648
    v_mfma_f32_16x16x32_bf16 v[28:31], v[48:51], v[124:127], 0
    ds_read_b64 v[84:85], v8 offset:576
    v_mfma_f32_16x16x32_bf16 v[32:35], v[48:51], v[128:131], 0
    ds_read_b64 v[86:87], v8 offset:584
    v_mfma_f32_16x16x32_bf16 v[36:39], v[48:51], v[132:135], 0
    ds_read_b128 v[148:151], v9 offset:3136
    v_mfma_f32_16x16x32_bf16 v[40:43], v[48:51], v[136:139], 0
    ds_read_b64 v[88:89], v8 offset:1088
    v_mfma_f32_16x16x32_bf16 v[44:47], v[48:51], v[140:143], 0
    ds_read_b64 v[90:91], v8 offset:1096
    v_mfma_f32_16x16x32_bf16 v[20:23], v[52:55], v[112:115], v[20:23]
    ds_read_b128 v[152:155], v9 offset:2624
    v_mfma_f32_16x16x32_bf16 v[24:27], v[52:55], v[116:119], v[24:27]
    ds_read_b64 v[92:93], v8 offset:1600
    v_mfma_f32_16x16x32_bf16 v[28:31], v[52:55], v[120:123], v[28:31]
    ds_read_b64 v[94:95], v8 offset:1608
    v_mfma_f32_16x16x32_bf16 v[32:35], v[52:55], v[124:127], v[32:35]
    ds_read_b128 v[156:159], v9 offset:2112
    v_mfma_f32_16x16x32_bf16 v[36:39], v[52:55], v[128:131], v[36:39]
    ds_read_b64 v[96:97], v8 offset:2112
    v_mfma_f32_16x16x32_bf16 v[40:43], v[52:55], v[132:135], v[40:43]
    ds_read_b64 v[98:99], v8 offset:2120
    v_mfma_f32_16x16x32_bf16 v[44:47], v[52:55], v[136:139], v[44:47]
    ds_read_b128 v[160:163], v9 offset:1600
    v_mfma_f32_16x16x32_bf16 v[24:27], v[56:59], v[112:115], v[24:27]
    ds_read_b64 v[100:101], v8 offset:2624
    v_mfma_f32_16x16x32_bf16 v[28:31], v[56:59], v[116:119], v[28:31]
    ds_read_b64 v[102:103], v8 offset:2632
    v_mfma_f32_16x16x32_bf16 v[32:35], v[56:59], v[120:123], v[32:35]
    ds_read_b128 v[164:167], v9 offset:1088
    v_mfma_f32_16x16x32_bf16 v[36:39], v[56:59], v[124:127], v[36:39]
    ds_read_b64 v[104:105], v8 offset:3136
    v_mfma_f32_16x16x32_bf16 v[40:43], v[56:59], v[128:131], v[40:43]
    ds_read_b64 v[106:107], v8 offset:3144
    v_mfma_f32_16x16x32_bf16 v[44:47], v[56:59], v[132:135], v[44:47]
    ds_read_b128 v[168:171], v9 offset:576
    v_mfma_f32_16x16x32_bf16 v[28:31], v[60:63], v[112:115], v[28:31]
    ds_read_b64 v[108:109], v8 offset:3648
    v_mfma_f32_16x16x32_bf16 v[32:35], v[60:63], v[116:119], v[32:35]
    ds_read_b64 v[110:111], v8 offset:3656
    v_mfma_f32_16x16x32_bf16 v[36:39], v[60:63], v[120:123], v[36:39]
    ds_read_b128 v[172:175], v9 offset:64
    v_mfma_f32_16x16x32_bf16 v[40:43], v[60:63], v[124:127], v[40:43]
    ds_read_b64 v[226:227], v222 offset:3584
    v_mfma_f32_16x16x32_bf16 v[44:47], v[60:63], v[128:131], v[44:47]
    ds_read_b64 v[230:231], v222 offset:3072
    v_mfma_f32_16x16x32_bf16 v[32:35], v[64:67], v[112:115], v[32:35]
    ds_read_b64 v[234:235], v222 offset:2560
    v_mfma_f32_16x16x32_bf16 v[36:39], v[64:67], v[116:119], v[36:39]
    ds_read_b64 v[238:239], v222 offset:2048
    v_mfma_f32_16x16x32_bf16 v[40:43], v[64:67], v[120:123], v[40:43]
    ds_read_b64 v[242:243], v222 offset:1536
    v_mfma_f32_16x16x32_bf16 v[44:47], v[64:67], v[124:127], v[44:47]
    ds_read_b64 v[246:247], v222 offset:1024
    v_mfma_f32_16x16x32_bf16 v[36:39], v[68:71], v[112:115], v[36:39]
    ds_read_b64 v[250:251], v222 offset:512
    v_mfma_f32_16x16x32_bf16 v[40:43], v[68:71], v[116:119], v[40:43]
    ds_read_b64 v[254:255], v222 offset:0
    v_mfma_f32_16x16x32_bf16 v[44:47], v[68:71], v[120:123], v[44:47]
    v_mfma_f32_16x16x32_bf16 v[40:43], v[72:75], v[112:115], v[40:43]
    v_mfma_f32_16x16x32_bf16 v[44:47], v[72:75], v[116:119], v[44:47]
    v_mfma_f32_16x16x32_bf16 v[44:47], v[76:79], v[112:115], v[44:47]
    s_waitcnt lgkmcnt(0)
    v_mfma_f32_16x16x32_bf16 v[16:19], v[80:83], v[144:147], v[16:19]
    ds_read_b64 v[48:49], v8 offset:128
    v_mfma_f32_16x16x32_bf16 v[20:23], v[80:83], v[148:151], v[20:23]
    ds_read_b64 v[50:51], v8 offset:136
    v_mfma_f32_16x16x32_bf16 v[24:27], v[80:83], v[152:155], v[24:27]
    ds_read_b128 v[112:115], v9 offset:3712
    v_mfma_f32_16x16x32_bf16 v[28:31], v[80:83], v[156:159], v[28:31]
    ds_read_b64 v[52:53], v8 offset:640
    v_mfma_f32_16x16x32_bf16 v[32:35], v[80:83], v[160:163], v[32:35]
    ds_read_b64 v[54:55], v8 offset:648
    v_mfma_f32_16x16x32_bf16 v[36:39], v[80:83], v[164:167], v[36:39]
    ds_read_b128 v[116:119], v9 offset:3200
    v_mfma_f32_16x16x32_bf16 v[40:43], v[80:83], v[168:171], v[40:43]
    ds_read_b64 v[56:57], v8 offset:1152
    v_mfma_f32_16x16x32_bf16 v[44:47], v[80:83], v[172:175], v[44:47]
    ds_read_b64 v[58:59], v8 offset:1160
    v_mfma_f32_16x16x32_bf16 v[20:23], v[84:87], v[144:147], v[20:23]
    ds_read_b128 v[120:123], v9 offset:2688
    v_mfma_f32_16x16x32_bf16 v[24:27], v[84:87], v[148:151], v[24:27]
    ds_read_b64 v[60:61], v8 offset:1664
    v_mfma_f32_16x16x32_bf16 v[28:31], v[84:87], v[152:155], v[28:31]
    ds_read_b64 v[62:63], v8 offset:1672
    v_mfma_f32_16x16x32_bf16 v[32:35], v[84:87], v[156:159], v[32:35]
    ds_read_b128 v[124:127], v9 offset:2176
    v_mfma_f32_16x16x32_bf16 v[36:39], v[84:87], v[160:163], v[36:39]
    ds_read_b64 v[64:65], v8 offset:2176
    v_mfma_f32_16x16x32_bf16 v[40:43], v[84:87], v[164:167], v[40:43]
    ds_read_b64 v[66:67], v8 offset:2184
    v_mfma_f32_16x16x32_bf16 v[44:47], v[84:87], v[168:171], v[44:47]
    ds_read_b128 v[128:131], v9 offset:1664
    v_mfma_f32_16x16x32_bf16 v[24:27], v[88:91], v[144:147], v[24:27]
    ds_read_b64 v[68:69], v8 offset:2688
    v_mfma_f32_16x16x32_bf16 v[28:31], v[88:91], v[148:151], v[28:31]
    ds_read_b64 v[70:71], v8 offset:2696
    v_mfma_f32_16x16x32_bf16 v[32:35], v[88:91], v[152:155], v[32:35]
    ds_read_b128 v[132:135], v9 offset:1152
    v_mfma_f32_16x16x32_bf16 v[36:39], v[88:91], v[156:159], v[36:39]
    ds_read_b64 v[72:73], v8 offset:3200
    v_mfma_f32_16x16x32_bf16 v[40:43], v[88:91], v[160:163], v[40:43]
    ds_read_b64 v[74:75], v8 offset:3208
    v_mfma_f32_16x16x32_bf16 v[44:47], v[88:91], v[164:167], v[44:47]
    ds_read_b128 v[136:139], v9 offset:640
    v_mfma_f32_16x16x32_bf16 v[28:31], v[92:95], v[144:147], v[28:31]
    ds_read_b64 v[76:77], v8 offset:3712
    v_mfma_f32_16x16x32_bf16 v[32:35], v[92:95], v[148:151], v[32:35]
    ds_read_b64 v[78:79], v8 offset:3720
    v_mfma_f32_16x16x32_bf16 v[36:39], v[92:95], v[152:155], v[36:39]
    ds_read_b128 v[140:143], v9 offset:128
    v_mfma_f32_16x16x32_bf16 v[40:43], v[92:95], v[156:159], v[40:43]
    v_and_b32 v224, 0xffff0000, v227
    v_mfma_f32_16x16x32_bf16 v[44:47], v[92:95], v[160:163], v[44:47]
    v_lshlrev_b32 v225, 16, v227
    v_mfma_f32_16x16x32_bf16 v[32:35], v[96:99], v[144:147], v[32:35]
    v_lshlrev_b32 v227, 16, v226
    v_mfma_f32_16x16x32_bf16 v[36:39], v[96:99], v[148:151], v[36:39]
    v_and_b32 v226, 0xffff0000, v226
    v_mfma_f32_16x16x32_bf16 v[40:43], v[96:99], v[152:155], v[40:43]
    v_mul_f32 v224, s71, v224
    v_mfma_f32_16x16x32_bf16 v[44:47], v[96:99], v[156:159], v[44:47]
    v_mul_f32 v225, s71, v225
    v_mfma_f32_16x16x32_bf16 v[36:39], v[100:103], v[144:147], v[36:39]
    v_mul_f32 v226, s71, v226
    v_mfma_f32_16x16x32_bf16 v[40:43], v[100:103], v[148:151], v[40:43]
    v_mul_f32 v227, s71, v227
    v_mfma_f32_16x16x32_bf16 v[44:47], v[100:103], v[152:155], v[44:47]
    v_and_b32 v228, 0xffff0000, v231
    v_mfma_f32_16x16x32_bf16 v[40:43], v[104:107], v[144:147], v[40:43]
    v_lshlrev_b32 v229, 16, v231
    v_mfma_f32_16x16x32_bf16 v[44:47], v[104:107], v[148:151], v[44:47]
    v_mfma_f32_16x16x32_bf16 v[44:47], v[108:111], v[144:147], v[44:47]
    s_waitcnt lgkmcnt(0)
    v_mfma_f32_16x16x32_bf16 v[16:19], v[48:51], v[112:115], v[16:19]
    ds_read_b64 v[80:81], v8 offset:192
    v_mfma_f32_16x16x32_bf16 v[20:23], v[48:51], v[116:119], v[20:23]
    ds_read_b64 v[82:83], v8 offset:200
    v_mfma_f32_16x16x32_bf16 v[24:27], v[48:51], v[120:123], v[24:27]
    ds_read_b128 v[144:147], v9 offset:3776
    v_mfma_f32_16x16x32_bf16 v[28:31], v[48:51], v[124:127], v[28:31]
    ds_read_b64 v[84:85], v8 offset:704
    v_mfma_f32_16x16x32_bf16 v[32:35], v[48:51], v[128:131], v[32:35]
    ds_read_b64 v[86:87], v8 offset:712
    v_mfma_f32_16x16x32_bf16 v[36:39], v[48:51], v[132:135], v[36:39]
    ds_read_b128 v[148:151], v9 offset:3264
    v_mfma_f32_16x16x32_bf16 v[40:43], v[48:51], v[136:139], v[40:43]
    ds_read_b64 v[88:89], v8 offset:1216
    v_mfma_f32_16x16x32_bf16 v[44:47], v[48:51], v[140:143], v[44:47]
    ds_read_b64 v[90:91], v8 offset:1224
    v_mfma_f32_16x16x32_bf16 v[20:23], v[52:55], v[112:115], v[20:23]
    ds_read_b128 v[152:155], v9 offset:2752
    v_mfma_f32_16x16x32_bf16 v[24:27], v[52:55], v[116:119], v[24:27]
    ds_read_b64 v[92:93], v8 offset:1728
    v_mfma_f32_16x16x32_bf16 v[28:31], v[52:55], v[120:123], v[28:31]
    ds_read_b64 v[94:95], v8 offset:1736
    v_mfma_f32_16x16x32_bf16 v[32:35], v[52:55], v[124:127], v[32:35]
    ds_read_b128 v[156:159], v9 offset:2240
    v_mfma_f32_16x16x32_bf16 v[36:39], v[52:55], v[128:131], v[36:39]
    ds_read_b64 v[96:97], v8 offset:2240
    v_mfma_f32_16x16x32_bf16 v[40:43], v[52:55], v[132:135], v[40:43]
    ds_read_b64 v[98:99], v8 offset:2248
    v_mfma_f32_16x16x32_bf16 v[44:47], v[52:55], v[136:139], v[44:47]
    ds_read_b128 v[160:163], v9 offset:1728
    v_mfma_f32_16x16x32_bf16 v[24:27], v[56:59], v[112:115], v[24:27]
    ds_read_b64 v[100:101], v8 offset:2752
    v_mfma_f32_16x16x32_bf16 v[28:31], v[56:59], v[116:119], v[28:31]
    ds_read_b64 v[102:103], v8 offset:2760
    v_mfma_f32_16x16x32_bf16 v[32:35], v[56:59], v[120:123], v[32:35]
    ds_read_b128 v[164:167], v9 offset:1216
    v_mfma_f32_16x16x32_bf16 v[36:39], v[56:59], v[124:127], v[36:39]
    ds_read_b64 v[104:105], v8 offset:3264
    v_mfma_f32_16x16x32_bf16 v[40:43], v[56:59], v[128:131], v[40:43]
    ds_read_b64 v[106:107], v8 offset:3272
    v_mfma_f32_16x16x32_bf16 v[44:47], v[56:59], v[132:135], v[44:47]
    ds_read_b128 v[168:171], v9 offset:704
    v_mfma_f32_16x16x32_bf16 v[28:31], v[60:63], v[112:115], v[28:31]
    ds_read_b64 v[108:109], v8 offset:3776
    v_mfma_f32_16x16x32_bf16 v[32:35], v[60:63], v[116:119], v[32:35]
    ds_read_b64 v[110:111], v8 offset:3784
    v_mfma_f32_16x16x32_bf16 v[36:39], v[60:63], v[120:123], v[36:39]
    ds_read_b128 v[172:175], v9 offset:192
    v_mfma_f32_16x16x32_bf16 v[40:43], v[60:63], v[124:127], v[40:43]
    v_lshlrev_b32 v231, 16, v230
    v_mfma_f32_16x16x32_bf16 v[44:47], v[60:63], v[128:131], v[44:47]
    v_and_b32 v230, 0xffff0000, v230
    v_mfma_f32_16x16x32_bf16 v[32:35], v[64:67], v[112:115], v[32:35]
    v_mul_f32 v228, s71, v228
    v_mfma_f32_16x16x32_bf16 v[36:39], v[64:67], v[116:119], v[36:39]
    v_mul_f32 v229, s71, v229
    v_mfma_f32_16x16x32_bf16 v[40:43], v[64:67], v[120:123], v[40:43]
    v_mul_f32 v230, s71, v230
    v_mfma_f32_16x16x32_bf16 v[44:47], v[64:67], v[124:127], v[44:47]
    v_mul_f32 v231, s71, v231
    v_mfma_f32_16x16x32_bf16 v[36:39], v[68:71], v[112:115], v[36:39]
    v_and_b32 v232, 0xffff0000, v235
    v_mfma_f32_16x16x32_bf16 v[40:43], v[68:71], v[116:119], v[40:43]
    v_lshlrev_b32 v233, 16, v235
    v_mfma_f32_16x16x32_bf16 v[44:47], v[68:71], v[120:123], v[44:47]
    v_lshlrev_b32 v235, 16, v234
    v_mfma_f32_16x16x32_bf16 v[40:43], v[72:75], v[112:115], v[40:43]
    v_and_b32 v234, 0xffff0000, v234
    v_mfma_f32_16x16x32_bf16 v[44:47], v[72:75], v[116:119], v[44:47]
    v_mfma_f32_16x16x32_bf16 v[44:47], v[76:79], v[112:115], v[44:47]
    s_waitcnt lgkmcnt(0)
    s_cmp_lg_u32 s60, 0
    s_cbranch_scc1 L_w0o_8
    buffer_load_dword v212, v213, s[8:11], 0 offen sc1
L_w0o_8:
    v_mfma_f32_16x16x32_bf16 v[16:19], v[80:83], v[144:147], v[16:19]
    ds_read_b64 v[48:49], v8 offset:256
    v_mfma_f32_16x16x32_bf16 v[20:23], v[80:83], v[148:151], v[20:23]
    ds_read_b64 v[50:51], v8 offset:264
    v_mfma_f32_16x16x32_bf16 v[24:27], v[80:83], v[152:155], v[24:27]
    ds_read_b128 v[112:115], v9 offset:3840
    v_mfma_f32_16x16x32_bf16 v[28:31], v[80:83], v[156:159], v[28:31]
    ds_read_b64 v[52:53], v8 offset:768
    v_mfma_f32_16x16x32_bf16 v[32:35], v[80:83], v[160:163], v[32:35]
    ds_read_b64 v[54:55], v8 offset:776
    v_mfma_f32_16x16x32_bf16 v[36:39], v[80:83], v[164:167], v[36:39]
    ds_read_b128 v[116:119], v9 offset:3328
    v_mfma_f32_16x16x32_bf16 v[40:43], v[80:83], v[168:171], v[40:43]
    ds_read_b64 v[56:57], v8 offset:1280
    v_mfma_f32_16x16x32_bf16 v[44:47], v[80:83], v[172:175], v[44:47]
    ds_read_b64 v[58:59], v8 offset:1288
    v_mfma_f32_16x16x32_bf16 v[20:23], v[84:87], v[144:147], v[20:23]
    ds_read_b128 v[120:123], v9 offset:2816
    v_mfma_f32_16x16x32_bf16 v[24:27], v[84:87], v[148:151], v[24:27]
    ds_read_b64 v[60:61], v8 offset:1792
    v_mfma_f32_16x16x32_bf16 v[28:31], v[84:87], v[152:155], v[28:31]
    ds_read_b64 v[62:63], v8 offset:1800
    v_mfma_f32_16x16x32_bf16 v[32:35], v[84:87], v[156:159], v[32:35]
    ds_read_b128 v[124:127], v9 offset:2304
    v_mfma_f32_16x16x32_bf16 v[36:39], v[84:87], v[160:163], v[36:39]
    ds_read_b64 v[64:65], v8 offset:2304
    v_mfma_f32_16x16x32_bf16 v[40:43], v[84:87], v[164:167], v[40:43]
    ds_read_b64 v[66:67], v8 offset:2312
    v_mfma_f32_16x16x32_bf16 v[44:47], v[84:87], v[168:171], v[44:47]
    ds_read_b128 v[128:131], v9 offset:1792
    v_mfma_f32_16x16x32_bf16 v[24:27], v[88:91], v[144:147], v[24:27]
    ds_read_b64 v[68:69], v8 offset:2816
    v_mfma_f32_16x16x32_bf16 v[28:31], v[88:91], v[148:151], v[28:31]
    ds_read_b64 v[70:71], v8 offset:2824
    v_mfma_f32_16x16x32_bf16 v[32:35], v[88:91], v[152:155], v[32:35]
    ds_read_b128 v[132:135], v9 offset:1280
    v_mfma_f32_16x16x32_bf16 v[36:39], v[88:91], v[156:159], v[36:39]
    ds_read_b64 v[72:73], v8 offset:3328
    v_mfma_f32_16x16x32_bf16 v[40:43], v[88:91], v[160:163], v[40:43]
    ds_read_b64 v[74:75], v8 offset:3336
    v_mfma_f32_16x16x32_bf16 v[44:47], v[88:91], v[164:167], v[44:47]
    ds_read_b128 v[136:139], v9 offset:768
    v_mfma_f32_16x16x32_bf16 v[28:31], v[92:95], v[144:147], v[28:31]
    ds_read_b64 v[76:77], v8 offset:3840
    v_mfma_f32_16x16x32_bf16 v[32:35], v[92:95], v[148:151], v[32:35]
    ds_read_b64 v[78:79], v8 offset:3848
    v_mfma_f32_16x16x32_bf16 v[36:39], v[92:95], v[152:155], v[36:39]
    ds_read_b128 v[140:143], v9 offset:256
    v_mfma_f32_16x16x32_bf16 v[40:43], v[92:95], v[156:159], v[40:43]
    v_mul_f32 v232, s71, v232
    v_mfma_f32_16x16x32_bf16 v[44:47], v[92:95], v[160:163], v[44:47]
    v_mul_f32 v233, s71, v233
    v_mfma_f32_16x16x32_bf16 v[32:35], v[96:99], v[144:147], v[32:35]
    v_mul_f32 v234, s71, v234
    v_mfma_f32_16x16x32_bf16 v[36:39], v[96:99], v[148:151], v[36:39]
    v_mul_f32 v235, s71, v235
    v_mfma_f32_16x16x32_bf16 v[40:43], v[96:99], v[152:155], v[40:43]
    v_and_b32 v236, 0xffff0000, v239
    v_mfma_f32_16x16x32_bf16 v[44:47], v[96:99], v[156:159], v[44:47]
    v_lshlrev_b32 v237, 16, v239
    v_mfma_f32_16x16x32_bf16 v[36:39], v[100:103], v[144:147], v[36:39]
    v_lshlrev_b32 v239, 16, v238
    v_mfma_f32_16x16x32_bf16 v[40:43], v[100:103], v[148:151], v[40:43]
    v_and_b32 v238, 0xffff0000, v238
    v_mfma_f32_16x16x32_bf16 v[44:47], v[100:103], v[152:155], v[44:47]
    v_mul_f32 v236, s71, v236
    v_mfma_f32_16x16x32_bf16 v[40:43], v[104:107], v[144:147], v[40:43]
    v_mul_f32 v237, s71, v237
    v_mfma_f32_16x16x32_bf16 v[44:47], v[104:107], v[148:151], v[44:47]
    v_mfma_f32_16x16x32_bf16 v[44:47], v[108:111], v[144:147], v[44:47]
    s_waitcnt lgkmcnt(0)
    s_cmp_lg_u32 s60, 0
    s_cbranch_scc1 L_w0o_9
    s_waitcnt vmcnt(0)
    v_cmp_gt_u32 vcc, 64, v212
    s_nop 1
    s_cmp_eq_u64 vcc, 0
    s_cselect_b32 s62, 1, 0
    v_mov_b32 v221, s62
    ds_write_b32 v220, v221
    buffer_load_dword v216, v217, s[8:11], 0 offen sc1
L_w0o_9:
    v_mfma_f32_16x16x32_bf16 v[16:19], v[48:51], v[112:115], v[16:19]
    ds_read_b64 v[80:81], v8 offset:320
    v_mfma_f32_16x16x32_bf16 v[20:23], v[48:51], v[116:119], v[20:23]
    ds_read_b64 v[82:83], v8 offset:328
    v_mfma_f32_16x16x32_bf16 v[24:27], v[48:51], v[120:123], v[24:27]
    ds_read_b128 v[144:147], v9 offset:3904
    v_mfma_f32_16x16x32_bf16 v[28:31], v[48:51], v[124:127], v[28:31]
    ds_read_b64 v[84:85], v8 offset:832
    v_mfma_f32_16x16x32_bf16 v[32:35], v[48:51], v[128:131], v[32:35]
    ds_read_b64 v[86:87], v8 offset:840
    v_mfma_f32_16x16x32_bf16 v[36:39], v[48:51], v[132:135], v[36:39]
    ds_read_b128 v[148:151], v9 offset:3392
    v_mfma_f32_16x16x32_bf16 v[40:43], v[48:51], v[136:139], v[40:43]
    ds_read_b64 v[88:89], v8 offset:1344
    v_mfma_f32_16x16x32_bf16 v[44:47], v[48:51], v[140:143], v[44:47]
    ds_read_b64 v[90:91], v8 offset:1352
    v_mfma_f32_16x16x32_bf16 v[20:23], v[52:55], v[112:115], v[20:23]
    ds_read_b128 v[152:155], v9 offset:2880
    v_mfma_f32_16x16x32_bf16 v[24:27], v[52:55], v[116:119], v[24:27]
    ds_read_b64 v[92:93], v8 offset:1856
    v_mfma_f32_16x16x32_bf16 v[28:31], v[52:55], v[120:123], v[28:31]
    ds_read_b64 v[94:95], v8 offset:1864
    v_mfma_f32_16x16x32_bf16 v[32:35], v[52:55], v[124:127], v[32:35]
    ds_read_b128 v[156:159], v9 offset:2368
    v_mfma_f32_16x16x32_bf16 v[36:39], v[52:55], v[128:131], v[36:39]
    ds_read_b64 v[96:97], v8 offset:2368
    v_mfma_f32_16x16x32_bf16 v[40:43], v[52:55], v[132:135], v[40:43]
    ds_read_b64 v[98:99], v8 offset:2376
    v_mfma_f32_16x16x32_bf16 v[44:47], v[52:55], v[136:139], v[44:47]
    ds_read_b128 v[160:163], v9 offset:1856
    v_mfma_f32_16x16x32_bf16 v[24:27], v[56:59], v[112:115], v[24:27]
    ds_read_b64 v[100:101], v8 offset:2880
    v_mfma_f32_16x16x32_bf16 v[28:31], v[56:59], v[116:119], v[28:31]
    ds_read_b64 v[102:103], v8 offset:2888
    v_mfma_f32_16x16x32_bf16 v[32:35], v[56:59], v[120:123], v[32:35]
    ds_read_b128 v[164:167], v9 offset:1344
    v_mfma_f32_16x16x32_bf16 v[36:39], v[56:59], v[124:127], v[36:39]
    ds_read_b64 v[104:105], v8 offset:3392
    v_mfma_f32_16x16x32_bf16 v[40:43], v[56:59], v[128:131], v[40:43]
    ds_read_b64 v[106:107], v8 offset:3400
    v_mfma_f32_16x16x32_bf16 v[44:47], v[56:59], v[132:135], v[44:47]
    ds_read_b128 v[168:171], v9 offset:832
    v_mfma_f32_16x16x32_bf16 v[28:31], v[60:63], v[112:115], v[28:31]
    ds_read_b64 v[108:109], v8 offset:3904
    v_mfma_f32_16x16x32_bf16 v[32:35], v[60:63], v[116:119], v[32:35]
    ds_read_b64 v[110:111], v8 offset:3912
    v_mfma_f32_16x16x32_bf16 v[36:39], v[60:63], v[120:123], v[36:39]
    ds_read_b128 v[172:175], v9 offset:320
    v_mfma_f32_16x16x32_bf16 v[40:43], v[60:63], v[124:127], v[40:43]
    v_mul_f32 v238, s71, v238
    v_mfma_f32_16x16x32_bf16 v[44:47], v[60:63], v[128:131], v[44:47]
    v_mul_f32 v239, s71, v239
    v_mfma_f32_16x16x32_bf16 v[32:35], v[64:67], v[112:115], v[32:35]
    v_and_b32 v240, 0xffff0000, v243
    v_mfma_f32_16x16x32_bf16 v[36:39], v[64:67], v[116:119], v[36:39]
    v_lshlrev_b32 v241, 16, v243
    v_mfma_f32_16x16x32_bf16 v[40:43], v[64:67], v[120:123], v[40:43]
    v_lshlrev_b32 v243, 16, v242
    v_mfma_f32_16x16x32_bf16 v[44:47], v[64:67], v[124:127], v[44:47]
    v_and_b32 v242, 0xffff0000, v242
    v_mfma_f32_16x16x32_bf16 v[36:39], v[68:71], v[112:115], v[36:39]
    v_mul_f32 v240, s71, v240
    v_mfma_f32_16x16x32_bf16 v[40:43], v[68:71], v[116:119], v[40:43]
    v_mul_f32 v241, s71, v241
    v_mfma_f32_16x16x32_bf16 v[44:47], v[68:71], v[120:123], v[44:47]
    v_mul_f32 v242, s71, v242
    v_mfma_f32_16x16x32_bf16 v[40:43], v[72:75], v[112:115], v[40:43]
    v_mul_f32 v243, s71, v243
    v_mfma_f32_16x16x32_bf16 v[44:47], v[72:75], v[116:119], v[44:47]
    v_mfma_f32_16x16x32_bf16 v[44:47], v[76:79], v[112:115], v[44:47]
    s_waitcnt lgkmcnt(0)
    s_barrier
    ds_read_b32 v221, v220
    s_waitcnt lgkmcnt(0)
    v_readfirstlane_b32 s69, v221
    s_nop 3
    s_lshr_b32 s70, s69, 1
    s_and_b32 s69, s69, 1
    s_cmp_eq_u32 s69, 0
    s_cbranch_scc1 L_lq_10
    buffer_load_dwordx4 v[176:179], v12, s[8:11], s72 offen sc1
    buffer_load_dwordx4 v[192:195], v2, s[8:11], s73 offen sc1
    s_add_u32 s72, s72, 163840
    s_add_u32 s73, s73, 1024
    buffer_load_dwordx4 v[180:183], v12, s[8:11], s72 offen sc1
    buffer_load_dwordx4 v[196:199], v2, s[8:11], s73 offen sc1
    s_add_u32 s72, s72, 163840
    s_add_u32 s73, s73, 1024
    buffer_load_dwordx4 v[184:187], v12, s[8:11], s72 offen sc1
    buffer_load_dwordx4 v[200:203], v2, s[8:11], s73 offen sc1
    s_add_u32 s72, s72, 163840
    s_add_u32 s73, s73, 1024
    buffer_load_dwordx4 v[188:191], v12, s[8:11], s72 offen sc1
    buffer_load_dwordx4 v[204:207], v2, s[8:11], s73 offen sc1
    s_add_u32 s72, s72, 163840
    s_add_u32 s73, s73, 1024
L_lq_10:
    v_mfma_f32_16x16x32_bf16 v[16:19], v[80:83], v[144:147], v[16:19]
    ds_read_b64 v[48:49], v8 offset:384
    v_mfma_f32_16x16x32_bf16 v[20:23], v[80:83], v[148:151], v[20:23]
    ds_read_b64 v[50:51], v8 offset:392
    v_mfma_f32_16x16x32_bf16 v[24:27], v[80:83], v[152:155], v[24:27]
    ds_read_b128 v[112:115], v9 offset:3968
    v_mfma_f32_16x16x32_bf16 v[28:31], v[80:83], v[156:159], v[28:31]
    ds_read_b64 v[52:53], v8 offset:896
    v_mfma_f32_16x16x32_bf16 v[32:35], v[80:83], v[160:163], v[32:35]
    ds_read_b64 v[54:55], v8 offset:904
    v_mfma_f32_16x16x32_bf16 v[36:39], v[80:83], v[164:167], v[36:39]
    ds_read_b128 v[116:119], v9 offset:3456
    v_mfma_f32_16x16x32_bf16 v[40:43], v[80:83], v[168:171], v[40:43]
    ds_read_b64 v[56:57], v8 offset:1408
    v_mfma_f32_16x16x32_bf16 v[44:47], v[80:83], v[172:175], v[44:47]
    ds_read_b64 v[58:59], v8 offset:1416
    v_mfma_f32_16x16x32_bf16 v[20:23], v[84:87], v[144:147], v[20:23]
    ds_read_b128 v[120:123], v9 offset:2944
    v_mfma_f32_16x16x32_bf16 v[24:27], v[84:87], v[148:151], v[24:27]
    ds_read_b64 v[60:61], v8 offset:1920
    v_mfma_f32_16x16x32_bf16 v[28:31], v[84:87], v[152:155], v[28:31]
    ds_read_b64 v[62:63], v8 offset:1928
    v_mfma_f32_16x16x32_bf16 v[32:35], v[84:87], v[156:159], v[32:35]
    ds_read_b128 v[124:127], v9 offset:2432
    v_mfma_f32_16x16x32_bf16 v[36:39], v[84:87], v[160:163], v[36:39]
    ds_read_b64 v[64:65], v8 offset:2432
    v_mfma_f32_16x16x32_bf16 v[40:43], v[84:87], v[164:167], v[40:43]
    ds_read_b64 v[66:67], v8 offset:2440
    v_mfma_f32_16x16x32_bf16 v[44:47], v[84:87], v[168:171], v[44:47]
    ds_read_b128 v[128:131], v9 offset:1920
    v_mfma_f32_16x16x32_bf16 v[24:27], v[88:91], v[144:147], v[24:27]
    ds_read_b64 v[68:69], v8 offset:2944
    v_mfma_f32_16x16x32_bf16 v[28:31], v[88:91], v[148:151], v[28:31]
    ds_read_b64 v[70:71], v8 offset:2952
    v_mfma_f32_16x16x32_bf16 v[32:35], v[88:91], v[152:155], v[32:35]
    ds_read_b128 v[132:135], v9 offset:1408
    v_mfma_f32_16x16x32_bf16 v[36:39], v[88:91], v[156:159], v[36:39]
    ds_read_b64 v[72:73], v8 offset:3456
    v_mfma_f32_16x16x32_bf16 v[40:43], v[88:91], v[160:163], v[40:43]
    ds_read_b64 v[74:75], v8 offset:3464
    v_mfma_f32_16x16x32_bf16 v[44:47], v[88:91], v[164:167], v[44:47]
    ds_read_b128 v[136:139], v9 offset:896
    v_mfma_f32_16x16x32_bf16 v[28:31], v[92:95], v[144:147], v[28:31]
    ds_read_b64 v[76:77], v8 offset:3968
    v_mfma_f32_16x16x32_bf16 v[32:35], v[92:95], v[148:151], v[32:35]
    ds_read_b64 v[78:79], v8 offset:3976
    v_mfma_f32_16x16x32_bf16 v[36:39], v[92:95], v[152:155], v[36:39]
    ds_read_b128 v[140:143], v9 offset:384
    v_mfma_f32_16x16x32_bf16 v[40:43], v[92:95], v[156:159], v[40:43]
    v_and_b32 v244, 0xffff0000, v247
    v_mfma_f32_16x16x32_bf16 v[44:47], v[92:95], v[160:163], v[44:47]
    v_lshlrev_b32 v245, 16, v247
    v_mfma_f32_16x16x32_bf16 v[32:35], v[96:99], v[144:147], v[32:35]
    v_lshlrev_b32 v247, 16, v246
    v_mfma_f32_16x16x32_bf16 v[36:39], v[96:99], v[148:151], v[36:39]
    v_and_b32 v246, 0xffff0000, v246
    v_mfma_f32_16x16x32_bf16 v[40:43], v[96:99], v[152:155], v[40:43]
    v_mul_f32 v244, s71, v244
    v_mfma_f32_16x16x32_bf16 v[44:47], v[96:99], v[156:159], v[44:47]
    v_mul_f32 v245, s71, v245
    v_mfma_f32_16x16x32_bf16 v[36:39], v[100:103], v[144:147], v[36:39]
    v_mul_f32 v246, s71, v246
    v_mfma_f32_16x16x32_bf16 v[40:43], v[100:103], v[148:151], v[40:43]
    v_mul_f32 v247, s71, v247
    v_mfma_f32_16x16x32_bf16 v[44:47], v[100:103], v[152:155], v[44:47]
    v_and_b32 v248, 0xffff0000, v251
    v_mfma_f32_16x16x32_bf16 v[40:43], v[104:107], v[144:147], v[40:43]
    v_lshlrev_b32 v249, 16, v251
    v_mfma_f32_16x16x32_bf16 v[44:47], v[104:107], v[148:151], v[44:47]
    v_mfma_f32_16x16x32_bf16 v[44:47], v[108:111], v[144:147], v[44:47]
    s_waitcnt lgkmcnt(0)
    v_mfma_f32_16x16x32_bf16 v[16:19], v[48:51], v[112:115], v[16:19]
    ds_read_b64 v[80:81], v8 offset:448
    v_mfma_f32_16x16x32_bf16 v[20:23], v[48:51], v[116:119], v[20:23]
    ds_read_b64 v[82:83], v8 offset:456
    v_mfma_f32_16x16x32_bf16 v[24:27], v[48:51], v[120:123], v[24:27]
    ds_read_b128 v[144:147], v9 offset:4032
    v_mfma_f32_16x16x32_bf16 v[28:31], v[48:51], v[124:127], v[28:31]
    ds_read_b64 v[84:85], v8 offset:960
    v_mfma_f32_16x16x32_bf16 v[32:35], v[48:51], v[128:131], v[32:35]
    ds_read_b64 v[86:87], v8 offset:968
    v_mfma_f32_16x16x32_bf16 v[36:39], v[48:51], v[132:135], v[36:39]
    ds_read_b128 v[148:151], v9 offset:3520
    v_mfma_f32_16x16x32_bf16 v[40:43], v[48:51], v[136:139], v[40:43]
    ds_read_b64 v[88:89], v8 offset:1472
    v_mfma_f32_16x16x32_bf16 v[44:47], v[48:51], v[140:143], v[44:47]
    ds_read_b64 v[90:91], v8 offset:1480
    v_mfma_f32_16x16x32_bf16 v[20:23], v[52:55], v[112:115], v[20:23]
    ds_read_b128 v[152:155], v9 offset:3008
    v_mfma_f32_16x16x32_bf16 v[24:27], v[52:55], v[116:119], v[24:27]
    ds_read_b64 v[92:93], v8 offset:1984
    v_mfma_f32_16x16x32_bf16 v[28:31], v[52:55], v[120:123], v[28:31]
    ds_read_b64 v[94:95], v8 offset:1992
    v_mfma_f32_16x16x32_bf16 v[32:35], v[52:55], v[124:127], v[32:35]
    ds_read_b128 v[156:159], v9 offset:2496
    v_mfma_f32_16x16x32_bf16 v[36:39], v[52:55], v[128:131], v[36:39]
    ds_read_b64 v[96:97], v8 offset:2496
    v_mfma_f32_16x16x32_bf16 v[40:43], v[52:55], v[132:135], v[40:43]
    ds_read_b64 v[98:99], v8 offset:2504
    v_mfma_f32_16x16x32_bf16 v[44:47], v[52:55], v[136:139], v[44:47]
    ds_read_b128 v[160:163], v9 offset:1984
    v_mfma_f32_16x16x32_bf16 v[24:27], v[56:59], v[112:115], v[24:27]
    ds_read_b64 v[100:101], v8 offset:3008
    v_mfma_f32_16x16x32_bf16 v[28:31], v[56:59], v[116:119], v[28:31]
    ds_read_b64 v[102:103], v8 offset:3016
    v_mfma_f32_16x16x32_bf16 v[32:35], v[56:59], v[120:123], v[32:35]
    ds_read_b128 v[164:167], v9 offset:1472
    v_mfma_f32_16x16x32_bf16 v[36:39], v[56:59], v[124:127], v[36:39]
    ds_read_b64 v[104:105], v8 offset:3520
    v_mfma_f32_16x16x32_bf16 v[40:43], v[56:59], v[128:131], v[40:43]
    ds_read_b64 v[106:107], v8 offset:3528
    v_mfma_f32_16x16x32_bf16 v[44:47], v[56:59], v[132:135], v[44:47]
    ds_read_b128 v[168:171], v9 offset:960
    v_mfma_f32_16x16x32_bf16 v[28:31], v[60:63], v[112:115], v[28:31]
    ds_read_b64 v[108:109], v8 offset:4032
    v_mfma_f32_16x16x32_bf16 v[32:35], v[60:63], v[116:119], v[32:35]
    ds_read_b64 v[110:111], v8 offset:4040
    v_mfma_f32_16x16x32_bf16 v[36:39], v[60:63], v[120:123], v[36:39]
    ds_read_b128 v[172:175], v9 offset:448
    v_mfma_f32_16x16x32_bf16 v[40:43], v[60:63], v[124:127], v[40:43]
    v_lshlrev_b32 v251, 16, v250
    v_mfma_f32_16x16x32_bf16 v[44:47], v[60:63], v[128:131], v[44:47]
    v_and_b32 v250, 0xffff0000, v250
    v_mfma_f32_16x16x32_bf16 v[32:35], v[64:67], v[112:115], v[32:35]
    v_mul_f32 v248, s71, v248
    v_mfma_f32_16x16x32_bf16 v[36:39], v[64:67], v[116:119], v[36:39]
    v_mul_f32 v249, s71, v249
    v_mfma_f32_16x16x32_bf16 v[40:43], v[64:67], v[120:123], v[40:43]
    v_mul_f32 v250, s71, v250
    v_mfma_f32_16x16x32_bf16 v[44:47], v[64:67], v[124:127], v[44:47]
    v_mul_f32 v251, s71, v251
    v_mfma_f32_16x16x32_bf16 v[36:39], v[68:71], v[112:115], v[36:39]
    v_and_b32 v252, 0xffff0000, v255
    v_mfma_f32_16x16x32_bf16 v[40:43], v[68:71], v[116:119], v[40:43]
    v_lshlrev_b32 v253, 16, v255
    v_mfma_f32_16x16x32_bf16 v[44:47], v[68:71], v[120:123], v[44:47]
    v_lshlrev_b32 v255, 16, v254
    v_mfma_f32_16x16x32_bf16 v[40:43], v[72:75], v[112:115], v[40:43]
    v_and_b32 v254, 0xffff0000, v254
    v_mfma_f32_16x16x32_bf16 v[44:47], v[72:75], v[116:119], v[44:47]
    v_mfma_f32_16x16x32_bf16 v[44:47], v[76:79], v[112:115], v[44:47]
    s_waitcnt lgkmcnt(0)
    v_mfma_f32_16x16x32_bf16 v[16:19], v[80:83], v[144:147], v[16:19]
    v_mul_f32 v252, s71, v252
    v_mfma_f32_16x16x32_bf16 v[20:23], v[80:83], v[148:151], v[20:23]
    v_mul_f32 v253, s71, v253
    v_mfma_f32_16x16x32_bf16 v[24:27], v[80:83], v[152:155], v[24:27]
    v_mul_f32 v254, s71, v254
    v_mfma_f32_16x16x32_bf16 v[28:31], v[80:83], v[156:159], v[28:31]
    v_mul_f32 v255, s71, v255
    v_mfma_f32_16x16x32_bf16 v[32:35], v[80:83], v[160:163], v[32:35]
    v_mfma_f32_16x16x32_bf16 v[36:39], v[80:83], v[164:167], v[36:39]
    v_mfma_f32_16x16x32_bf16 v[40:43], v[80:83], v[168:171], v[40:43]
    v_mfma_f32_16x16x32_bf16 v[44:47], v[80:83], v[172:175], v[44:47]
    v_mfma_f32_16x16x32_bf16 v[20:23], v[84:87], v[144:147], v[20:23]
    v_mfma_f32_16x16x32_bf16 v[24:27], v[84:87], v[148:151], v[24:27]
    v_mfma_f32_16x16x32_bf16 v[28:31], v[84:87], v[152:155], v[28:31]
    v_mfma_f32_16x16x32_bf16 v[32:35], v[84:87], v[156:159], v[32:35]
    v_mfma_f32_16x16x32_bf16 v[36:39], v[84:87], v[160:163], v[36:39]
    v_mfma_f32_16x16x32_bf16 v[40:43], v[84:87], v[164:167], v[40:43]
    v_mfma_f32_16x16x32_bf16 v[44:47], v[84:87], v[168:171], v[44:47]
    v_mfma_f32_16x16x32_bf16 v[24:27], v[88:91], v[144:147], v[24:27]
    v_mfma_f32_16x16x32_bf16 v[28:31], v[88:91], v[148:151], v[28:31]
    v_mfma_f32_16x16x32_bf16 v[32:35], v[88:91], v[152:155], v[32:35]
    v_mfma_f32_16x16x32_bf16 v[36:39], v[88:91], v[156:159], v[36:39]
    v_mfma_f32_16x16x32_bf16 v[40:43], v[88:91], v[160:163], v[40:43]
    v_mfma_f32_16x16x32_bf16 v[44:47], v[88:91], v[164:167], v[44:47]
    v_mfma_f32_16x16x32_bf16 v[28:31], v[92:95], v[144:147], v[28:31]
    v_mfma_f32_16x16x32_bf16 v[32:35], v[92:95], v[148:151], v[32:35]
    v_mfma_f32_16x16x32_bf16 v[36:39], v[92:95], v[152:155], v[36:39]
    v_mfma_f32_16x16x32_bf16 v[40:43], v[92:95], v[156:159], v[40:43]
    v_mfma_f32_16x16x32_bf16 v[44:47], v[92:95], v[160:163], v[44:47]
    v_mfma_f32_16x16x32_bf16 v[32:35], v[96:99], v[144:147], v[32:35]
    v_mfma_f32_16x16x32_bf16 v[36:39], v[96:99], v[148:151], v[36:39]
    v_mfma_f32_16x16x32_bf16 v[40:43], v[96:99], v[152:155], v[40:43]
    v_mfma_f32_16x16x32_bf16 v[44:47], v[96:99], v[156:159], v[44:47]
    v_mfma_f32_16x16x32_bf16 v[36:39], v[100:103], v[144:147], v[36:39]
    v_mfma_f32_16x16x32_bf16 v[40:43], v[100:103], v[148:151], v[40:43]
    v_mfma_f32_16x16x32_bf16 v[44:47], v[100:103], v[152:155], v[44:47]
    v_mfma_f32_16x16x32_bf16 v[40:43], v[104:107], v[144:147], v[40:43]
    v_mfma_f32_16x16x32_bf16 v[44:47], v[104:107], v[148:151], v[44:47]
    v_mfma_f32_16x16x32_bf16 v[44:47], v[108:111], v[144:147], v[44:47]
    s_waitcnt vmcnt(0)
    s_cmp_eq_u32 s69, 1
    s_cbranch_scc1 L_nlq_11
    s_cmp_lg_u32 s60, 0
    s_cbranch_scc1 L_w0o_12
L_pe_13:
    v_cmp_gt_u32 vcc, 64, v212
    s_nop 1
    s_cbranch_vccz L_pok_14
    s_cmp_eq_u32 s97, 0
    s_cbranch_scc1 L_pok_14
    s_sub_u32 s97, s97, 1
    s_sleep 2
    buffer_load_dword v212, v213, s[8:11], 0 offen sc1
    s_waitcnt vmcnt(0)
    s_branch L_pe_13
L_pok_14:
L_w0o_12:
    s_barrier
    buffer_load_dwordx4 v[176:179], v12, s[8:11], s72 offen sc1
    buffer_load_dwordx4 v[192:195], v2, s[8:11], s73 offen sc1
    s_add_u32 s72, s72, 163840
    s_add_u32 s73, s73, 1024
    buffer_load_dwordx4 v[180:183], v12, s[8:11], s72 offen sc1
    buffer_load_dwordx4 v[196:199], v2, s[8:11], s73 offen sc1
    s_add_u32 s72, s72, 163840
    s_add_u32 s73, s73, 1024
    buffer_load_dwordx4 v[184:187], v12, s[8:11], s72 offen sc1
    buffer_load_dwordx4 v[200:203], v2, s[8:11], s73 offen sc1
    s_add_u32 s72, s72, 163840
    s_add_u32 s73, s73, 1024
    buffer_load_dwordx4 v[188:191], v12, s[8:11], s72 offen sc1
    buffer_load_dwordx4 v[204:207], v2, s[8:11], s73 offen sc1
    s_add_u32 s72, s72, 163840
    s_add_u32 s73, s73, 1024
    s_waitcnt vmcnt(0)
L_nlq_11:
    s_nop 7
    v_pk_add_f32 v[16:17], v[16:17], v[224:225]
    v_pk_add_f32 v[18:19], v[18:19], v[226:227]
    v_cvt_pk_bf16_f32 v68, v16, v18
    v_cvt_pk_bf16_f32 v69, v17, v19
    v_pk_add_f32 v[20:21], v[20:21], v[228:229]
    v_pk_add_f32 v[22:23], v[22:23], v[230:231]
    v_cvt_pk_bf16_f32 v70, v20, v22
    v_cvt_pk_bf16_f32 v71, v21, v23
    v_pk_add_f32 v[24:25], v[24:25], v[232:233]
    v_pk_add_f32 v[26:27], v[26:27], v[234:235]
    v_cvt_pk_bf16_f32 v72, v24, v26
    v_cvt_pk_bf16_f32 v73, v25, v27
    v_pk_add_f32 v[28:29], v[28:29], v[236:237]
    v_pk_add_f32 v[30:31], v[30:31], v[238:239]
    v_cvt_pk_bf16_f32 v74, v28, v30
    v_cvt_pk_bf16_f32 v75, v29, v31
    v_pk_add_f32 v[32:33], v[32:33], v[240:241]
    v_pk_add_f32 v[34:35], v[34:35], v[242:243]
    v_cvt_pk_bf16_f32 v76, v32, v34
    v_cvt_pk_bf16_f32 v77, v33, v35
    v_pk_add_f32 v[36:37], v[36:37], v[244:245]
    v_pk_add_f32 v[38:39], v[38:39], v[246:247]
    v_cvt_pk_bf16_f32 v78, v36, v38
    v_cvt_pk_bf16_f32 v79, v37, v39
    v_pk_add_f32 v[40:41], v[40:41], v[248:249]
    v_pk_add_f32 v[42:43], v[42:43], v[250:251]
    v_cvt_pk_bf16_f32 v80, v40, v42
    v_cvt_pk_bf16_f32 v81, v41, v43
    v_pk_add_f32 v[44:45], v[44:45], v[252:253]
    v_pk_add_f32 v[46:47], v[46:47], v[254:255]
    v_cvt_pk_bf16_f32 v82, v44, v46
    v_cvt_pk_bf16_f32 v83, v45, v47
    ds_write_b32 v223, v68 offset:0
    ds_write_b32 v223, v69 offset:2048
    ds_write_b32 v223, v70 offset:256
    ds_write_b32 v223, v71 offset:2304
    ds_write_b32 v223, v72 offset:512
    ds_write_b32 v223, v73 offset:2560
    ds_write_b32 v223, v74 offset:768
    ds_write_b32 v223, v75 offset:2816
    ds_write_b32 v223, v76 offset:1024
    ds_write_b32 v223, v77 offset:3072
    ds_write_b32 v223, v78 offset:1280
    ds_write_b32 v223, v79 offset:3328
    ds_write_b32 v223, v80 offset:1536
    ds_write_b32 v223, v81 offset:3584
    ds_write_b32 v223, v82 offset:1792
    ds_write_b32 v223, v83 offset:3840
    s_waitcnt lgkmcnt(0)
    s_barrier
    v_bfe_u32 v10, v1, 2, 2
    v_mul_u32_u24 v10, 16704, v10
    v_lshrrev_b32 v11, 4, v1
    v_lshl_add_u32 v10, v11, 5, v10
    v_and_b32 v11, 3, v1
    v_lshl_add_u32 v10, v11, 3, v10
    s_lshl_b32 s72, s60, 9
    s_add_u32 s72, s72, 76800
    v_add_u32 v10, s72, v10
    ds_read_b64_tr_b16 v[96:97], v10 offset:0
    ds_read_b64_tr_b16 v[98:99], v10 offset:2048
    ds_read_b64_tr_b16 v[100:101], v10 offset:128
    ds_read_b64_tr_b16 v[102:103], v10 offset:2176
    ds_read_b64_tr_b16 v[104:105], v10 offset:256
    ds_read_b64_tr_b16 v[106:107], v10 offset:2304
    ds_read_b64_tr_b16 v[108:109], v10 offset:384
    ds_read_b64_tr_b16 v[110:111], v10 offset:2432
    s_add_u32 s72, s74, 2654208
    s_add_u32 s73, s74, 5275648
    s_waitcnt lgkmcnt(0)
    buffer_store_dwordx4 v[96:99], v12, s[8:11], s72 offen sc1
    v_mul_f32 v64, v192, v193
    v_mul_f32 v65, v194, v195
    v_lshlrev_b32 v66, 16, v176
    v_and_b32 v67, 0xffff0000, v176
    v_lshlrev_b32 v68, 16, v96
    v_and_b32 v69, 0xffff0000, v96
    v_fma_f32 v70, v66, v193, -v64
    v_fma_f32 v71, v67, v193, -v64
    v_fmac_f32 v66, v70, v68
    v_fmac_f32 v67, v71, v69
    v_cvt_pk_bf16_f32 v128, v66, v67
    v_lshlrev_b32 v66, 16, v177
    v_and_b32 v67, 0xffff0000, v177
    v_lshlrev_b32 v68, 16, v97
    v_and_b32 v69, 0xffff0000, v97
    v_fma_f32 v70, v66, v193, -v64
    v_fma_f32 v71, v67, v193, -v64
    v_fmac_f32 v66, v70, v68
    v_fmac_f32 v67, v71, v69
    v_cvt_pk_bf16_f32 v129, v66, v67
    v_lshlrev_b32 v66, 16, v178
    v_and_b32 v67, 0xffff0000, v178
    v_lshlrev_b32 v68, 16, v98
    v_and_b32 v69, 0xffff0000, v98
    v_fma_f32 v70, v66, v195, -v65
    v_fma_f32 v71, v67, v195, -v65
    v_fmac_f32 v66, v70, v68
    v_fmac_f32 v67, v71, v69
    v_cvt_pk_bf16_f32 v130, v66, v67
    v_lshlrev_b32 v66, 16, v179
    v_and_b32 v67, 0xffff0000, v179
    v_lshlrev_b32 v68, 16, v99
    v_and_b32 v69, 0xffff0000, v99
    v_fma_f32 v70, v66, v195, -v65
    v_fma_f32 v71, v67, v195, -v65
    v_fmac_f32 v66, v70, v68
    v_fmac_f32 v67, v71, v69
    v_cvt_pk_bf16_f32 v131, v66, v67
    buffer_store_dwordx4 v[128:131], v12, s[8:11], s73 offen sc1
    s_add_u32 s72, s72, 163840
    s_add_u32 s73, s73, 163840
    buffer_store_dwordx4 v[100:103], v12, s[8:11], s72 offen sc1
    v_mul_f32 v64, v196, v197
    v_mul_f32 v65, v198, v199
    v_lshlrev_b32 v66, 16, v180
    v_and_b32 v67, 0xffff0000, v180
    v_lshlrev_b32 v68, 16, v100
    v_and_b32 v69, 0xffff0000, v100
    v_fma_f32 v70, v66, v197, -v64
    v_fma_f32 v71, v67, v197, -v64
    v_fmac_f32 v66, v70, v68
    v_fmac_f32 v67, v71, v69
    v_cvt_pk_bf16_f32 v132, v66, v67
    v_lshlrev_b32 v66, 16, v181
    v_and_b32 v67, 0xffff0000, v181
    v_lshlrev_b32 v68, 16, v101
    v_and_b32 v69, 0xffff0000, v101
    v_fma_f32 v70, v66, v197, -v64
    v_fma_f32 v71, v67, v197, -v64
    v_fmac_f32 v66, v70, v68
    v_fmac_f32 v67, v71, v69
    v_cvt_pk_bf16_f32 v133, v66, v67
    v_lshlrev_b32 v66, 16, v182
    v_and_b32 v67, 0xffff0000, v182
    v_lshlrev_b32 v68, 16, v102
    v_and_b32 v69, 0xffff0000, v102
    v_fma_f32 v70, v66, v199, -v65
    v_fma_f32 v71, v67, v199, -v65
    v_fmac_f32 v66, v70, v68
    v_fmac_f32 v67, v71, v69
    v_cvt_pk_bf16_f32 v134, v66, v67
    v_lshlrev_b32 v66, 16, v183
    v_and_b32 v67, 0xffff0000, v183
    v_lshlrev_b32 v68, 16, v103
    v_and_b32 v69, 0xffff0000, v103
    v_fma_f32 v70, v66, v199, -v65
    v_fma_f32 v71, v67, v199, -v65
    v_fmac_f32 v66, v70, v68
    v_fmac_f32 v67, v71, v69
    v_cvt_pk_bf16_f32 v135, v66, v67
    buffer_store_dwordx4 v[132:135], v12, s[8:11], s73 offen sc1
    s_add_u32 s72, s72, 163840
    s_add_u32 s73, s73, 163840
    buffer_store_dwordx4 v[104:107], v12, s[8:11], s72 offen sc1
    v_mul_f32 v64, v200, v201
    v_mul_f32 v65, v202, v203
    v_lshlrev_b32 v66, 16, v184
    v_and_b32 v67, 0xffff0000, v184
    v_lshlrev_b32 v68, 16, v104
    v_and_b32 v69, 0xffff0000, v104
    v_fma_f32 v70, v66, v201, -v64
    v_fma_f32 v71, v67, v201, -v64
    v_fmac_f32 v66, v70, v68
    v_fmac_f32 v67, v71, v69
    v_cvt_pk_bf16_f32 v136, v66, v67
    v_lshlrev_b32 v66, 16, v185
    v_and_b32 v67, 0xffff0000, v185
    v_lshlrev_b32 v68, 16, v105
    v_and_b32 v69, 0xffff0000, v105
    v_fma_f32 v70, v66, v201, -v64
    v_fma_f32 v71, v67, v201, -v64
    v_fmac_f32 v66, v70, v68
    v_fmac_f32 v67, v71, v69
    v_cvt_pk_bf16_f32 v137, v66, v67
    v_lshlrev_b32 v66, 16, v186
    v_and_b32 v67, 0xffff0000, v186
    v_lshlrev_b32 v68, 16, v106
    v_and_b32 v69, 0xffff0000, v106
    v_fma_f32 v70, v66, v203, -v65
    v_fma_f32 v71, v67, v203, -v65
    v_fmac_f32 v66, v70, v68
    v_fmac_f32 v67, v71, v69
    v_cvt_pk_bf16_f32 v138, v66, v67
    v_lshlrev_b32 v66, 16, v187
    v_and_b32 v67, 0xffff0000, v187
    v_lshlrev_b32 v68, 16, v107
    v_and_b32 v69, 0xffff0000, v107
    v_fma_f32 v70, v66, v203, -v65
    v_fma_f32 v71, v67, v203, -v65
    v_fmac_f32 v66, v70, v68
    v_fmac_f32 v67, v71, v69
    v_cvt_pk_bf16_f32 v139, v66, v67
    buffer_store_dwordx4 v[136:139], v12, s[8:11], s73 offen sc1
    s_add_u32 s72, s72, 163840
    s_add_u32 s73, s73, 163840
    buffer_store_dwordx4 v[108:111], v12, s[8:11], s72 offen sc1
    v_mul_f32 v64, v204, v205
    v_mul_f32 v65, v206, v207
    v_lshlrev_b32 v66, 16, v188
    v_and_b32 v67, 0xffff0000, v188
    v_lshlrev_b32 v68, 16, v108
    v_and_b32 v69, 0xffff0000, v108
    v_fma_f32 v70, v66, v205, -v64
    v_fma_f32 v71, v67, v205, -v64
    v_fmac_f32 v66, v70, v68
    v_fmac_f32 v67, v71, v69
    v_cvt_pk_bf16_f32 v140, v66, v67
    v_lshlrev_b32 v66, 16, v189
    v_and_b32 v67, 0xffff0000, v189
    v_lshlrev_b32 v68, 16, v109
    v_and_b32 v69, 0xffff0000, v109
    v_fma_f32 v70, v66, v205, -v64
    v_fma_f32 v71, v67, v205, -v64
    v_fmac_f32 v66, v70, v68
    v_fmac_f32 v67, v71, v69
    v_cvt_pk_bf16_f32 v141, v66, v67
    v_lshlrev_b32 v66, 16, v190
    v_and_b32 v67, 0xffff0000, v190
    v_lshlrev_b32 v68, 16, v110
    v_and_b32 v69, 0xffff0000, v110
    v_fma_f32 v70, v66, v207, -v65
    v_fma_f32 v71, v67, v207, -v65
    v_fmac_f32 v66, v70, v68
    v_fmac_f32 v67, v71, v69
    v_cvt_pk_bf16_f32 v142, v66, v67
    v_lshlrev_b32 v66, 16, v191
    v_and_b32 v67, 0xffff0000, v191
    v_lshlrev_b32 v68, 16, v111
    v_and_b32 v69, 0xffff0000, v111
    v_fma_f32 v70, v66, v207, -v65
    v_fma_f32 v71, v67, v207, -v65
    v_fmac_f32 v66, v70, v68
    v_fmac_f32 v67, v71, v69
    v_cvt_pk_bf16_f32 v143, v66, v67
    buffer_store_dwordx4 v[140:143], v12, s[8:11], s73 offen sc1
    s_add_u32 s72, s72, 163840
    s_add_u32 s73, s73, 163840
    s_waitcnt vmcnt(0)
    s_barrier
    s_cmp_lg_u32 s60, 0
    s_cbranch_scc1 L_arr_15
    s_mov_b64 s[98:99], exec
    s_mov_b64 exec, 0xffff
    v_lshlrev_b32 v4, 7, v1
    v_add_u32 v4, 14336, v4
    v_mov_b32 v5, 1
    buffer_atomic_add v5, v4, s[8:11], 0 offen
    s_mov_b64 exec, s[98:99]
L_arr_15:
    s_cmp_lg_u32 s60, 0
    s_cbranch_scc1 L_w0o_16
L_pe_17:
    v_cmp_gt_u32 vcc, 30, v216
    s_nop 1
    s_cbranch_vccz L_pok_18
    s_cmp_eq_u32 s97, 0
    s_cbranch_scc1 L_pok_18
    s_sub_u32 s97, s97, 1
    s_sleep 2
    buffer_load_dword v216, v217, s[8:11], 0 offen sc1
    s_waitcnt vmcnt(0)
    s_branch L_pe_17
L_pok_18:
L_w0o_16:
    s_barrier
    s_cmp_eq_u32 s60, 0
    s_cbranch_scc1 L_dma_19
    s_sub_u32 s63, s60, 1
    s_mul_i32 s63, s63, 48128
    s_mul_i32 s62, s77, 143360
    s_add_u32 s62, s62, s63
    s_add_u32 s62, s62, 11657216
    s_mov_b32 m0, s63
    s_nop 0
    buffer_load_dwordx4 v2, s[8:11], s62 offen offset:0 sc1 lds
    buffer_load_dwordx4 v2, s[8:11], s62 offen offset:1024 sc1 lds
    buffer_load_dwordx4 v2, s[8:11], s62 offen offset:2048 sc1 lds
    buffer_load_dwordx4 v2, s[8:11], s62 offen offset:3072 sc1 lds
    s_add_u32 s62, s62, 4096
    s_add_u32 s63, s63, 4096
    s_mov_b32 m0, s63
    s_nop 0
    buffer_load_dwordx4 v2, s[8:11], s62 offen offset:0 sc1 lds
    buffer_load_dwordx4 v2, s[8:11], s62 offen offset:1024 sc1 lds
    buffer_load_dwordx4 v2, s[8:11], s62 offen offset:2048 sc1 lds
    buffer_load_dwordx4 v2, s[8:11], s62 offen offset:3072 sc1 lds
    s_add_u32 s62, s62, 4096
    s_add_u32 s63, s63, 4096
    s_mov_b32 m0, s63
    s_nop 0
    buffer_load_dwordx4 v2, s[8:11], s62 offen offset:0 sc1 lds
    buffer_load_dwordx4 v2, s[8:11], s62 offen offset:1024 sc1 lds
    buffer_load_dwordx4 v2, s[8:11], s62 offen offset:2048 sc1 lds
    buffer_load_dwordx4 v2, s[8:11], s62 offen offset:3072 sc1 lds
    s_add_u32 s62, s62, 4096
    s_add_u32 s63, s63, 4096
    s_mov_b32 m0, s63
    s_nop 0
    buffer_load_dwordx4 v2, s[8:11], s62 offen offset:0 sc1 lds
    buffer_load_dwordx4 v2, s[8:11], s62 offen offset:1024 sc1 lds
    buffer_load_dwordx4 v2, s[8:11], s62 offen offset:2048 sc1 lds
    buffer_load_dwordx4 v2, s[8:11], s62 offen offset:3072 sc1 lds
    s_add_u32 s62, s62, 4096
    s_add_u32 s63, s63, 4096
    s_mov_b32 m0, s63
    s_nop 0
    buffer_load_dwordx4 v2, s[8:11], s62 offen offset:0 sc1 lds
    buffer_load_dwordx4 v2, s[8:11], s62 offen offset:1024 sc1 lds
    buffer_load_dwordx4 v2, s[8:11], s62 offen offset:2048 sc1 lds
    buffer_load_dwordx4 v2, s[8:11], s62 offen offset:3072 sc1 lds
    s_add_u32 s62, s62, 4096
    s_add_u32 s63, s63, 4096
    s_mov_b32 m0, s63
    s_nop 0
    buffer_load_dwordx4 v2, s[8:11], s62 offen offset:0 sc1 lds
    buffer_load_dwordx4 v2, s[8:11], s62 offen offset:1024 sc1 lds
    buffer_load_dwordx4 v2, s[8:11], s62 offen offset:2048 sc1 lds
    buffer_load_dwordx4 v2, s[8:11], s62 offen offset:3072 sc1 lds
    s_add_u32 s62, s62, 4096
    s_add_u32 s63, s63, 4096
    s_mov_b32 m0, s63
    s_nop 0
    buffer_load_dwordx4 v2, s[8:11], s62 offen offset:0 sc1 lds
    buffer_load_dwordx4 v2, s[8:11], s62 offen offset:1024 sc1 lds
    buffer_load_dwordx4 v2, s[8:11], s62 offen offset:2048 sc1 lds
    buffer_load_dwordx4 v2, s[8:11], s62 offen offset:3072 sc1 lds
    s_add_u32 s62, s62, 4096
    s_add_u32 s63, s63, 4096
    s_mov_b32 m0, s63
    s_nop 0
    buffer_load_dwordx4 v2, s[8:11], s62 offen offset:0 sc1 lds
    buffer_load_dwordx4 v2, s[8:11], s62 offen offset:1024 sc1 lds
    buffer_load_dwordx4 v2, s[8:11], s62 offen offset:2048 sc1 lds
    buffer_load_dwordx4 v2, s[8:11], s62 offen offset:3072 sc1 lds
    s_add_u32 s62, s62, 4096
    s_add_u32 s63, s63, 4096
    s_mov_b32 m0, s63
    s_nop 0
    buffer_load_dwordx4 v2, s[8:11], s62 offen offset:0 sc1 lds
    buffer_load_dwordx4 v2, s[8:11], s62 offen offset:1024 sc1 lds
    buffer_load_dwordx4 v2, s[8:11], s62 offen offset:2048 sc1 lds
    buffer_load_dwordx4 v2, s[8:11], s62 offen offset:3072 sc1 lds
    s_add_u32 s62, s62, 4096
    s_add_u32 s63, s63, 4096
    s_mov_b32 m0, s63
    s_nop 0
    buffer_load_dwordx4 v2, s[8:11], s62 offen offset:0 sc1 lds
    buffer_load_dwordx4 v2, s[8:11], s62 offen offset:1024 sc1 lds
    buffer_load_dwordx4 v2, s[8:11], s62 offen offset:2048 sc1 lds
    buffer_load_dwordx4 v2, s[8:11], s62 offen offset:3072 sc1 lds
    s_add_u32 s62, s62, 4096
    s_add_u32 s63, s63, 4096
    s_mov_b32 m0, s63
    s_nop 0
    buffer_load_dwordx4 v2, s[8:11], s62 offen offset:0 sc1 lds
    buffer_load_dwordx4 v2, s[8:11], s62 offen offset:1024 sc1 lds
    buffer_load_dwordx4 v2, s[8:11], s62 offen offset:2048 sc1 lds
    buffer_load_dwordx4 v2, s[8:11], s62 offen offset:3072 sc1 lds
    s_add_u32 s62, s62, 4096
    s_add_u32 s63, s63, 4096
    s_mov_b32 m0, s63
    s_nop 0
    buffer_load_dwordx4 v2, s[8:11], s62 offen offset:0 sc1 lds
    buffer_load_dwordx4 v2, s[8:11], s62 offen offset:1024 sc1 lds
    buffer_load_dwordx4 v2, s[8:11], s62 offen offset:2048 sc1 lds
L_dma_19:
    s_mov_b32 s96, 0
    s_branch L_ffn
L_roleB:
    s_waitcnt lgkmcnt(0)
    s_mov_b32 s8, s58
    s_mov_b32 s9, s59
    s_mov_b32 s10, 268435456
    s_mov_b32 s11, 0x20000
    s_mov_b32 s28, s56
    s_mov_b32 s29, s57
    s_mov_b32 s30, 256
    s_mov_b32 s31, 0x20000
    s_cmp_ge_u32 s61, 224
    s_cbranch_scc0 L_qrole
    s_sub_u32 s67, s61, 224
    s_cmp_lg_u32 s61, 255
    s_cbranch_scc1 L_nz_20
    v_mov_b32 v8, 0
    v_mov_b32 v9, 0
    v_mov_b32 v10, 0
    v_mov_b32 v11, 0
    s_lshl_b32 s62, s60, 13
    buffer_store_dwordx4 v[8:11], v2, s[8:11], s62 offen offset:0 sc1
    buffer_store_dwordx4 v[8:11], v2, s[8:11], s62 offen offset:1024 sc1
    buffer_store_dwordx4 v[8:11], v2, s[8:11], s62 offen offset:2048 sc1
    buffer_store_dwordx4 v[8:11], v2, s[8:11], s62 offen offset:3072 sc1
    s_add_u32 s62, s62, 4096
    buffer_store_dwordx4 v[8:11], v2, s[8:11], s62 offen offset:0 sc1
    buffer_store_dwordx4 v[8:11], v2, s[8:11], s62 offen offset:1024 sc1
    buffer_store_dwordx4 v[8:11], v2, s[8:11], s62 offen offset:2048 sc1
    buffer_store_dwordx4 v[8:11], v2, s[8:11], s62 offen offset:3072 sc1
    s_waitcnt vmcnt(0)
    s_barrier
    s_cmp_lg_u32 s60, 0
    s_cbranch_scc1 L_arr_21
    s_mov_b64 s[98:99], exec
    s_mov_b64 exec, 1
    v_mov_b32 v8, 0
    v_mov_b32 v9, 1
    buffer_atomic_add v9, v8, s[28:31], 0 offen
    s_mov_b64 exec, s[98:99]
L_arr_21:
L_nz_20:
    s_getpc_b64 s[62:63]
L_pc_22:
    s_sub_u32 s62, s62, L_pc_22-interleave_layers__ssm_conv_h3__dense_activation_relu__prompt_kernel
    s_subb_u32 s63, s63, 0
    s_mov_b32 s12, s62
    s_mov_b32 s13, s63
    s_mov_b32 s14, L_code_end-interleave_layers__ssm_conv_h3__dense_activation_relu__prompt_kernel
    s_mov_b32 s15, 0x20000
    v_lshlrev_b32 v6, 7, v0
    buffer_load_dword v254, v6, s[12:15], 0 offen
    s_mov_b32 s62, 32768
    buffer_load_dword v255, v6, s[12:15], s62 offen
    s_cmp_ge_u32 s67, 30
    s_cbranch_scc1 L_bdone
    s_mov_b32 s12, s50
    s_mov_b32 s13, s51
    s_mov_b32 s14, 2211840
    s_mov_b32 s15, 0x20000
    s_mul_i32 s62, s67, 21846
    s_lshr_b32 s62, s62, 16
    s_mul_i32 s63, s62, 3
    s_sub_u32 s63, s67, s63
    s_mul_i32 s64, s62, 221184
    s_mul_i32 s65, s63, 1152
    s_add_u32 s64, s64, s65
    s_mov_b32 s65, 0x38E38E4
    v_add_u32 v6, 0, v0
    v_mul_hi_u32 v7, v6, s65
    v_mul_u32_u24 v8, 72, v7
    v_sub_u32 v8, v6, v8
    v_mul_u32_u24 v9, 3456, v7
    v_lshl_add_u32 v9, v8, 4, v9
    v_add_u32 v7, v7, v6
    v_lshlrev_b32 v96, 4, v7
    buffer_load_dwordx4 v[16:19], v9, s[12:15], s64 offen
    v_add_u32 v6, 256, v0
    v_mul_hi_u32 v7, v6, s65
    v_mul_u32_u24 v8, 72, v7
    v_sub_u32 v8, v6, v8
    v_mul_u32_u24 v9, 3456, v7
    v_lshl_add_u32 v9, v8, 4, v9
    v_add_u32 v7, v7, v6
    v_lshlrev_b32 v97, 4, v7
    buffer_load_dwordx4 v[20:23], v9, s[12:15], s64 offen
    v_add_u32 v6, 512, v0
    v_mul_hi_u32 v7, v6, s65
    v_mul_u32_u24 v8, 72, v7
    v_sub_u32 v8, v6, v8
    v_mul_u32_u24 v9, 3456, v7
    v_lshl_add_u32 v9, v8, 4, v9
    v_add_u32 v7, v7, v6
    v_lshlrev_b32 v98, 4, v7
    buffer_load_dwordx4 v[24:27], v9, s[12:15], s64 offen
    v_add_u32 v6, 768, v0
    v_mul_hi_u32 v7, v6, s65
    v_mul_u32_u24 v8, 72, v7
    v_sub_u32 v8, v6, v8
    v_mul_u32_u24 v9, 3456, v7
    v_lshl_add_u32 v9, v8, 4, v9
    v_add_u32 v7, v7, v6
    v_lshlrev_b32 v99, 4, v7
    buffer_load_dwordx4 v[28:31], v9, s[12:15], s64 offen
    v_add_u32 v6, 1024, v0
    v_mul_hi_u32 v7, v6, s65
    v_mul_u32_u24 v8, 72, v7
    v_sub_u32 v8, v6, v8
    v_mul_u32_u24 v9, 3456, v7
    v_lshl_add_u32 v9, v8, 4, v9
    v_add_u32 v7, v7, v6
    v_lshlrev_b32 v100, 4, v7
    buffer_load_dwordx4 v[32:35], v9, s[12:15], s64 offen
    v_add_u32 v6, 1280, v0
    v_mul_hi_u32 v7, v6, s65
    v_mul_u32_u24 v8, 72, v7
    v_sub_u32 v8, v6, v8
    v_mul_u32_u24 v9, 3456, v7
    v_lshl_add_u32 v9, v8, 4, v9
    v_add_u32 v7, v7, v6
    v_lshlrev_b32 v101, 4, v7
    buffer_load_dwordx4 v[36:39], v9, s[12:15], s64 offen
    v_add_u32 v6, 1536, v0
    v_mul_hi_u32 v7, v6, s65
    v_mul_u32_u24 v8, 72, v7
    v_sub_u32 v8, v6, v8
    v_mul_u32_u24 v9, 3456, v7
    v_lshl_add_u32 v9, v8, 4, v9
    v_add_u32 v7, v7, v6
    v_lshlrev_b32 v102, 4, v7
    buffer_load_dwordx4 v[40:43], v9, s[12:15], s64 offen
    v_add_u32 v6, 1792, v0
    v_mul_hi_u32 v7, v6, s65
    v_mul_u32_u24 v8, 72, v7
    v_sub_u32 v8, v6, v8
    v_mul_u32_u24 v9, 3456, v7
    v_lshl_add_u32 v9, v8, 4, v9
    v_add_u32 v7, v7, v6
    v_lshlrev_b32 v103, 4, v7
    buffer_load_dwordx4 v[44:47], v9, s[12:15], s64 offen
    v_add_u32 v6, 2048, v0
    v_mul_hi_u32 v7, v6, s65
    v_mul_u32_u24 v8, 72, v7
    v_sub_u32 v8, v6, v8
    v_mul_u32_u24 v9, 3456, v7
    v_lshl_add_u32 v9, v8, 4, v9
    v_add_u32 v7, v7, v6
    v_lshlrev_b32 v104, 4, v7
    buffer_load_dwordx4 v[48:51], v9, s[12:15], s64 offen
    v_add_u32 v6, 2304, v0
    v_mul_hi_u32 v7, v6, s65
    v_mul_u32_u24 v8, 72, v7
    v_sub_u32 v8, v6, v8
    v_mul_u32_u24 v9, 3456, v7
    v_lshl_add_u32 v9, v8, 4, v9
    v_add_u32 v7, v7, v6
    v_lshlrev_b32 v105, 4, v7
    buffer_load_dwordx4 v[52:55], v9, s[12:15], s64 offen
    v_add_u32 v6, 2560, v0
    v_mul_hi_u32 v7, v6, s65
    v_mul_u32_u24 v8, 72, v7
    v_sub_u32 v8, v6, v8
    v_mul_u32_u24 v9, 3456, v7
    v_lshl_add_u32 v9, v8, 4, v9
    v_add_u32 v7, v7, v6
    v_lshlrev_b32 v106, 4, v7
    buffer_load_dwordx4 v[56:59], v9, s[12:15], s64 offen
    v_add_u32 v6, 2816, v0
    v_mul_hi_u32 v7, v6, s65
    v_mul_u32_u24 v8, 72, v7
    v_sub_u32 v8, v6, v8
    v_mul_u32_u24 v9, 3456, v7
    v_lshl_add_u32 v9, v8, 4, v9
    v_add_u32 v7, v7, v6
    v_lshlrev_b32 v107, 4, v7
    buffer_load_dwordx4 v[60:63], v9, s[12:15], s64 offen
    v_add_u32 v6, 3072, v0
    v_mul_hi_u32 v7, v6, s65
    v_mul_u32_u24 v8, 72, v7
    v_sub_u32 v8, v6, v8
    v_mul_u32_u24 v9, 3456, v7
    v_lshl_add_u32 v9, v8, 4, v9
    v_add_u32 v7, v7, v6
    v_lshlrev_b32 v108, 4, v7
    buffer_load_dwordx4 v[64:67], v9, s[12:15], s64 offen
    v_add_u32 v6, 3328, v0
    v_mul_hi_u32 v7, v6, s65
    v_mul_u32_u24 v8, 72, v7
    v_sub_u32 v8, v6, v8
    v_mul_u32_u24 v9, 3456, v7
    v_lshl_add_u32 v9, v8, 4, v9
    v_add_u32 v7, v7, v6
    v_lshlrev_b32 v109, 4, v7
    buffer_load_dwordx4 v[68:71], v9, s[12:15], s64 offen
    v_add_u32 v6, 3584, v0
    v_mul_hi_u32 v7, v6, s65
    v_mul_u32_u24 v8, 72, v7
    v_sub_u32 v8, v6, v8
    v_mul_u32_u24 v9, 3456, v7
    v_lshl_add_u32 v9, v8, 4, v9
    v_add_u32 v7, v7, v6
    v_lshlrev_b32 v110, 4, v7
    buffer_load_dwordx4 v[72:75], v9, s[12:15], s64 offen
    v_add_u32 v6, 3840, v0
    v_mul_hi_u32 v7, v6, s65
    v_mul_u32_u24 v8, 72, v7
    v_sub_u32 v8, v6, v8
    v_mul_u32_u24 v9, 3456, v7
    v_lshl_add_u32 v9, v8, 4, v9
    v_add_u32 v7, v7, v6
    v_lshlrev_b32 v111, 4, v7
    buffer_load_dwordx4 v[76:79], v9, s[12:15], s64 offen
    v_add_u32 v6, 4096, v0
    v_mul_hi_u32 v7, v6, s65
    v_mul_u32_u24 v8, 72, v7
    v_sub_u32 v8, v6, v8
    v_mul_u32_u24 v9, 3456, v7
    v_lshl_add_u32 v9, v8, 4, v9
    v_add_u32 v7, v7, v6
    v_lshlrev_b32 v112, 4, v7
    buffer_load_dwordx4 v[80:83], v9, s[12:15], s64 offen
    v_add_u32 v6, 4352, v0
    v_mul_hi_u32 v7, v6, s65
    v_mul_u32_u24 v8, 72, v7
    v_sub_u32 v8, v6, v8
    v_mul_u32_u24 v9, 3456, v7
    v_lshl_add_u32 v9, v8, 4, v9
    v_add_u32 v7, v7, v6
    v_lshlrev_b32 v113, 4, v7
    buffer_load_dwordx4 v[84:87], v9, s[12:15], s64 offen
    s_waitcnt vmcnt(17)
    ds_write_b128 v96, v[16:19]
    s_waitcnt vmcnt(16)
    ds_write_b128 v97, v[20:23]
    s_waitcnt vmcnt(15)
    ds_write_b128 v98, v[24:27]
    s_waitcnt vmcnt(14)
    ds_write_b128 v99, v[28:31]
    s_waitcnt vmcnt(13)
    ds_write_b128 v100, v[32:35]
    s_waitcnt vmcnt(12)
    ds_write_b128 v101, v[36:39]
    s_waitcnt vmcnt(11)
    ds_write_b128 v102, v[40:43]
    s_waitcnt vmcnt(10)
    ds_write_b128 v103, v[44:47]
    s_waitcnt vmcnt(9)
    ds_write_b128 v104, v[48:51]
    s_waitcnt vmcnt(8)
    ds_write_b128 v105, v[52:55]
    s_waitcnt vmcnt(7)
    ds_write_b128 v106, v[56:59]
    s_waitcnt vmcnt(6)
    ds_write_b128 v107, v[60:63]
    s_waitcnt vmcnt(5)
    ds_write_b128 v108, v[64:67]
    s_waitcnt vmcnt(4)
    ds_write_b128 v109, v[68:71]
    s_waitcnt vmcnt(3)
    ds_write_b128 v110, v[72:75]
    s_waitcnt vmcnt(2)
    ds_write_b128 v111, v[76:79]
    s_waitcnt vmcnt(1)
    ds_write_b128 v112, v[80:83]
    s_waitcnt vmcnt(0)
    ds_write_b128 v113, v[84:87]
    s_waitcnt lgkmcnt(0)
    s_barrier
    v_lshrrev_b32 v6, 4, v1
    v_lshlrev_b32 v6, 2, v6
    v_bfe_u32 v7, v1, 2, 2
    v_add_u32 v6, v6, v7
    v_mul_u32_u24 v6, 1168, v6
    v_and_b32 v7, 3, v1
    v_lshl_add_u32 v6, v7, 3, v6
    s_mul_i32 s64, s60, 9
    s_lshl_b32 s65, s64, 5
    v_add_u32 v6, s65, v6
    v_add_u32 v7, 37376, v6
    s_mul_i32 s65, s63, 36
    s_add_u32 s64, s64, s65
    s_lshl_b32 s62, s62, 1
    ds_read_b64_tr_b16 v[16:17], v6 offset:0
    ds_read_b64_tr_b16 v[18:19], v6 offset:18688
    ds_read_b64_tr_b16 v[20:21], v6 offset:32
    ds_read_b64_tr_b16 v[22:23], v6 offset:18720
    ds_read_b64_tr_b16 v[24:25], v6 offset:64
    ds_read_b64_tr_b16 v[26:27], v6 offset:18752
    ds_read_b64_tr_b16 v[28:29], v6 offset:96
    ds_read_b64_tr_b16 v[30:31], v6 offset:18784
    ds_read_b64_tr_b16 v[32:33], v6 offset:128
    ds_read_b64_tr_b16 v[34:35], v6 offset:18816
    ds_read_b64_tr_b16 v[36:37], v6 offset:160
    ds_read_b64_tr_b16 v[38:39], v6 offset:18848
    ds_read_b64_tr_b16 v[40:41], v6 offset:192
    ds_read_b64_tr_b16 v[42:43], v6 offset:18880
    ds_read_b64_tr_b16 v[44:45], v6 offset:224
    ds_read_b64_tr_b16 v[46:47], v6 offset:18912
    ds_read_b64_tr_b16 v[48:49], v6 offset:256
    ds_read_b64_tr_b16 v[50:51], v6 offset:18944
    ds_read_b64_tr_b16 v[52:53], v7 offset:0
    ds_read_b64_tr_b16 v[54:55], v7 offset:18688
    ds_read_b64_tr_b16 v[56:57], v7 offset:32
    ds_read_b64_tr_b16 v[58:59], v7 offset:18720
    ds_read_b64_tr_b16 v[60:61], v7 offset:64
    ds_read_b64_tr_b16 v[62:63], v7 offset:18752
    ds_read_b64_tr_b16 v[64:65], v7 offset:96
    ds_read_b64_tr_b16 v[66:67], v7 offset:18784
    ds_read_b64_tr_b16 v[68:69], v7 offset:128
    ds_read_b64_tr_b16 v[70:71], v7 offset:18816
    ds_read_b64_tr_b16 v[72:73], v7 offset:160
    ds_read_b64_tr_b16 v[74:75], v7 offset:18848
    ds_read_b64_tr_b16 v[76:77], v7 offset:192
    ds_read_b64_tr_b16 v[78:79], v7 offset:18880
    ds_read_b64_tr_b16 v[80:81], v7 offset:224
    ds_read_b64_tr_b16 v[82:83], v7 offset:18912
    ds_read_b64_tr_b16 v[84:85], v7 offset:256
    ds_read_b64_tr_b16 v[86:87], v7 offset:18944
    s_waitcnt lgkmcnt(0)
    s_mul_i32 s65, s64, 9363
    s_lshr_b32 s65, s65, 16
    s_mul_i32 s66, s65, 7
    s_sub_u32 s66, s64, s66
    s_mul_i32 s65, s65, 20
    s_add_u32 s65, s65, s62
    s_mul_i32 s65, s65, 7
    s_add_u32 s65, s65, s66
    s_lshl_b32 s65, s65, 10
    s_add_u32 s65, s65, 11657216
    buffer_store_dwordx4 v[16:19], v2, s[8:11], s65 offen sc1
    s_add_u32 s65, s65, 7168
    buffer_store_dwordx4 v[52:55], v2, s[8:11], s65 offen sc1
    s_add_u32 s64, s64, 1
    s_mul_i32 s65, s64, 9363
    s_lshr_b32 s65, s65, 16
    s_mul_i32 s66, s65, 7
    s_sub_u32 s66, s64, s66
    s_mul_i32 s65, s65, 20
    s_add_u32 s65, s65, s62
    s_mul_i32 s65, s65, 7
    s_add_u32 s65, s65, s66
    s_lshl_b32 s65, s65, 10
    s_add_u32 s65, s65, 11657216
    buffer_store_dwordx4 v[20:23], v2, s[8:11], s65 offen sc1
    s_add_u32 s65, s65, 7168
    buffer_store_dwordx4 v[56:59], v2, s[8:11], s65 offen sc1
    s_add_u32 s64, s64, 1
    s_mul_i32 s65, s64, 9363
    s_lshr_b32 s65, s65, 16
    s_mul_i32 s66, s65, 7
    s_sub_u32 s66, s64, s66
    s_mul_i32 s65, s65, 20
    s_add_u32 s65, s65, s62
    s_mul_i32 s65, s65, 7
    s_add_u32 s65, s65, s66
    s_lshl_b32 s65, s65, 10
    s_add_u32 s65, s65, 11657216
    buffer_store_dwordx4 v[24:27], v2, s[8:11], s65 offen sc1
    s_add_u32 s65, s65, 7168
    buffer_store_dwordx4 v[60:63], v2, s[8:11], s65 offen sc1
    s_add_u32 s64, s64, 1
    s_mul_i32 s65, s64, 9363
    s_lshr_b32 s65, s65, 16
    s_mul_i32 s66, s65, 7
    s_sub_u32 s66, s64, s66
    s_mul_i32 s65, s65, 20
    s_add_u32 s65, s65, s62
    s_mul_i32 s65, s65, 7
    s_add_u32 s65, s65, s66
    s_lshl_b32 s65, s65, 10
    s_add_u32 s65, s65, 11657216
    buffer_store_dwordx4 v[28:31], v2, s[8:11], s65 offen sc1
    s_add_u32 s65, s65, 7168
    buffer_store_dwordx4 v[64:67], v2, s[8:11], s65 offen sc1
    s_add_u32 s64, s64, 1
    s_mul_i32 s65, s64, 9363
    s_lshr_b32 s65, s65, 16
    s_mul_i32 s66, s65, 7
    s_sub_u32 s66, s64, s66
    s_mul_i32 s65, s65, 20
    s_add_u32 s65, s65, s62
    s_mul_i32 s65, s65, 7
    s_add_u32 s65, s65, s66
    s_lshl_b32 s65, s65, 10
    s_add_u32 s65, s65, 11657216
    buffer_store_dwordx4 v[32:35], v2, s[8:11], s65 offen sc1
    s_add_u32 s65, s65, 7168
    buffer_store_dwordx4 v[68:71], v2, s[8:11], s65 offen sc1
    s_add_u32 s64, s64, 1
    s_mul_i32 s65, s64, 9363
    s_lshr_b32 s65, s65, 16
    s_mul_i32 s66, s65, 7
    s_sub_u32 s66, s64, s66
    s_mul_i32 s65, s65, 20
    s_add_u32 s65, s65, s62
    s_mul_i32 s65, s65, 7
    s_add_u32 s65, s65, s66
    s_lshl_b32 s65, s65, 10
    s_add_u32 s65, s65, 11657216
    buffer_store_dwordx4 v[36:39], v2, s[8:11], s65 offen sc1
    s_add_u32 s65, s65, 7168
    buffer_store_dwordx4 v[72:75], v2, s[8:11], s65 offen sc1
    s_add_u32 s64, s64, 1
    s_mul_i32 s65, s64, 9363
    s_lshr_b32 s65, s65, 16
    s_mul_i32 s66, s65, 7
    s_sub_u32 s66, s64, s66
    s_mul_i32 s65, s65, 20
    s_add_u32 s65, s65, s62
    s_mul_i32 s65, s65, 7
    s_add_u32 s65, s65, s66
    s_lshl_b32 s65, s65, 10
    s_add_u32 s65, s65, 11657216
    buffer_store_dwordx4 v[40:43], v2, s[8:11], s65 offen sc1
    s_add_u32 s65, s65, 7168
    buffer_store_dwordx4 v[76:79], v2, s[8:11], s65 offen sc1
    s_add_u32 s64, s64, 1
    s_mul_i32 s65, s64, 9363
    s_lshr_b32 s65, s65, 16
    s_mul_i32 s66, s65, 7
    s_sub_u32 s66, s64, s66
    s_mul_i32 s65, s65, 20
    s_add_u32 s65, s65, s62
    s_mul_i32 s65, s65, 7
    s_add_u32 s65, s65, s66
    s_lshl_b32 s65, s65, 10
    s_add_u32 s65, s65, 11657216
    buffer_store_dwordx4 v[44:47], v2, s[8:11], s65 offen sc1
    s_add_u32 s65, s65, 7168
    buffer_store_dwordx4 v[80:83], v2, s[8:11], s65 offen sc1
    s_add_u32 s64, s64, 1
    s_mul_i32 s65, s64, 9363
    s_lshr_b32 s65, s65, 16
    s_mul_i32 s66, s65, 7
    s_sub_u32 s66, s64, s66
    s_mul_i32 s65, s65, 20
    s_add_u32 s65, s65, s62
    s_mul_i32 s65, s65, 7
    s_add_u32 s65, s65, s66
    s_lshl_b32 s65, s65, 10
    s_add_u32 s65, s65, 11657216
    buffer_store_dwordx4 v[48:51], v2, s[8:11], s65 offen sc1
    s_add_u32 s65, s65, 7168
    buffer_store_dwordx4 v[84:87], v2, s[8:11], s65 offen sc1
    s_add_u32 s64, s64, 1
    s_waitcnt vmcnt(0)
    s_barrier
    s_cmp_lg_u32 s60, 0
    s_cbranch_scc1 L_arr_23
    v_mov_b32 v4, 0
    buffer_load_dword v5, v4, s[28:31], 0 offen sc1
    s_waitcnt vmcnt(0)
L_pe_24:
    v_cmp_gt_u32 vcc, 1, v5
    s_nop 1
    s_cbranch_vccz L_pok_25
    s_cmp_eq_u32 s97, 0
    s_cbranch_scc1 L_pok_25
    s_sub_u32 s97, s97, 1
    s_sleep 2
    buffer_load_dword v5, v4, s[28:31], 0 offen sc1
    s_waitcnt vmcnt(0)
    s_branch L_pe_24
L_pok_25:
    s_mov_b64 s[98:99], exec
    s_mov_b64 exec, 0xffff
    v_lshlrev_b32 v4, 7, v1
    v_add_u32 v4, 10240, v4
    v_mov_b32 v5, 1
    buffer_atomic_add v5, v4, s[8:11], 0 offen
    s_mov_b64 exec, s[98:99]
L_arr_23:
    s_cmp_ge_u32 s67, 27
    s_cbranch_scc1 L_bdone
    s_mov_b32 s12, s50
    s_mov_b32 s13, s51
    s_mov_b32 s14, 2211840
    s_mov_b32 s15, 0x20000
    v_lshrrev_b32 v6, 3, v0
    v_and_b32 v7, 7, v0
    v_mul_u32_u24 v8, 3456, v6
    v_lshl_add_u32 v8, v7, 4, v8
    s_lshl_b32 s63, s67, 7
    v_mul_u32_u24 v9, 144, v6
    v_lshl_add_u32 v9, v7, 4, v9
    buffer_load_dwordx4 v[16:19], v8, s[12:15], s63 offen
    s_add_u32 s63, s63, 110592
    buffer_load_dwordx4 v[20:23], v8, s[12:15], s63 offen
    s_add_u32 s63, s63, 110592
    buffer_load_dwordx4 v[24:27], v8, s[12:15], s63 offen
    s_add_u32 s63, s63, 110592
    buffer_load_dwordx4 v[28:31], v8, s[12:15], s63 offen
    s_add_u32 s63, s63, 110592
    buffer_load_dwordx4 v[32:35], v8, s[12:15], s63 offen
    s_add_u32 s63, s63, 110592
    buffer_load_dwordx4 v[36:39], v8, s[12:15], s63 offen
    s_add_u32 s63, s63, 110592
    buffer_load_dwordx4 v[40:43], v8, s[12:15], s63 offen
    s_add_u32 s63, s63, 110592
    buffer_load_dwordx4 v[44:47], v8, s[12:15], s63 offen
    s_add_u32 s63, s63, 110592
    buffer_load_dwordx4 v[48:51], v8, s[12:15], s63 offen
    s_add_u32 s63, s63, 110592
    buffer_load_dwordx4 v[52:55], v8, s[12:15], s63 offen
    s_add_u32 s63, s63, 110592
    buffer_load_dwordx4 v[56:59], v8, s[12:15], s63 offen
    s_add_u32 s63, s63, 110592
    buffer_load_dwordx4 v[60:63], v8, s[12:15], s63 offen
    s_add_u32 s63, s63, 110592
    buffer_load_dwordx4 v[64:67], v8, s[12:15], s63 offen
    s_add_u32 s63, s63, 110592
    buffer_load_dwordx4 v[68:71], v8, s[12:15], s63 offen
    s_add_u32 s63, s63, 110592
    buffer_load_dwordx4 v[72:75], v8, s[12:15], s63 offen
    s_add_u32 s63, s63, 110592
    buffer_load_dwordx4 v[76:79], v8, s[12:15], s63 offen
    s_add_u32 s63, s63, 110592
    buffer_load_dwordx4 v[80:83], v8, s[12:15], s63 offen
    s_add_u32 s63, s63, 110592
    buffer_load_dwordx4 v[84:87], v8, s[12:15], s63 offen
    s_add_u32 s63, s63, 110592
    buffer_load_dwordx4 v[88:91], v8, s[12:15], s63 offen
    s_add_u32 s63, s63, 110592
    buffer_load_dwordx4 v[92:95], v8, s[12:15], s63 offen
    s_add_u32 s63, s63, 110592
    s_barrier
    s_waitcnt vmcnt(19)
    ds_write_b128 v9, v[16:19]
    v_add_u32 v9, 4608, v9
    s_waitcnt vmcnt(18)
    ds_write_b128 v9, v[20:23]
    v_add_u32 v9, 4608, v9
    s_waitcnt vmcnt(17)
    ds_write_b128 v9, v[24:27]
    v_add_u32 v9, 4608, v9
    s_waitcnt vmcnt(16)
    ds_write_b128 v9, v[28:31]
    v_add_u32 v9, 4608, v9
    s_waitcnt vmcnt(15)
    ds_write_b128 v9, v[32:35]
    v_add_u32 v9, 4608, v9
    s_waitcnt vmcnt(14)
    ds_write_b128 v9, v[36:39]
    v_add_u32 v9, 4608, v9
    s_waitcnt vmcnt(13)
    ds_write_b128 v9, v[40:43]
    v_add_u32 v9, 4608, v9
    s_waitcnt vmcnt(12)
    ds_write_b128 v9, v[44:47]
    v_add_u32 v9, 4608, v9
    s_waitcnt vmcnt(11)
    ds_write_b128 v9, v[48:51]
    v_add_u32 v9, 4608, v9
    s_waitcnt vmcnt(10)
    ds_write_b128 v9, v[52:55]
    v_add_u32 v9, 4608, v9
    s_waitcnt vmcnt(9)
    ds_write_b128 v9, v[56:59]
    v_add_u32 v9, 4608, v9
    s_waitcnt vmcnt(8)
    ds_write_b128 v9, v[60:63]
    v_add_u32 v9, 4608, v9
    s_waitcnt vmcnt(7)
    ds_write_b128 v9, v[64:67]
    v_add_u32 v9, 4608, v9
    s_waitcnt vmcnt(6)
    ds_write_b128 v9, v[68:71]
    v_add_u32 v9, 4608, v9
    s_waitcnt vmcnt(5)
    ds_write_b128 v9, v[72:75]
    v_add_u32 v9, 4608, v9
    s_waitcnt vmcnt(4)
    ds_write_b128 v9, v[76:79]
    v_add_u32 v9, 4608, v9
    s_waitcnt vmcnt(3)
    ds_write_b128 v9, v[80:83]
    v_add_u32 v9, 4608, v9
    s_waitcnt vmcnt(2)
    ds_write_b128 v9, v[84:87]
    v_add_u32 v9, 4608, v9
    s_waitcnt vmcnt(1)
    ds_write_b128 v9, v[88:91]
    v_add_u32 v9, 4608, v9
    s_waitcnt vmcnt(0)
    ds_write_b128 v9, v[92:95]
    v_add_u32 v9, 4608, v9
    s_waitcnt lgkmcnt(0)
    s_barrier
    v_lshrrev_b32 v6, 4, v1
    v_lshlrev_b32 v6, 2, v6
    v_bfe_u32 v7, v1, 2, 2
    v_add_u32 v6, v6, v7
    v_mul_u32_u24 v6, 144, v6
    v_and_b32 v7, 3, v1
    v_lshl_add_u32 v6, v7, 3, v6
    s_lshl_b32 s64, s60, 5
    v_add_u32 v6, s64, v6
    s_lshl_b32 s64, s67, 2
    s_add_u32 s64, s64, s60
    s_mul_i32 s65, s64, 9363
    s_lshr_b32 s65, s65, 16
    s_mul_i32 s66, s65, 7
    s_sub_u32 s66, s64, s66
    s_mul_i32 s65, s65, 140
    s_add_u32 s65, s65, s66
    s_lshl_b32 s65, s65, 10
    s_add_u32 s65, s65, 11657216
    v_mov_b32 v100, 0x3f803f80
    v_mov_b32 v101, 0x3f803f80
    v_mov_b32 v102, 0x3f803f80
    v_mov_b32 v103, 0x3f803f80
    v_mov_b32 v104, 0
    v_mov_b32 v105, 0
    v_mov_b32 v106, 0
    v_mov_b32 v107, 0
    ds_read_b64_tr_b16 v[16:17], v6
    ds_read_b64_tr_b16 v[18:19], v6 offset:2304
    v_add_u32 v6, 4608, v6
    ds_read_b64_tr_b16 v[20:21], v6
    ds_read_b64_tr_b16 v[22:23], v6 offset:2304
    v_add_u32 v6, 4608, v6
    ds_read_b64_tr_b16 v[24:25], v6
    ds_read_b64_tr_b16 v[26:27], v6 offset:2304
    v_add_u32 v6, 4608, v6
    ds_read_b64_tr_b16 v[28:29], v6
    ds_read_b64_tr_b16 v[30:31], v6 offset:2304
    v_add_u32 v6, 4608, v6
    ds_read_b64_tr_b16 v[32:33], v6
    ds_read_b64_tr_b16 v[34:35], v6 offset:2304
    v_add_u32 v6, 4608, v6
    s_waitcnt lgkmcnt(8)
    v_mfma_f32_16x16x32_bf16 v[104:107], v[16:19], v[100:103], v[104:107]
    ds_read_b64_tr_b16 v[36:37], v6
    ds_read_b64_tr_b16 v[38:39], v6 offset:2304
    v_add_u32 v6, 4608, v6
    s_waitcnt lgkmcnt(8)
    v_mfma_f32_16x16x32_bf16 v[104:107], v[20:23], v[100:103], v[104:107]
    ds_read_b64_tr_b16 v[40:41], v6
    ds_read_b64_tr_b16 v[42:43], v6 offset:2304
    v_add_u32 v6, 4608, v6
    s_waitcnt lgkmcnt(8)
    v_mfma_f32_16x16x32_bf16 v[104:107], v[24:27], v[100:103], v[104:107]
    ds_read_b64_tr_b16 v[44:45], v6
    ds_read_b64_tr_b16 v[46:47], v6 offset:2304
    v_add_u32 v6, 4608, v6
    s_waitcnt lgkmcnt(8)
    v_mfma_f32_16x16x32_bf16 v[104:107], v[28:31], v[100:103], v[104:107]
    ds_read_b64_tr_b16 v[48:49], v6
    ds_read_b64_tr_b16 v[50:51], v6 offset:2304
    v_add_u32 v6, 4608, v6
    s_waitcnt lgkmcnt(8)
    v_mfma_f32_16x16x32_bf16 v[104:107], v[32:35], v[100:103], v[104:107]
    ds_read_b64_tr_b16 v[52:53], v6
    ds_read_b64_tr_b16 v[54:55], v6 offset:2304
    v_add_u32 v6, 4608, v6
    s_waitcnt lgkmcnt(8)
    v_mfma_f32_16x16x32_bf16 v[104:107], v[36:39], v[100:103], v[104:107]
    ds_read_b64_tr_b16 v[56:57], v6
    ds_read_b64_tr_b16 v[58:59], v6 offset:2304
    v_add_u32 v6, 4608, v6
    s_waitcnt lgkmcnt(8)
    v_mfma_f32_16x16x32_bf16 v[104:107], v[40:43], v[100:103], v[104:107]
    ds_read_b64_tr_b16 v[60:61], v6
    ds_read_b64_tr_b16 v[62:63], v6 offset:2304
    v_add_u32 v6, 4608, v6
    s_waitcnt lgkmcnt(8)
    v_mfma_f32_16x16x32_bf16 v[104:107], v[44:47], v[100:103], v[104:107]
    ds_read_b64_tr_b16 v[64:65], v6
    ds_read_b64_tr_b16 v[66:67], v6 offset:2304
    v_add_u32 v6, 4608, v6
    s_waitcnt lgkmcnt(8)
    v_mfma_f32_16x16x32_bf16 v[104:107], v[48:51], v[100:103], v[104:107]
    ds_read_b64_tr_b16 v[68:69], v6
    ds_read_b64_tr_b16 v[70:71], v6 offset:2304
    v_add_u32 v6, 4608, v6
    s_waitcnt lgkmcnt(8)
    v_mfma_f32_16x16x32_bf16 v[104:107], v[52:55], v[100:103], v[104:107]
    ds_read_b64_tr_b16 v[72:73], v6
    ds_read_b64_tr_b16 v[74:75], v6 offset:2304
    v_add_u32 v6, 4608, v6
    s_waitcnt lgkmcnt(8)
    v_mfma_f32_16x16x32_bf16 v[104:107], v[56:59], v[100:103], v[104:107]
    ds_read_b64_tr_b16 v[76:77], v6
    ds_read_b64_tr_b16 v[78:79], v6 offset:2304
    v_add_u32 v6, 4608, v6
    s_waitcnt lgkmcnt(8)
    v_mfma_f32_16x16x32_bf16 v[104:107], v[60:63], v[100:103], v[104:107]
    ds_read_b64_tr_b16 v[80:81], v6
    ds_read_b64_tr_b16 v[82:83], v6 offset:2304
    v_add_u32 v6, 4608, v6
    s_waitcnt lgkmcnt(8)
    v_mfma_f32_16x16x32_bf16 v[104:107], v[64:67], v[100:103], v[104:107]
    ds_read_b64_tr_b16 v[84:85], v6
    ds_read_b64_tr_b16 v[86:87], v6 offset:2304
    v_add_u32 v6, 4608, v6
    s_waitcnt lgkmcnt(8)
    v_mfma_f32_16x16x32_bf16 v[104:107], v[68:71], v[100:103], v[104:107]
    ds_read_b64_tr_b16 v[88:89], v6
    ds_read_b64_tr_b16 v[90:91], v6 offset:2304
    v_add_u32 v6, 4608, v6
    s_waitcnt lgkmcnt(8)
    v_mfma_f32_16x16x32_bf16 v[104:107], v[72:75], v[100:103], v[104:107]
    ds_read_b64_tr_b16 v[92:93], v6
    ds_read_b64_tr_b16 v[94:95], v6 offset:2304
    v_add_u32 v6, 4608, v6
    s_waitcnt lgkmcnt(8)
    v_mfma_f32_16x16x32_bf16 v[104:107], v[76:79], v[100:103], v[104:107]
    s_waitcnt lgkmcnt(0)
    v_mfma_f32_16x16x32_bf16 v[104:107], v[80:83], v[100:103], v[104:107]
    v_mfma_f32_16x16x32_bf16 v[104:107], v[84:87], v[100:103], v[104:107]
    v_mfma_f32_16x16x32_bf16 v[104:107], v[88:91], v[100:103], v[104:107]
    v_mfma_f32_16x16x32_bf16 v[104:107], v[92:95], v[100:103], v[104:107]
    s_lshl_b32 s64, s64, 6
    s_add_u32 s64, s64, 11649024
    v_lshrrev_b32 v6, 4, v1
    v_lshlrev_b32 v6, 4, v6
    v_and_b32 v7, 15, v1
    v_cmp_eq_u32 vcc, 0, v7
    s_nop 4
    s_and_saveexec_b64 s[98:99], vcc
    buffer_store_dwordx4 v[104:107], v6, s[8:11], s64 offen sc1
    s_mov_b64 exec, s[98:99]
    s_waitcnt vmcnt(0)
    s_barrier
    s_cmp_lg_u32 s60, 0
    s_cbranch_scc1 L_arr_26
    s_mov_b64 s[98:99], exec
    s_mov_b64 exec, 0xffff
    v_lshlrev_b32 v4, 7, v1
    v_add_u32 v4, 18432, v4
    v_mov_b32 v5, 1
    buffer_atomic_add v5, v4, s[8:11], 0 offen
    s_mov_b64 exec, s[98:99]
L_arr_26:
    s_branch L_bdone
L_qrole:
    s_sub_u32 s67, s61, 160
    s_mov_b32 s12, s36
    s_mov_b32 s13, s37
    s_mov_b32 s14, 2621440
    s_mov_b32 s15, 0x20000
    s_sub_u32 s62, s61, 160
    s_mul_i32 s63, s62, 40960
    v_lshlrev_b32 v6, 4, v0
    buffer_load_dwordx4 v[16:19], v6, s[12:15], s63 offen offset:0
    s_add_u32 s64, s63, 4096
    buffer_load_dwordx4 v[20:23], v6, s[12:15], s64 offen
    s_add_u32 s64, s63, 8192
    buffer_load_dwordx4 v[24:27], v6, s[12:15], s64 offen
    s_add_u32 s64, s63, 12288
    buffer_load_dwordx4 v[28:31], v6, s[12:15], s64 offen
    s_add_u32 s64, s63, 16384
    buffer_load_dwordx4 v[32:35], v6, s[12:15], s64 offen
    s_add_u32 s64, s63, 20480
    buffer_load_dwordx4 v[36:39], v6, s[12:15], s64 offen
    s_add_u32 s64, s63, 24576
    buffer_load_dwordx4 v[40:43], v6, s[12:15], s64 offen
    s_add_u32 s64, s63, 28672
    buffer_load_dwordx4 v[44:47], v6, s[12:15], s64 offen
    s_add_u32 s64, s63, 32768
    buffer_load_dwordx4 v[48:51], v6, s[12:15], s64 offen
    s_add_u32 s64, s63, 36864
    buffer_load_dwordx4 v[52:55], v6, s[12:15], s64 offen
    s_mov_b32 s64, 0x3333334
    v_add_u32 v7, 0, v0
    v_mul_hi_u32 v8, v7, s64
    v_add_u32 v8, v8, v7
    v_lshlrev_b32 v60, 4, v8
    v_add_u32 v7, 256, v0
    v_mul_hi_u32 v8, v7, s64
    v_add_u32 v8, v8, v7
    v_lshlrev_b32 v61, 4, v8
    v_add_u32 v7, 512, v0
    v_mul_hi_u32 v8, v7, s64
    v_add_u32 v8, v8, v7
    v_lshlrev_b32 v62, 4, v8
    v_add_u32 v7, 768, v0
    v_mul_hi_u32 v8, v7, s64
    v_add_u32 v8, v8, v7
    v_lshlrev_b32 v63, 4, v8
    v_add_u32 v7, 1024, v0
    v_mul_hi_u32 v8, v7, s64
    v_add_u32 v8, v8, v7
    v_lshlrev_b32 v64, 4, v8
    v_add_u32 v7, 1280, v0
    v_mul_hi_u32 v8, v7, s64
    v_add_u32 v8, v8, v7
    v_lshlrev_b32 v65, 4, v8
    v_add_u32 v7, 1536, v0
    v_mul_hi_u32 v8, v7, s64
    v_add_u32 v8, v8, v7
    v_lshlrev_b32 v66, 4, v8
    v_add_u32 v7, 1792, v0
    v_mul_hi_u32 v8, v7, s64
    v_add_u32 v8, v8, v7
    v_lshlrev_b32 v67, 4, v8
    v_add_u32 v7, 2048, v0
    v_mul_hi_u32 v8, v7, s64
    v_add_u32 v8, v8, v7
    v_lshlrev_b32 v68, 4, v8
    v_add_u32 v7, 2304, v0
    v_mul_hi_u32 v8, v7, s64
    v_add_u32 v8, v8, v7
    v_lshlrev_b32 v69, 4, v8
    s_mov_b32 s65, s62
    s_mov_b32 s66, s63
    v_mov_b32 v160, -1
    v_mov_b32 v161, -1
    v_mov_b32 v162, -1
    v_mov_b32 v163, -1
    s_mul_i32 s62, s67, 16384
    s_mul_i32 s63, s60, 4096
    s_add_u32 s62, s62, s63
    s_add_u32 s62, s62, 7897088
    buffer_store_dwordx4 v[160:163], v2, s[8:11], s62 offen offset:0 sc1
    buffer_store_dwordx4 v[160:163], v2, s[8:11], s62 offen offset:1024 sc1
    buffer_store_dwordx4 v[160:163], v2, s[8:11], s62 offen offset:2048 sc1
    buffer_store_dwordx4 v[160:163], v2, s[8:11], s62 offen offset:3072 sc1
    s_mov_b32 s62, s65
    s_mov_b32 s63, s66
    s_waitcnt vmcnt(0)
    ds_write_b128 v60, v[16:19]
    ds_write_b128 v61, v[20:23]
    ds_write_b128 v62, v[24:27]
    ds_write_b128 v63, v[28:31]
    ds_write_b128 v64, v[32:35]
    ds_write_b128 v65, v[36:39]
    ds_write_b128 v66, v[40:43]
    ds_write_b128 v67, v[44:47]
    ds_write_b128 v68, v[48:51]
    ds_write_b128 v69, v[52:55]
    s_waitcnt lgkmcnt(0)
    s_barrier
    v_and_b32 v6, 15, v1
    v_lshrrev_b32 v7, 4, v1
    v_mul_u32_u24 v8, 2592, v6
    v_lshl_add_u32 v8, v7, 3, v8
    s_mul_i32 s64, s60, 320
    v_add_u32 v8, s64, v8
    ds_read_b64 v[16:17], v8 offset:0
    ds_read_b64 v[18:19], v8 offset:1296
    ds_read_b64 v[20:21], v8 offset:32
    ds_read_b64 v[22:23], v8 offset:1328
    ds_read_b64 v[24:25], v8 offset:64
    ds_read_b64 v[26:27], v8 offset:1360
    ds_read_b64 v[28:29], v8 offset:96
    ds_read_b64 v[30:31], v8 offset:1392
    ds_read_b64 v[32:33], v8 offset:128
    ds_read_b64 v[34:35], v8 offset:1424
    ds_read_b64 v[36:37], v8 offset:160
    ds_read_b64 v[38:39], v8 offset:1456
    ds_read_b64 v[40:41], v8 offset:192
    ds_read_b64 v[42:43], v8 offset:1488
    ds_read_b64 v[44:45], v8 offset:224
    ds_read_b64 v[46:47], v8 offset:1520
    ds_read_b64 v[48:49], v8 offset:256
    ds_read_b64 v[50:51], v8 offset:1552
    ds_read_b64 v[52:53], v8 offset:288
    ds_read_b64 v[54:55], v8 offset:1584
    s_mul_i32 s64, s62, 40960
    s_mul_i32 s65, s60, 10240
    s_add_u32 s64, s64, s65
    s_add_u32 s64, s64, 8945664
    s_waitcnt lgkmcnt(0)
    buffer_store_dwordx4 v[16:19], v2, s[8:11], s64 offen sc1
    s_add_u32 s64, s64, 1024
    buffer_store_dwordx4 v[20:23], v2, s[8:11], s64 offen sc1
    s_add_u32 s64, s64, 1024
    buffer_store_dwordx4 v[24:27], v2, s[8:11], s64 offen sc1
    s_add_u32 s64, s64, 1024
    buffer_store_dwordx4 v[28:31], v2, s[8:11], s64 offen sc1
    s_add_u32 s64, s64, 1024
    buffer_store_dwordx4 v[32:35], v2, s[8:11], s64 offen sc1
    s_add_u32 s64, s64, 1024
    buffer_store_dwordx4 v[36:39], v2, s[8:11], s64 offen sc1
    s_add_u32 s64, s64, 1024
    buffer_store_dwordx4 v[40:43], v2, s[8:11], s64 offen sc1
    s_add_u32 s64, s64, 1024
    buffer_store_dwordx4 v[44:47], v2, s[8:11], s64 offen sc1
    s_add_u32 s64, s64, 1024
    buffer_store_dwordx4 v[48:51], v2, s[8:11], s64 offen sc1
    s_add_u32 s64, s64, 1024
    buffer_store_dwordx4 v[52:55], v2, s[8:11], s64 offen sc1
    s_add_u32 s64, s64, 1024
    v_lshlrev_b32 v64, 16, v16
    v_and_b32 v65, 0xffff0000, v16
    v_lshlrev_b32 v104, 16, v18
    v_and_b32 v105, 0xffff0000, v18
    v_lshlrev_b32 v66, 16, v17
    v_and_b32 v67, 0xffff0000, v17
    v_lshlrev_b32 v106, 16, v19
    v_and_b32 v107, 0xffff0000, v19
    v_lshlrev_b32 v68, 16, v20
    v_and_b32 v69, 0xffff0000, v20
    v_lshlrev_b32 v108, 16, v22
    v_and_b32 v109, 0xffff0000, v22
    v_lshlrev_b32 v70, 16, v21
    v_and_b32 v71, 0xffff0000, v21
    v_lshlrev_b32 v110, 16, v23
    v_and_b32 v111, 0xffff0000, v23
    v_lshlrev_b32 v72, 16, v24
    v_and_b32 v73, 0xffff0000, v24
    v_lshlrev_b32 v112, 16, v26
    v_and_b32 v113, 0xffff0000, v26
    v_lshlrev_b32 v74, 16, v25
    v_and_b32 v75, 0xffff0000, v25
    v_lshlrev_b32 v114, 16, v27
    v_and_b32 v115, 0xffff0000, v27
    v_lshlrev_b32 v76, 16, v28
    v_and_b32 v77, 0xffff0000, v28
    v_lshlrev_b32 v116, 16, v30
    v_and_b32 v117, 0xffff0000, v30
    v_lshlrev_b32 v78, 16, v29
    v_and_b32 v79, 0xffff0000, v29
    v_lshlrev_b32 v118, 16, v31
    v_and_b32 v119, 0xffff0000, v31
    v_lshlrev_b32 v80, 16, v32
    v_and_b32 v81, 0xffff0000, v32
    v_lshlrev_b32 v120, 16, v34
    v_and_b32 v121, 0xffff0000, v34
    v_lshlrev_b32 v82, 16, v33
    v_and_b32 v83, 0xffff0000, v33
    v_lshlrev_b32 v122, 16, v35
    v_and_b32 v123, 0xffff0000, v35
    v_lshlrev_b32 v84, 16, v36
    v_and_b32 v85, 0xffff0000, v36
    v_lshlrev_b32 v124, 16, v38
    v_and_b32 v125, 0xffff0000, v38
    v_lshlrev_b32 v86, 16, v37
    v_and_b32 v87, 0xffff0000, v37
    v_lshlrev_b32 v126, 16, v39
    v_and_b32 v127, 0xffff0000, v39
    v_lshlrev_b32 v88, 16, v40
    v_and_b32 v89, 0xffff0000, v40
    v_lshlrev_b32 v128, 16, v42
    v_and_b32 v129, 0xffff0000, v42
    v_lshlrev_b32 v90, 16, v41
    v_and_b32 v91, 0xffff0000, v41
    v_lshlrev_b32 v130, 16, v43
    v_and_b32 v131, 0xffff0000, v43
    v_lshlrev_b32 v92, 16, v44
    v_and_b32 v93, 0xffff0000, v44
    v_lshlrev_b32 v132, 16, v46
    v_and_b32 v133, 0xffff0000, v46
    v_lshlrev_b32 v94, 16, v45
    v_and_b32 v95, 0xffff0000, v45
    v_lshlrev_b32 v134, 16, v47
    v_and_b32 v135, 0xffff0000, v47
    v_lshlrev_b32 v96, 16, v48
    v_and_b32 v97, 0xffff0000, v48
    v_lshlrev_b32 v136, 16, v50
    v_and_b32 v137, 0xffff0000, v50
    v_lshlrev_b32 v98, 16, v49
    v_and_b32 v99, 0xffff0000, v49
    v_lshlrev_b32 v138, 16, v51
    v_and_b32 v139, 0xffff0000, v51
    v_lshlrev_b32 v100, 16, v52
    v_and_b32 v101, 0xffff0000, v52
    v_lshlrev_b32 v140, 16, v54
    v_and_b32 v141, 0xffff0000, v54
    v_lshlrev_b32 v102, 16, v53
    v_and_b32 v103, 0xffff0000, v53
    v_lshlrev_b32 v142, 16, v55
    v_and_b32 v143, 0xffff0000, v55
    v_mov_b32 v144, 0
    v_mov_b32 v145, 0
    v_add_f32 v144, v144, v64
    v_add_f32 v145, v145, v104
    v_add_f32 v144, v144, v65
    v_add_f32 v145, v145, v105
    v_add_f32 v144, v144, v66
    v_add_f32 v145, v145, v106
    v_add_f32 v144, v144, v67
    v_add_f32 v145, v145, v107
    v_add_f32 v144, v144, v68
    v_add_f32 v145, v145, v108
    v_add_f32 v144, v144, v69
    v_add_f32 v145, v145, v109
    v_add_f32 v144, v144, v70
    v_add_f32 v145, v145, v110
    v_add_f32 v144, v144, v71
    v_add_f32 v145, v145, v111
    v_add_f32 v144, v144, v72
    v_add_f32 v145, v145, v112
    v_add_f32 v144, v144, v73
    v_add_f32 v145, v145, v113
    v_add_f32 v144, v144, v74
    v_add_f32 v145, v145, v114
    v_add_f32 v144, v144, v75
    v_add_f32 v145, v145, v115
    v_add_f32 v144, v144, v76
    v_add_f32 v145, v145, v116
    v_add_f32 v144, v144, v77
    v_add_f32 v145, v145, v117
    v_add_f32 v144, v144, v78
    v_add_f32 v145, v145, v118
    v_add_f32 v144, v144, v79
    v_add_f32 v145, v145, v119
    v_add_f32 v144, v144, v80
    v_add_f32 v145, v145, v120
    v_add_f32 v144, v144, v81
    v_add_f32 v145, v145, v121
    v_add_f32 v144, v144, v82
    v_add_f32 v145, v145, v122
    v_add_f32 v144, v144, v83
    v_add_f32 v145, v145, v123
    v_add_f32 v144, v144, v84
    v_add_f32 v145, v145, v124
    v_add_f32 v144, v144, v85
    v_add_f32 v145, v145, v125
    v_add_f32 v144, v144, v86
    v_add_f32 v145, v145, v126
    v_add_f32 v144, v144, v87
    v_add_f32 v145, v145, v127
    v_add_f32 v144, v144, v88
    v_add_f32 v145, v145, v128
    v_add_f32 v144, v144, v89
    v_add_f32 v145, v145, v129
    v_add_f32 v144, v144, v90
    v_add_f32 v145, v145, v130
    v_add_f32 v144, v144, v91
    v_add_f32 v145, v145, v131
    v_add_f32 v144, v144, v92
    v_add_f32 v145, v145, v132
    v_add_f32 v144, v144, v93
    v_add_f32 v145, v145, v133
    v_add_f32 v144, v144, v94
    v_add_f32 v145, v145, v134
    v_add_f32 v144, v144, v95
    v_add_f32 v145, v145, v135
    v_add_f32 v144, v144, v96
    v_add_f32 v145, v145, v136
    v_add_f32 v144, v144, v97
    v_add_f32 v145, v145, v137
    v_add_f32 v144, v144, v98
    v_add_f32 v145, v145, v138
    v_add_f32 v144, v144, v99
    v_add_f32 v145, v145, v139
    v_add_f32 v144, v144, v100
    v_add_f32 v145, v145, v140
    v_add_f32 v144, v144, v101
    v_add_f32 v145, v145, v141
    v_add_f32 v144, v144, v102
    v_add_f32 v145, v145, v142
    v_add_f32 v144, v144, v103
    v_add_f32 v145, v145, v143
    v_mov_b32 v10, v144
    s_nop 1
    v_permlane32_swap_b32 v144, v10
    v_add_f32 v144, v144, v10
    v_mov_b32 v10, v144
    s_nop 1
    v_permlane16_swap_b32 v144, v10
    v_add_f32 v144, v144, v10
    v_mov_b32 v10, v145
    s_nop 1
    v_permlane32_swap_b32 v145, v10
    v_add_f32 v145, v145, v10
    v_mov_b32 v10, v145
    s_nop 1
    v_permlane16_swap_b32 v145, v10
    v_add_f32 v145, v145, v10
    v_and_b32 v10, 15, v1
    v_lshlrev_b32 v10, 3, v10
    s_lshl_b32 s65, s60, 7
    v_add_u32 v11, s65, v10
    v_mov_b32 v158, v144
    v_mov_b32 v159, v145
    ds_write_b64 v11, v[158:159] offset:41472
    s_waitcnt lgkmcnt(0)
    s_barrier
    ds_read_b64 v[150:151], v10 offset:41472
    ds_read_b64 v[152:153], v10 offset:41600
    ds_read_b64 v[154:155], v10 offset:41728
    ds_read_b64 v[156:157], v10 offset:41856
    s_waitcnt lgkmcnt(0)
    v_add_f32 v144, v150, v152
    v_add_f32 v145, v151, v153
    v_add_f32 v144, v144, v154
    v_add_f32 v145, v145, v155
    v_add_f32 v144, v144, v156
    v_add_f32 v145, v145, v157
    v_mul_f32 v144, 0x3acccccd, v144
    v_mul_f32 v145, 0x3acccccd, v145
    v_mov_b32 v146, 0
    v_mov_b32 v147, 0
    v_sub_f32 v10, v64, v144
    v_sub_f32 v11, v104, v145
    v_fmac_f32 v146, v10, v10
    v_fmac_f32 v147, v11, v11
    v_sub_f32 v10, v65, v144
    v_sub_f32 v11, v105, v145
    v_fmac_f32 v146, v10, v10
    v_fmac_f32 v147, v11, v11
    v_sub_f32 v10, v66, v144
    v_sub_f32 v11, v106, v145
    v_fmac_f32 v146, v10, v10
    v_fmac_f32 v147, v11, v11
    v_sub_f32 v10, v67, v144
    v_sub_f32 v11, v107, v145
    v_fmac_f32 v146, v10, v10
    v_fmac_f32 v147, v11, v11
    v_sub_f32 v10, v68, v144
    v_sub_f32 v11, v108, v145
    v_fmac_f32 v146, v10, v10
    v_fmac_f32 v147, v11, v11
    v_sub_f32 v10, v69, v144
    v_sub_f32 v11, v109, v145
    v_fmac_f32 v146, v10, v10
    v_fmac_f32 v147, v11, v11
    v_sub_f32 v10, v70, v144
    v_sub_f32 v11, v110, v145
    v_fmac_f32 v146, v10, v10
    v_fmac_f32 v147, v11, v11
    v_sub_f32 v10, v71, v144
    v_sub_f32 v11, v111, v145
    v_fmac_f32 v146, v10, v10
    v_fmac_f32 v147, v11, v11
    v_sub_f32 v10, v72, v144
    v_sub_f32 v11, v112, v145
    v_fmac_f32 v146, v10, v10
    v_fmac_f32 v147, v11, v11
    v_sub_f32 v10, v73, v144
    v_sub_f32 v11, v113, v145
    v_fmac_f32 v146, v10, v10
    v_fmac_f32 v147, v11, v11
    v_sub_f32 v10, v74, v144
    v_sub_f32 v11, v114, v145
    v_fmac_f32 v146, v10, v10
    v_fmac_f32 v147, v11, v11
    v_sub_f32 v10, v75, v144
    v_sub_f32 v11, v115, v145
    v_fmac_f32 v146, v10, v10
    v_fmac_f32 v147, v11, v11
    v_sub_f32 v10, v76, v144
    v_sub_f32 v11, v116, v145
    v_fmac_f32 v146, v10, v10
    v_fmac_f32 v147, v11, v11
    v_sub_f32 v10, v77, v144
    v_sub_f32 v11, v117, v145
    v_fmac_f32 v146, v10, v10
    v_fmac_f32 v147, v11, v11
    v_sub_f32 v10, v78, v144
    v_sub_f32 v11, v118, v145
    v_fmac_f32 v146, v10, v10
    v_fmac_f32 v147, v11, v11
    v_sub_f32 v10, v79, v144
    v_sub_f32 v11, v119, v145
    v_fmac_f32 v146, v10, v10
    v_fmac_f32 v147, v11, v11
    v_sub_f32 v10, v80, v144
    v_sub_f32 v11, v120, v145
    v_fmac_f32 v146, v10, v10
    v_fmac_f32 v147, v11, v11
    v_sub_f32 v10, v81, v144
    v_sub_f32 v11, v121, v145
    v_fmac_f32 v146, v10, v10
    v_fmac_f32 v147, v11, v11
    v_sub_f32 v10, v82, v144
    v_sub_f32 v11, v122, v145
    v_fmac_f32 v146, v10, v10
    v_fmac_f32 v147, v11, v11
    v_sub_f32 v10, v83, v144
    v_sub_f32 v11, v123, v145
    v_fmac_f32 v146, v10, v10
    v_fmac_f32 v147, v11, v11
    v_sub_f32 v10, v84, v144
    v_sub_f32 v11, v124, v145
    v_fmac_f32 v146, v10, v10
    v_fmac_f32 v147, v11, v11
    v_sub_f32 v10, v85, v144
    v_sub_f32 v11, v125, v145
    v_fmac_f32 v146, v10, v10
    v_fmac_f32 v147, v11, v11
    v_sub_f32 v10, v86, v144
    v_sub_f32 v11, v126, v145
    v_fmac_f32 v146, v10, v10
    v_fmac_f32 v147, v11, v11
    v_sub_f32 v10, v87, v144
    v_sub_f32 v11, v127, v145
    v_fmac_f32 v146, v10, v10
    v_fmac_f32 v147, v11, v11
    v_sub_f32 v10, v88, v144
    v_sub_f32 v11, v128, v145
    v_fmac_f32 v146, v10, v10
    v_fmac_f32 v147, v11, v11
    v_sub_f32 v10, v89, v144
    v_sub_f32 v11, v129, v145
    v_fmac_f32 v146, v10, v10
    v_fmac_f32 v147, v11, v11
    v_sub_f32 v10, v90, v144
    v_sub_f32 v11, v130, v145
    v_fmac_f32 v146, v10, v10
    v_fmac_f32 v147, v11, v11
    v_sub_f32 v10, v91, v144
    v_sub_f32 v11, v131, v145
    v_fmac_f32 v146, v10, v10
    v_fmac_f32 v147, v11, v11
    v_sub_f32 v10, v92, v144
    v_sub_f32 v11, v132, v145
    v_fmac_f32 v146, v10, v10
    v_fmac_f32 v147, v11, v11
    v_sub_f32 v10, v93, v144
    v_sub_f32 v11, v133, v145
    v_fmac_f32 v146, v10, v10
    v_fmac_f32 v147, v11, v11
    v_sub_f32 v10, v94, v144
    v_sub_f32 v11, v134, v145
    v_fmac_f32 v146, v10, v10
    v_fmac_f32 v147, v11, v11
    v_sub_f32 v10, v95, v144
    v_sub_f32 v11, v135, v145
    v_fmac_f32 v146, v10, v10
    v_fmac_f32 v147, v11, v11
    v_sub_f32 v10, v96, v144
    v_sub_f32 v11, v136, v145
    v_fmac_f32 v146, v10, v10
    v_fmac_f32 v147, v11, v11
    v_sub_f32 v10, v97, v144
    v_sub_f32 v11, v137, v145
    v_fmac_f32 v146, v10, v10
    v_fmac_f32 v147, v11, v11
    v_sub_f32 v10, v98, v144
    v_sub_f32 v11, v138, v145
    v_fmac_f32 v146, v10, v10
    v_fmac_f32 v147, v11, v11
    v_sub_f32 v10, v99, v144
    v_sub_f32 v11, v139, v145
    v_fmac_f32 v146, v10, v10
    v_fmac_f32 v147, v11, v11
    v_sub_f32 v10, v100, v144
    v_sub_f32 v11, v140, v145
    v_fmac_f32 v146, v10, v10
    v_fmac_f32 v147, v11, v11
    v_sub_f32 v10, v101, v144
    v_sub_f32 v11, v141, v145
    v_fmac_f32 v146, v10, v10
    v_fmac_f32 v147, v11, v11
    v_sub_f32 v10, v102, v144
    v_sub_f32 v11, v142, v145
    v_fmac_f32 v146, v10, v10
    v_fmac_f32 v147, v11, v11
    v_sub_f32 v10, v103, v144
    v_sub_f32 v11, v143, v145
    v_fmac_f32 v146, v10, v10
    v_fmac_f32 v147, v11, v11
    v_mov_b32 v10, v146
    s_nop 1
    v_permlane32_swap_b32 v146, v10
    v_add_f32 v146, v146, v10
    v_mov_b32 v10, v146
    s_nop 1
    v_permlane16_swap_b32 v146, v10
    v_add_f32 v146, v146, v10
    v_mov_b32 v10, v147
    s_nop 1
    v_permlane32_swap_b32 v147, v10
    v_add_f32 v147, v147, v10
    v_mov_b32 v10, v147
    s_nop 1
    v_permlane16_swap_b32 v147, v10
    v_add_f32 v147, v147, v10
    v_and_b32 v10, 15, v1
    v_lshlrev_b32 v10, 3, v10
    s_lshl_b32 s65, s60, 7
    v_add_u32 v11, s65, v10
    v_mov_b32 v158, v146
    v_mov_b32 v159, v147
    ds_write_b64 v11, v[158:159] offset:41984
    s_waitcnt lgkmcnt(0)
    s_barrier
    ds_read_b64 v[150:151], v10 offset:41984
    ds_read_b64 v[152:153], v10 offset:42112
    ds_read_b64 v[154:155], v10 offset:42240
    ds_read_b64 v[156:157], v10 offset:42368
    s_waitcnt lgkmcnt(0)
    v_add_f32 v146, v150, v152
    v_add_f32 v147, v151, v153
    v_add_f32 v146, v146, v154
    v_add_f32 v147, v147, v155
    v_add_f32 v146, v146, v156
    v_add_f32 v147, v147, v157
    v_mov_b32 v10, 0x3727c5ac
    v_fmac_f32 v10, 0x3acccccd, v146
    v_mov_b32 v11, 0x3727c5ac
    v_fmac_f32 v11, 0x3acccccd, v147
    v_rsq_f32 v10, v10
    v_rsq_f32 v11, v11
    v_mov_b32 v148, v144
    v_mov_b32 v150, v145
    v_mov_b32 v149, v10
    v_mov_b32 v151, v11
    s_cmp_lg_u32 s60, 0
    s_cbranch_scc1 L_qst_27
    s_lshl_b32 s64, s62, 8
    s_add_u32 s64, s64, 11632640
    s_mov_b64 s[98:99], exec
    s_mov_b64 exec, 0xffff
    buffer_store_dwordx4 v[148:151], v2, s[8:11], s64 offen sc1
    s_mov_b64 exec, s[98:99]
L_qst_27:
    s_waitcnt vmcnt(0)
    s_barrier
    s_cmp_lg_u32 s60, 0
    s_cbranch_scc1 L_arr_28
    v_mov_b32 v4, 0
    buffer_load_dword v5, v4, s[28:31], 0 offen sc1
    s_waitcnt vmcnt(0)
L_pe_29:
    v_cmp_gt_u32 vcc, 1, v5
    s_nop 1
    s_cbranch_vccz L_pok_30
    s_cmp_eq_u32 s97, 0
    s_cbranch_scc1 L_pok_30
    s_sub_u32 s97, s97, 1
    s_sleep 2
    buffer_load_dword v5, v4, s[28:31], 0 offen sc1
    s_waitcnt vmcnt(0)
    s_branch L_pe_29
L_pok_30:
    s_mov_b64 s[98:99], exec
    s_mov_b64 exec, 0xffff
    v_lshlrev_b32 v4, 7, v1
    v_add_u32 v4, 8192, v4
    v_mov_b32 v5, 1
    buffer_atomic_add v5, v4, s[8:11], 0 offen
    s_mov_b64 exec, s[98:99]
L_arr_28:
    s_cmp_ge_u32 s67, 54
    s_cbranch_scc1 L_bdone
    s_mov_b32 s16, s52
    s_mov_b32 s17, s53
    s_mov_b32 s18, 2211840
    s_mov_b32 s19, 0x20000
    s_mul_i32 s70, s67, 40960
    v_lshlrev_b32 v9, 4, v0
    s_add_u32 s71, s70, 0
    buffer_load_dwordx4 v[200:203], v9, s[16:19], s71 offen
    s_add_u32 s71, s70, 4096
    buffer_load_dwordx4 v[204:207], v9, s[16:19], s71 offen
    s_add_u32 s71, s70, 8192
    buffer_load_dwordx4 v[208:211], v9, s[16:19], s71 offen
    s_add_u32 s71, s70, 12288
    buffer_load_dwordx4 v[212:215], v9, s[16:19], s71 offen
    s_add_u32 s71, s70, 16384
    buffer_load_dwordx4 v[216:219], v9, s[16:19], s71 offen
    s_add_u32 s71, s70, 20480
    buffer_load_dwordx4 v[220:223], v9, s[16:19], s71 offen
    s_add_u32 s71, s70, 24576
    buffer_load_dwordx4 v[224:227], v9, s[16:19], s71 offen
    s_add_u32 s71, s70, 28672
    buffer_load_dwordx4 v[228:231], v9, s[16:19], s71 offen
    s_add_u32 s71, s70, 32768
    buffer_load_dwordx4 v[232:235], v9, s[16:19], s71 offen
    s_add_u32 s71, s70, 36864
    buffer_load_dwordx4 v[236:239], v9, s[16:19], s71 offen
    s_waitcnt vmcnt(0)
    s_mov_b32 s64, 0x3333334
    v_add_u32 v7, 0, v0
    v_mul_hi_u32 v8, v7, s64
    v_add_u32 v8, v8, v7
    v_lshlrev_b32 v60, 4, v8
    v_add_u32 v7, 256, v0
    v_mul_hi_u32 v8, v7, s64
    v_add_u32 v8, v8, v7
    v_lshlrev_b32 v61, 4, v8
    v_add_u32 v7, 512, v0
    v_mul_hi_u32 v8, v7, s64
    v_add_u32 v8, v8, v7
    v_lshlrev_b32 v62, 4, v8
    v_add_u32 v7, 768, v0
    v_mul_hi_u32 v8, v7, s64
    v_add_u32 v8, v8, v7
    v_lshlrev_b32 v63, 4, v8
    v_add_u32 v7, 1024, v0
    v_mul_hi_u32 v8, v7, s64
    v_add_u32 v8, v8, v7
    v_lshlrev_b32 v64, 4, v8
    v_add_u32 v7, 1280, v0
    v_mul_hi_u32 v8, v7, s64
    v_add_u32 v8, v8, v7
    v_lshlrev_b32 v65, 4, v8
    v_add_u32 v7, 1536, v0
    v_mul_hi_u32 v8, v7, s64
    v_add_u32 v8, v8, v7
    v_lshlrev_b32 v66, 4, v8
    v_add_u32 v7, 1792, v0
    v_mul_hi_u32 v8, v7, s64
    v_add_u32 v8, v8, v7
    v_lshlrev_b32 v67, 4, v8
    v_add_u32 v7, 2048, v0
    v_mul_hi_u32 v8, v7, s64
    v_add_u32 v8, v8, v7
    v_lshlrev_b32 v68, 4, v8
    v_add_u32 v7, 2304, v0
    v_mul_hi_u32 v8, v7, s64
    v_add_u32 v8, v8, v7
    v_lshlrev_b32 v69, 4, v8
    s_barrier
    ds_write_b128 v60, v[200:203]
    ds_write_b128 v61, v[204:207]
    ds_write_b128 v62, v[208:211]
    ds_write_b128 v63, v[212:215]
    ds_write_b128 v64, v[216:219]
    ds_write_b128 v65, v[220:223]
    ds_write_b128 v66, v[224:227]
    ds_write_b128 v67, v[228:231]
    ds_write_b128 v68, v[232:235]
    ds_write_b128 v69, v[236:239]
    s_waitcnt lgkmcnt(0)
    s_barrier
    v_lshrrev_b32 v6, 4, v1
    v_lshlrev_b32 v6, 2, v6
    v_bfe_u32 v7, v1, 2, 2
    v_add_u32 v6, v6, v7
    v_mul_u32_u24 v6, 1296, v6
    v_and_b32 v7, 3, v1
    v_lshl_add_u32 v6, v7, 3, v6
    s_mul_i32 s64, s60, 320
    v_add_u32 v6, s64, v6
    ds_read_b64_tr_b16 v[16:17], v6 offset:0
    ds_read_b64_tr_b16 v[18:19], v6 offset:20736
    ds_read_b64_tr_b16 v[20:21], v6 offset:32
    ds_read_b64_tr_b16 v[22:23], v6 offset:20768
    ds_read_b64_tr_b16 v[24:25], v6 offset:64
    ds_read_b64_tr_b16 v[26:27], v6 offset:20800
    ds_read_b64_tr_b16 v[28:29], v6 offset:96
    ds_read_b64_tr_b16 v[30:31], v6 offset:20832
    ds_read_b64_tr_b16 v[32:33], v6 offset:128
    ds_read_b64_tr_b16 v[34:35], v6 offset:20864
    ds_read_b64_tr_b16 v[36:37], v6 offset:160
    ds_read_b64_tr_b16 v[38:39], v6 offset:20896
    ds_read_b64_tr_b16 v[40:41], v6 offset:192
    ds_read_b64_tr_b16 v[42:43], v6 offset:20928
    ds_read_b64_tr_b16 v[44:45], v6 offset:224
    ds_read_b64_tr_b16 v[46:47], v6 offset:20960
    ds_read_b64_tr_b16 v[48:49], v6 offset:256
    ds_read_b64_tr_b16 v[50:51], v6 offset:20992
    ds_read_b64_tr_b16 v[52:53], v6 offset:288
    ds_read_b64_tr_b16 v[54:55], v6 offset:21024
    s_lshl_b32 s64, s60, 1
    s_mul_i32 s64, s64, 54
    s_add_u32 s64, s64, s67
    s_mul_i32 s64, s64, 5120
    s_add_u32 s64, s64, 13950976
    s_waitcnt lgkmcnt(15)
    buffer_store_dwordx4 v[16:19], v2, s[8:11], s64 offen sc1
    s_add_u32 s64, s64, 1024
    s_waitcnt lgkmcnt(15)
    buffer_store_dwordx4 v[20:23], v2, s[8:11], s64 offen sc1
    s_add_u32 s64, s64, 1024
    s_waitcnt lgkmcnt(14)
    buffer_store_dwordx4 v[24:27], v2, s[8:11], s64 offen sc1
    s_add_u32 s64, s64, 1024
    s_waitcnt lgkmcnt(12)
    buffer_store_dwordx4 v[28:31], v2, s[8:11], s64 offen sc1
    s_add_u32 s64, s64, 1024
    s_waitcnt lgkmcnt(10)
    buffer_store_dwordx4 v[32:35], v2, s[8:11], s64 offen sc1
    s_add_u32 s64, s64, 1024
    s_add_u32 s64, s64, 271360
    s_waitcnt lgkmcnt(8)
    buffer_store_dwordx4 v[36:39], v2, s[8:11], s64 offen sc1
    s_add_u32 s64, s64, 1024
    s_waitcnt lgkmcnt(6)
    buffer_store_dwordx4 v[40:43], v2, s[8:11], s64 offen sc1
    s_add_u32 s64, s64, 1024
    s_waitcnt lgkmcnt(4)
    buffer_store_dwordx4 v[44:47], v2, s[8:11], s64 offen sc1
    s_add_u32 s64, s64, 1024
    s_waitcnt lgkmcnt(2)
    buffer_store_dwordx4 v[48:51], v2, s[8:11], s64 offen sc1
    s_add_u32 s64, s64, 1024
    s_waitcnt lgkmcnt(0)
    buffer_store_dwordx4 v[52:55], v2, s[8:11], s64 offen sc1
    s_add_u32 s64, s64, 1024
    s_waitcnt vmcnt(0)
    s_barrier
    s_cmp_lg_u32 s60, 0
    s_cbranch_scc1 L_arr_31
    s_mov_b64 s[98:99], exec
    s_mov_b64 exec, 0xffff
    v_lshlrev_b32 v4, 7, v1
    v_add_u32 v4, 12288, v4
    v_mov_b32 v5, 1
    buffer_atomic_add v5, v4, s[8:11], 0 offen
    s_mov_b64 exec, s[98:99]
L_arr_31:
L_bdone:
    s_cmp_lg_u32 s60, 0
    s_cbranch_scc1 L_w0o_32
    v_mov_b32 v4, 0
    buffer_load_dword v5, v4, s[28:31], 0 offen sc1
    s_waitcnt vmcnt(0)
L_pe_33:
    v_cmp_gt_u32 vcc, 1, v5
    s_nop 1
    s_cbranch_vccz L_pok_34
    s_cmp_eq_u32 s97, 0
    s_cbranch_scc1 L_pok_34
    s_sub_u32 s97, s97, 1
    s_sleep 2
    buffer_load_dword v5, v4, s[28:31], 0 offen sc1
    s_waitcnt vmcnt(0)
    s_branch L_pe_33
L_pok_34:
    s_and_b32 s62, s61, 15
    s_lshl_b32 s62, s62, 7
    s_add_u32 s62, s62, 8192
    v_mov_b32 v4, s62
    buffer_load_dword v5, v4, s[8:11], 0 offen sc1
    s_waitcnt vmcnt(0)
L_pe_35:
    v_cmp_gt_u32 vcc, 64, v5
    s_nop 1
    s_cbranch_vccz L_pok_36
    s_cmp_eq_u32 s97, 0
    s_cbranch_scc1 L_pok_36
    s_sub_u32 s97, s97, 1
    s_sleep 2
    buffer_load_dword v5, v4, s[8:11], 0 offen sc1
    s_waitcnt vmcnt(0)
    s_branch L_pe_35
L_pok_36:
    s_and_b32 s62, s61, 15
    s_lshl_b32 s62, s62, 7
    s_add_u32 s62, s62, 10240
    v_mov_b32 v4, s62
    buffer_load_dword v5, v4, s[8:11], 0 offen sc1
    s_waitcnt vmcnt(0)
L_pe_37:
    v_cmp_gt_u32 vcc, 30, v5
    s_nop 1
    s_cbranch_vccz L_pok_38
    s_cmp_eq_u32 s97, 0
    s_cbranch_scc1 L_pok_38
    s_sub_u32 s97, s97, 1
    s_sleep 2
    buffer_load_dword v5, v4, s[8:11], 0 offen sc1
    s_waitcnt vmcnt(0)
    s_branch L_pe_37
L_pok_38:
L_w0o_32:
    s_barrier
    s_cmp_eq_u32 s60, 0
    s_cbranch_scc1 L_dma_39
    s_sub_u32 s63, s60, 1
    s_mul_i32 s63, s63, 48128
    s_mul_i32 s62, s77, 143360
    s_add_u32 s62, s62, s63
    s_add_u32 s62, s62, 11657216
    s_mov_b32 m0, s63
    s_nop 0
    buffer_load_dwordx4 v2, s[8:11], s62 offen offset:0 sc1 lds
    buffer_load_dwordx4 v2, s[8:11], s62 offen offset:1024 sc1 lds
    buffer_load_dwordx4 v2, s[8:11], s62 offen offset:2048 sc1 lds
    buffer_load_dwordx4 v2, s[8:11], s62 offen offset:3072 sc1 lds
    s_add_u32 s62, s62, 4096
    s_add_u32 s63, s63, 4096
    s_mov_b32 m0, s63
    s_nop 0
    buffer_load_dwordx4 v2, s[8:11], s62 offen offset:0 sc1 lds
    buffer_load_dwordx4 v2, s[8:11], s62 offen offset:1024 sc1 lds
    buffer_load_dwordx4 v2, s[8:11], s62 offen offset:2048 sc1 lds
    buffer_load_dwordx4 v2, s[8:11], s62 offen offset:3072 sc1 lds
    s_add_u32 s62, s62, 4096
    s_add_u32 s63, s63, 4096
    s_mov_b32 m0, s63
    s_nop 0
    buffer_load_dwordx4 v2, s[8:11], s62 offen offset:0 sc1 lds
    buffer_load_dwordx4 v2, s[8:11], s62 offen offset:1024 sc1 lds
    buffer_load_dwordx4 v2, s[8:11], s62 offen offset:2048 sc1 lds
    buffer_load_dwordx4 v2, s[8:11], s62 offen offset:3072 sc1 lds
    s_add_u32 s62, s62, 4096
    s_add_u32 s63, s63, 4096
    s_mov_b32 m0, s63
    s_nop 0
    buffer_load_dwordx4 v2, s[8:11], s62 offen offset:0 sc1 lds
    buffer_load_dwordx4 v2, s[8:11], s62 offen offset:1024 sc1 lds
    buffer_load_dwordx4 v2, s[8:11], s62 offen offset:2048 sc1 lds
    buffer_load_dwordx4 v2, s[8:11], s62 offen offset:3072 sc1 lds
    s_add_u32 s62, s62, 4096
    s_add_u32 s63, s63, 4096
    s_mov_b32 m0, s63
    s_nop 0
    buffer_load_dwordx4 v2, s[8:11], s62 offen offset:0 sc1 lds
    buffer_load_dwordx4 v2, s[8:11], s62 offen offset:1024 sc1 lds
    buffer_load_dwordx4 v2, s[8:11], s62 offen offset:2048 sc1 lds
    buffer_load_dwordx4 v2, s[8:11], s62 offen offset:3072 sc1 lds
    s_add_u32 s62, s62, 4096
    s_add_u32 s63, s63, 4096
    s_mov_b32 m0, s63
    s_nop 0
    buffer_load_dwordx4 v2, s[8:11], s62 offen offset:0 sc1 lds
    buffer_load_dwordx4 v2, s[8:11], s62 offen offset:1024 sc1 lds
    buffer_load_dwordx4 v2, s[8:11], s62 offen offset:2048 sc1 lds
    buffer_load_dwordx4 v2, s[8:11], s62 offen offset:3072 sc1 lds
    s_add_u32 s62, s62, 4096
    s_add_u32 s63, s63, 4096
    s_mov_b32 m0, s63
    s_nop 0
    buffer_load_dwordx4 v2, s[8:11], s62 offen offset:0 sc1 lds
    buffer_load_dwordx4 v2, s[8:11], s62 offen offset:1024 sc1 lds
    buffer_load_dwordx4 v2, s[8:11], s62 offen offset:2048 sc1 lds
    buffer_load_dwordx4 v2, s[8:11], s62 offen offset:3072 sc1 lds
    s_add_u32 s62, s62, 4096
    s_add_u32 s63, s63, 4096
    s_mov_b32 m0, s63
    s_nop 0
    buffer_load_dwordx4 v2, s[8:11], s62 offen offset:0 sc1 lds
    buffer_load_dwordx4 v2, s[8:11], s62 offen offset:1024 sc1 lds
    buffer_load_dwordx4 v2, s[8:11], s62 offen offset:2048 sc1 lds
    buffer_load_dwordx4 v2, s[8:11], s62 offen offset:3072 sc1 lds
    s_add_u32 s62, s62, 4096
    s_add_u32 s63, s63, 4096
    s_mov_b32 m0, s63
    s_nop 0
    buffer_load_dwordx4 v2, s[8:11], s62 offen offset:0 sc1 lds
    buffer_load_dwordx4 v2, s[8:11], s62 offen offset:1024 sc1 lds
    buffer_load_dwordx4 v2, s[8:11], s62 offen offset:2048 sc1 lds
    buffer_load_dwordx4 v2, s[8:11], s62 offen offset:3072 sc1 lds
    s_add_u32 s62, s62, 4096
    s_add_u32 s63, s63, 4096
    s_mov_b32 m0, s63
    s_nop 0
    buffer_load_dwordx4 v2, s[8:11], s62 offen offset:0 sc1 lds
    buffer_load_dwordx4 v2, s[8:11], s62 offen offset:1024 sc1 lds
    buffer_load_dwordx4 v2, s[8:11], s62 offen offset:2048 sc1 lds
    buffer_load_dwordx4 v2, s[8:11], s62 offen offset:3072 sc1 lds
    s_add_u32 s62, s62, 4096
    s_add_u32 s63, s63, 4096
    s_mov_b32 m0, s63
    s_nop 0
    buffer_load_dwordx4 v2, s[8:11], s62 offen offset:0 sc1 lds
    buffer_load_dwordx4 v2, s[8:11], s62 offen offset:1024 sc1 lds
    buffer_load_dwordx4 v2, s[8:11], s62 offen offset:2048 sc1 lds
    buffer_load_dwordx4 v2, s[8:11], s62 offen offset:3072 sc1 lds
    s_add_u32 s62, s62, 4096
    s_add_u32 s63, s63, 4096
    s_mov_b32 m0, s63
    s_nop 0
    buffer_load_dwordx4 v2, s[8:11], s62 offen offset:0 sc1 lds
    buffer_load_dwordx4 v2, s[8:11], s62 offen offset:1024 sc1 lds
    buffer_load_dwordx4 v2, s[8:11], s62 offen offset:2048 sc1 lds
L_dma_39:
    s_cmp_eq_u32 s60, 0
    s_cbranch_scc1 L_l1w_42
    s_lshr_b32 s62, s61, 3
    s_sub_u32 s62, s62, 20
    s_mul_i32 s62, s62, 3
    s_add_u32 s62, s62, s60
    s_sub_u32 s62, s62, 1
    s_lshl_b32 s62, s62, 14
    s_add_u32 s62, s62, 11657216
    s_waitcnt vmcnt(30)
    buffer_load_dwordx4 v[16:19], v2, s[8:11], s62 offen sc1
    s_add_u32 s62, s62, 1024
    buffer_load_dwordx4 v[20:23], v2, s[8:11], s62 offen sc1
    s_add_u32 s62, s62, 1024
    buffer_load_dwordx4 v[24:27], v2, s[8:11], s62 offen sc1
    s_add_u32 s62, s62, 1024
    buffer_load_dwordx4 v[28:31], v2, s[8:11], s62 offen sc1
    s_add_u32 s62, s62, 1024
    buffer_load_dwordx4 v[32:35], v2, s[8:11], s62 offen sc1
    s_add_u32 s62, s62, 1024
    buffer_load_dwordx4 v[36:39], v2, s[8:11], s62 offen sc1
    s_add_u32 s62, s62, 1024
    buffer_load_dwordx4 v[40:43], v2, s[8:11], s62 offen sc1
    s_add_u32 s62, s62, 1024
    buffer_load_dwordx4 v[44:47], v2, s[8:11], s62 offen sc1
    s_add_u32 s62, s62, 1024
    buffer_load_dwordx4 v[48:51], v2, s[8:11], s62 offen sc1
    s_add_u32 s62, s62, 1024
    buffer_load_dwordx4 v[52:55], v2, s[8:11], s62 offen sc1
    s_add_u32 s62, s62, 1024
    buffer_load_dwordx4 v[56:59], v2, s[8:11], s62 offen sc1
    s_add_u32 s62, s62, 1024
    buffer_load_dwordx4 v[60:63], v2, s[8:11], s62 offen sc1
    s_add_u32 s62, s62, 1024
    buffer_load_dwordx4 v[64:67], v2, s[8:11], s62 offen sc1
    s_add_u32 s62, s62, 1024
    buffer_load_dwordx4 v[68:71], v2, s[8:11], s62 offen sc1
    s_add_u32 s62, s62, 1024
    buffer_load_dwordx4 v[72:75], v2, s[8:11], s62 offen sc1
    s_add_u32 s62, s62, 1024
    buffer_load_dwordx4 v[76:79], v2, s[8:11], s62 offen sc1
    s_add_u32 s62, s62, 1024
L_l1w_42:
    v_mov_b32 v6, 147456
    v_mov_b32 v7, 0
    ds_write_b32 v6, v7
    s_cmp_lg_u32 s60, 0
    s_cbranch_scc1 L_w0o_43
    s_and_b32 s62, s61, 15
    s_lshl_b32 s62, s62, 7
    s_add_u32 s62, s62, 12288
    v_mov_b32 v4, s62
    buffer_load_dword v5, v4, s[8:11], 0 offen sc1
    s_waitcnt vmcnt(0)
L_pe_44:
    v_cmp_gt_u32 vcc, 54, v5
    s_nop 1
    s_cbranch_vccz L_pok_45
    s_cmp_eq_u32 s97, 0
    s_cbranch_scc1 L_pok_45
    s_sub_u32 s97, s97, 1
    s_sleep 8
    buffer_load_dword v5, v4, s[8:11], 0 offen sc1
    s_waitcnt vmcnt(0)
    s_branch L_pe_44
L_pok_45:
L_w0o_43:
    s_waitcnt lgkmcnt(0)
    s_barrier
    s_cmp_eq_u32 s60, 0
    s_cbranch_scc1 L_lw0_40
    s_lshr_b32 s62, s61, 3
    s_sub_u32 s62, s62, 20
    s_mul_i32 s62, s62, 3
    s_add_u32 s62, s62, s60
    s_sub_u32 s62, s62, 1
    s_mul_i32 s62, s62, 61440
    s_add_u32 s62, s62, 13950976
    buffer_load_dwordx4 v[16:19], v2, s[8:11], s62 offen sc1
    s_add_u32 s62, s62, 1024
    buffer_load_dwordx4 v[20:23], v2, s[8:11], s62 offen sc1
    s_add_u32 s62, s62, 1024
    buffer_load_dwordx4 v[24:27], v2, s[8:11], s62 offen sc1
    s_add_u32 s62, s62, 1024
    buffer_load_dwordx4 v[28:31], v2, s[8:11], s62 offen sc1
    s_add_u32 s62, s62, 1024
    buffer_load_dwordx4 v[32:35], v2, s[8:11], s62 offen sc1
    s_add_u32 s62, s62, 1024
    buffer_load_dwordx4 v[36:39], v2, s[8:11], s62 offen sc1
    s_add_u32 s62, s62, 1024
    ds_read_b32 v7, v6
    s_waitcnt vmcnt(0) lgkmcnt(0)
    v_readfirstlane_b32 s63, v7
    s_nop 3
    s_cmp_lg_u32 s63, 0
    s_cbranch_scc1 L_lwe_41
    buffer_load_dwordx4 v[40:43], v2, s[8:11], s62 offen sc1
    s_add_u32 s62, s62, 1024
    buffer_load_dwordx4 v[44:47], v2, s[8:11], s62 offen sc1
    s_add_u32 s62, s62, 1024
    buffer_load_dwordx4 v[48:51], v2, s[8:11], s62 offen sc1
    s_add_u32 s62, s62, 1024
    buffer_load_dwordx4 v[52:55], v2, s[8:11], s62 offen sc1
    s_add_u32 s62, s62, 1024
    buffer_load_dwordx4 v[56:59], v2, s[8:11], s62 offen sc1
    s_add_u32 s62, s62, 1024
    buffer_load_dwordx4 v[60:63], v2, s[8:11], s62 offen sc1
    s_add_u32 s62, s62, 1024
    ds_read_b32 v7, v6
    s_waitcnt vmcnt(0) lgkmcnt(0)
    v_readfirstlane_b32 s63, v7
    s_nop 3
    s_cmp_lg_u32 s63, 0
    s_cbranch_scc1 L_lwe_41
    buffer_load_dwordx4 v[64:67], v2, s[8:11], s62 offen sc1
    s_add_u32 s62, s62, 1024
    buffer_load_dwordx4 v[68:71], v2, s[8:11], s62 offen sc1
    s_add_u32 s62, s62, 1024
    buffer_load_dwordx4 v[72:75], v2, s[8:11], s62 offen sc1
    s_add_u32 s62, s62, 1024
    buffer_load_dwordx4 v[76:79], v2, s[8:11], s62 offen sc1
    s_add_u32 s62, s62, 1024
    buffer_load_dwordx4 v[16:19], v2, s[8:11], s62 offen sc1
    s_add_u32 s62, s62, 1024
    buffer_load_dwordx4 v[20:23], v2, s[8:11], s62 offen sc1
    s_add_u32 s62, s62, 1024
    ds_read_b32 v7, v6
    s_waitcnt vmcnt(0) lgkmcnt(0)
    v_readfirstlane_b32 s63, v7
    s_nop 3
    s_cmp_lg_u32 s63, 0
    s_cbranch_scc1 L_lwe_41
    buffer_load_dwordx4 v[24:27], v2, s[8:11], s62 offen sc1
    s_add_u32 s62, s62, 1024
    buffer_load_dwordx4 v[28:31], v2, s[8:11], s62 offen sc1
    s_add_u32 s62, s62, 1024
    buffer_load_dwordx4 v[32:35], v2, s[8:11], s62 offen sc1
    s_add_u32 s62, s62, 1024
    buffer_load_dwordx4 v[36:39], v2, s[8:11], s62 offen sc1
    s_add_u32 s62, s62, 1024
    buffer_load_dwordx4 v[40:43], v2, s[8:11], s62 offen sc1
    s_add_u32 s62, s62, 1024
    buffer_load_dwordx4 v[44:47], v2, s[8:11], s62 offen sc1
    s_add_u32 s62, s62, 1024
    ds_read_b32 v7, v6
    s_waitcnt vmcnt(0) lgkmcnt(0)
    v_readfirstlane_b32 s63, v7
    s_nop 3
    s_cmp_lg_u32 s63, 0
    s_cbranch_scc1 L_lwe_41
    buffer_load_dwordx4 v[48:51], v2, s[8:11], s62 offen sc1
    s_add_u32 s62, s62, 1024
    buffer_load_dwordx4 v[52:55], v2, s[8:11], s62 offen sc1
    s_add_u32 s62, s62, 1024
    buffer_load_dwordx4 v[56:59], v2, s[8:11], s62 offen sc1
    s_add_u32 s62, s62, 1024
    buffer_load_dwordx4 v[60:63], v2, s[8:11], s62 offen sc1
    s_add_u32 s62, s62, 1024
    buffer_load_dwordx4 v[64:67], v2, s[8:11], s62 offen sc1
    s_add_u32 s62, s62, 1024
    buffer_load_dwordx4 v[68:71], v2, s[8:11], s62 offen sc1
    s_add_u32 s62, s62, 1024
    ds_read_b32 v7, v6
    s_waitcnt vmcnt(0) lgkmcnt(0)
    v_readfirstlane_b32 s63, v7
    s_nop 3
    s_cmp_lg_u32 s63, 0
    s_cbranch_scc1 L_lwe_41
    buffer_load_dwordx4 v[72:75], v2, s[8:11], s62 offen sc1
    s_add_u32 s62, s62, 1024
    buffer_load_dwordx4 v[76:79], v2, s[8:11], s62 offen sc1
    s_add_u32 s62, s62, 1024
    buffer_load_dwordx4 v[16:19], v2, s[8:11], s62 offen sc1
    s_add_u32 s62, s62, 1024
    buffer_load_dwordx4 v[20:23], v2, s[8:11], s62 offen sc1
    s_add_u32 s62, s62, 1024
    buffer_load_dwordx4 v[24:27], v2, s[8:11], s62 offen sc1
    s_add_u32 s62, s62, 1024
    buffer_load_dwordx4 v[28:31], v2, s[8:11], s62 offen sc1
    s_add_u32 s62, s62, 1024
    ds_read_b32 v7, v6
    s_waitcnt vmcnt(0) lgkmcnt(0)
    v_readfirstlane_b32 s63, v7
    s_nop 3
    s_cmp_lg_u32 s63, 0
    s_cbranch_scc1 L_lwe_41
    buffer_load_dwordx4 v[32:35], v2, s[8:11], s62 offen sc1
    s_add_u32 s62, s62, 1024
    buffer_load_dwordx4 v[36:39], v2, s[8:11], s62 offen sc1
    s_add_u32 s62, s62, 1024
    buffer_load_dwordx4 v[40:43], v2, s[8:11], s62 offen sc1
    s_add_u32 s62, s62, 1024
    buffer_load_dwordx4 v[44:47], v2, s[8:11], s62 offen sc1
    s_add_u32 s62, s62, 1024
    buffer_load_dwordx4 v[48:51], v2, s[8:11], s62 offen sc1
    s_add_u32 s62, s62, 1024
    buffer_load_dwordx4 v[52:55], v2, s[8:11], s62 offen sc1
    s_add_u32 s62, s62, 1024
    ds_read_b32 v7, v6
    s_waitcnt vmcnt(0) lgkmcnt(0)
    v_readfirstlane_b32 s63, v7
    s_nop 3
    s_cmp_lg_u32 s63, 0
    s_cbranch_scc1 L_lwe_41
    buffer_load_dwordx4 v[56:59], v2, s[8:11], s62 offen sc1
    s_add_u32 s62, s62, 1024
    buffer_load_dwordx4 v[60:63], v2, s[8:11], s62 offen sc1
    s_add_u32 s62, s62, 1024
    buffer_load_dwordx4 v[64:67], v2, s[8:11], s62 offen sc1
    s_add_u32 s62, s62, 1024
    buffer_load_dwordx4 v[68:71], v2, s[8:11], s62 offen sc1
    s_add_u32 s62, s62, 1024
    buffer_load_dwordx4 v[72:75], v2, s[8:11], s62 offen sc1
    s_add_u32 s62, s62, 1024
    buffer_load_dwordx4 v[76:79], v2, s[8:11], s62 offen sc1
    s_add_u32 s62, s62, 1024
    ds_read_b32 v7, v6
    s_waitcnt vmcnt(0) lgkmcnt(0)
    v_readfirstlane_b32 s63, v7
    s_nop 3
    s_cmp_lg_u32 s63, 0
    s_cbranch_scc1 L_lwe_41
    buffer_load_dwordx4 v[16:19], v2, s[8:11], s62 offen sc1
    s_add_u32 s62, s62, 1024
    buffer_load_dwordx4 v[20:23], v2, s[8:11], s62 offen sc1
    s_add_u32 s62, s62, 1024
    buffer_load_dwordx4 v[24:27], v2, s[8:11], s62 offen sc1
    s_add_u32 s62, s62, 1024
    buffer_load_dwordx4 v[28:31], v2, s[8:11], s62 offen sc1
    s_add_u32 s62, s62, 1024
    buffer_load_dwordx4 v[32:35], v2, s[8:11], s62 offen sc1
    s_add_u32 s62, s62, 1024
    buffer_load_dwordx4 v[36:39], v2, s[8:11], s62 offen sc1
    s_add_u32 s62, s62, 1024
    ds_read_b32 v7, v6
    s_waitcnt vmcnt(0) lgkmcnt(0)
    v_readfirstlane_b32 s63, v7
    s_nop 3
    s_cmp_lg_u32 s63, 0
    s_cbranch_scc1 L_lwe_41
    buffer_load_dwordx4 v[40:43], v2, s[8:11], s62 offen sc1
    s_add_u32 s62, s62, 1024
    buffer_load_dwordx4 v[44:47], v2, s[8:11], s62 offen sc1
    s_add_u32 s62, s62, 1024
    buffer_load_dwordx4 v[48:51], v2, s[8:11], s62 offen sc1
    s_add_u32 s62, s62, 1024
    buffer_load_dwordx4 v[52:55], v2, s[8:11], s62 offen sc1
    s_add_u32 s62, s62, 1024
    buffer_load_dwordx4 v[56:59], v2, s[8:11], s62 offen sc1
    s_add_u32 s62, s62, 1024
    buffer_load_dwordx4 v[60:63], v2, s[8:11], s62 offen sc1
    s_add_u32 s62, s62, 1024
    ds_read_b32 v7, v6
    s_waitcnt vmcnt(0) lgkmcnt(0)
    v_readfirstlane_b32 s63, v7
    s_nop 3
    s_cmp_lg_u32 s63, 0
    s_cbranch_scc1 L_lwe_41
    s_branch L_lwe_41
L_lw0_40:
    s_and_b32 s62, s61, 15
    s_lshl_b32 s62, s62, 7
    s_add_u32 s62, s62, 14336
    v_mov_b32 v4, s62
    buffer_load_dword v5, v4, s[8:11], 0 offen sc1
    s_waitcnt vmcnt(0)
L_pe_46:
    v_cmp_gt_u32 vcc, 160, v5
    s_nop 1
    s_cbranch_vccz L_pok_47
    s_cmp_eq_u32 s97, 0
    s_cbranch_scc1 L_pok_47
    s_sub_u32 s97, s97, 1
    s_sleep 2
    buffer_load_dword v5, v4, s[8:11], 0 offen sc1
    s_waitcnt vmcnt(0)
    s_branch L_pe_46
L_pok_47:
    v_mov_b32 v7, 1
    ds_write_b32 v6, v7
    s_waitcnt lgkmcnt(0)
L_lwe_41:
    s_mov_b32 s96, 1
L_ffn:
    s_mul_i32 s62, s60, 14
    s_cmp_ge_u32 s60, 3
    s_cselect_b32 s63, 1, 0
    s_sub_u32 s62, s62, s63
    s_mul_i32 s63, s79, 54
    s_add_u32 s62, s62, s63
    s_mul_i32 s62, s62, 5120
    s_add_u32 s62, s62, 13950976
    s_mul_i32 s63, s85, 3072
    s_add_u32 s86, s62, s63
    s_sub_u32 s63, 1, s85
    s_lshl_b32 s63, s63, 11
    s_add_u32 s87, s62, s63
    s_mov_b32 s82, 0
    s_mov_b32 s80, 5275648
    s_mov_b32 s81, 16179200
    s_mul_i32 s88, s83, 40960
    s_add_u32 s88, s88, s80
    s_lshl_b32 s62, s77, 11
    s_add_u32 s90, s62, s88
    s_add_u32 s91, s90, 32768
    s_cmp_lt_u32 s77, 4
    s_cselect_b32 s91, s91, 0x20000000
    s_cmp_eq_u32 s96, 1
    s_cbranch_scc1 L_cw_48
    s_cmp_lg_u32 s60, 0
    s_cbranch_scc1 L_w0o_49
    s_and_b32 s62, s61, 15
    s_lshl_b32 s62, s62, 7
    s_add_u32 s62, s62, 14336
    v_mov_b32 v4, s62
    buffer_load_dword v5, v4, s[8:11], 0 offen sc1
    s_waitcnt vmcnt(0)
L_pe_50:
    v_cmp_gt_u32 vcc, 160, v5
    s_nop 1
    s_cbranch_vccz L_pok_51
    s_cmp_eq_u32 s97, 0
    s_cbranch_scc1 L_pok_51
    s_sub_u32 s97, s97, 1
    s_sleep 2
    buffer_load_dword v5, v4, s[8:11], 0 offen sc1
    s_waitcnt vmcnt(0)
    s_branch L_pe_50
L_pok_51:
L_w0o_49:
L_cw_48:
    s_barrier
    s_mov_b32 s82, 0
    s_mov_b32 s80, 5275648
    s_mov_b32 s81, 16179200
    s_waitcnt vmcnt(44)
    s_and_b32 s62, s61, 15
    s_lshl_b32 s62, s62, 7
    s_add_u32 s62, s62, 18432
    v_mov_b32 v229, s62
    buffer_load_dword v228, v229, s[8:11], 0 offen sc1
    s_and_b32 s62, s61, 15
    s_lshl_b32 s62, s62, 7
    s_add_u32 s62, s62, 12288
    v_mov_b32 v231, s62
    buffer_load_dword v230, v231, s[8:11], 0 offen sc1
    buffer_load_dwordx4 v[208:211], v2, s[8:11], s90 offen sc1
    buffer_load_dwordx4 v[212:215], v2, s[8:11], s90 offen offset:1024 sc1
    buffer_load_dwordx4 v[216:219], v2, s[8:11], s91 offen sc1
    buffer_load_dwordx4 v[220:223], v2, s[8:11], s91 offen offset:1024 sc1
    buffer_load_dwordx4 v[128:131], v2, s[8:11], s88 offen sc1
    buffer_load_dwordx4 v[132:135], v2, s[8:11], s88 offen offset:1024 sc1
    s_add_u32 s88, s88, 2048
    buffer_load_dwordx4 v[136:139], v2, s[8:11], s88 offen sc1
    buffer_load_dwordx4 v[140:143], v2, s[8:11], s88 offen offset:1024 sc1
    s_add_u32 s88, s88, 2048
    buffer_load_dwordx4 v[144:147], v2, s[8:11], s88 offen sc1
    buffer_load_dwordx4 v[148:151], v2, s[8:11], s88 offen offset:1024 sc1
    s_add_u32 s88, s88, 2048
    buffer_load_dwordx4 v[152:155], v2, s[8:11], s88 offen sc1
    buffer_load_dwordx4 v[156:159], v2, s[8:11], s88 offen offset:1024 sc1
    s_add_u32 s88, s88, 2048
    buffer_load_dwordx4 v[160:163], v2, s[8:11], s88 offen sc1
    buffer_load_dwordx4 v[164:167], v2, s[8:11], s88 offen offset:1024 sc1
    s_add_u32 s88, s88, 2048
    buffer_load_dwordx4 v[168:171], v2, s[8:11], s88 offen sc1
    buffer_load_dwordx4 v[172:175], v2, s[8:11], s88 offen offset:1024 sc1
    s_add_u32 s88, s88, 2048
    s_waitcnt vmcnt(16)
L_pe_52:
    v_cmp_gt_u32 vcc, 27, v228
    s_nop 1
    s_cbranch_vccz L_pok_53
    s_cmp_eq_u32 s97, 0
    s_cbranch_scc1 L_pok_53
    s_sub_u32 s97, s97, 1
    s_sleep 2
    buffer_load_dword v228, v229, s[8:11], 0 offen sc1
    s_waitcnt vmcnt(0)
    s_branch L_pe_52
L_pok_53:
L_pe_54:
    v_cmp_gt_u32 vcc, 54, v230
    s_nop 1
    s_cbranch_vccz L_pok_55
    s_cmp_eq_u32 s97, 0
    s_cbranch_scc1 L_pok_55
    s_sub_u32 s97, s97, 1
    s_sleep 2
    buffer_load_dword v230, v231, s[8:11], 0 offen sc1
    s_waitcnt vmcnt(0)
    s_branch L_pe_54
L_pok_55:
    s_mul_i32 s62, s82, 262144
    s_lshl_b32 s63, s83, 12
    s_add_u32 s62, s62, s63
    s_add_u32 s89, s62, 7897088
    s_lshl_b32 s63, s77, 8
    s_add_u32 s93, s89, s63
    v_mov_b32 v16, 0x3f803f80
    v_mov_b32 v17, 0x3f803f80
    v_mov_b32 v18, 0x3f803f80
    v_mov_b32 v19, 0x3f803f80
    v_and_b32 v6, 15, v1
    v_lshrrev_b32 v7, 4, v1
    v_lshrrev_b32 v8, 2, v6
    v_cmp_eq_u32 vcc, v7, v8
    v_lshlrev_b32 v9, 4, v6
    v_mov_b32 v10, 0x20000000
    v_cndmask_b32 v229, v10, v9, vcc
    v_and_b32 v6, 3, v6
    v_cmp_eq_u32 s[62:63], 1, v6
    v_cmp_eq_u32 s[64:65], 2, v6
    v_cmp_eq_u32 s[66:67], 3, v6
    s_waitcnt vmcnt(12)
    v_swap_b32 v210, v212
    v_swap_b32 v211, v213
    v_swap_b32 v218, v220
    v_swap_b32 v219, v221
    s_nop 0
    v_mfma_f32_16x16x32_bf16 v[20:23], v[16:19], v[208:211], 0
    v_mfma_f32_16x16x32_bf16 v[24:27], v[208:211], v[208:211], 0
    v_mfma_f32_16x16x32_bf16 v[28:31], v[16:19], v[212:215], 0
    v_mfma_f32_16x16x32_bf16 v[32:35], v[212:215], v[212:215], 0
    v_mfma_f32_16x16x32_bf16 v[20:23], v[16:19], v[216:219], v[20:23]
    v_mfma_f32_16x16x32_bf16 v[24:27], v[216:219], v[216:219], v[24:27]
    v_mfma_f32_16x16x32_bf16 v[28:31], v[16:19], v[220:223], v[28:31]
    v_mfma_f32_16x16x32_bf16 v[32:35], v[220:223], v[220:223], v[32:35]
    s_nop 7
    v_mov_b32 v224, v20
    v_mov_b32 v226, v28
    v_cndmask_b32 v225, v24, v25, s[62:63]
    v_cndmask_b32 v225, v225, v26, s[64:65]
    v_cndmask_b32 v225, v225, v27, s[66:67]
    v_cndmask_b32 v227, v32, v33, s[62:63]
    v_cndmask_b32 v227, v227, v34, s[64:65]
    v_cndmask_b32 v227, v227, v35, s[66:67]
    buffer_store_dwordx4 v[224:227], v229, s[8:11], s93 offen sc1
    s_barrier
    v_mov_b32 v3, v2
    v_add_u32 v4, 64512, v2
    v_add_u32 v5, 93184, v2
    ds_read_b128 v[72:75], v3 offset:0
    ds_read_b128 v[76:79], v3 offset:1024
    ds_read_b128 v[80:83], v3 offset:2048
    ds_read_b128 v[84:87], v3 offset:3072
    ds_read_b128 v[88:91], v3 offset:4096
    ds_read_b128 v[92:95], v3 offset:5120
    ds_read_b128 v[96:99], v3 offset:6144
    s_mul_i32 s62, s83, 110592
    s_mul_i32 s63, s77, 7168
    s_add_u32 s62, s62, s63
    s_add_u32 s62, s62, s81
    s_add_u32 s63, s62, 3072
    s_cmp_eq_u32 s77, 15
    s_cselect_b32 s63, 0x20000000, s63
    v_lshrrev_b32 v9, 4, v1
    v_lshlrev_b32 v9, 4, v9
    s_mul_i32 s64, s77, 448
    s_add_u32 s64, s64, 11649024
    s_waitcnt vmcnt(10)
    v_swap_b32 v130, v132
    v_swap_b32 v131, v133
    s_nop 0
    s_waitcnt lgkmcnt(0)
    v_mfma_f32_16x16x32_bf16 v[16:19], v[72:75], v[128:131], 0
    ds_read_b128 v[100:103], v3 offset:7168
    buffer_load_dwordx4 v[176:179], v2, s[8:11], s88 offen sc1
    v_mfma_f32_16x16x32_bf16 v[44:47], v[72:75], v[132:135], 0
    ds_read_b128 v[104:107], v3 offset:8192
    buffer_load_dwordx4 v[180:183], v2, s[8:11], s88 offen offset:1024 sc1
    s_add_u32 s88, s88, 2048
    v_mfma_f32_16x16x32_bf16 v[20:23], v[76:79], v[128:131], 0
    ds_read_b128 v[108:111], v3 offset:9216
    buffer_load_dwordx4 v[184:187], v2, s[8:11], s88 offen sc1
    v_mfma_f32_16x16x32_bf16 v[48:51], v[76:79], v[132:135], 0
    ds_read_b128 v[112:115], v3 offset:10240
    buffer_load_dwordx4 v[188:191], v2, s[8:11], s88 offen offset:1024 sc1
    s_add_u32 s88, s88, 2048
    v_mfma_f32_16x16x32_bf16 v[24:27], v[80:83], v[128:131], 0
    ds_read_b128 v[116:119], v3 offset:11264
    v_mfma_f32_16x16x32_bf16 v[52:55], v[80:83], v[132:135], 0
    ds_read_b128 v[120:123], v3 offset:12288
    v_mfma_f32_16x16x32_bf16 v[28:31], v[84:87], v[128:131], 0
    ds_read_b128 v[124:127], v3 offset:13312
    v_mfma_f32_16x16x32_bf16 v[56:59], v[84:87], v[132:135], 0
    v_mfma_f32_16x16x32_bf16 v[32:35], v[88:91], v[128:131], 0
    v_mfma_f32_16x16x32_bf16 v[60:63], v[88:91], v[132:135], 0
    v_mfma_f32_16x16x32_bf16 v[36:39], v[92:95], v[128:131], 0
    s_waitcnt vmcnt(12)
    v_mfma_f32_16x16x32_bf16 v[64:67], v[92:95], v[132:135], 0
    v_swap_b32 v138, v140
    v_mfma_f32_16x16x32_bf16 v[40:43], v[96:99], v[128:131], 0
    v_swap_b32 v139, v141
    v_mfma_f32_16x16x32_bf16 v[68:71], v[96:99], v[132:135], 0
    s_waitcnt lgkmcnt(0)
    v_mfma_f32_16x16x32_bf16 v[16:19], v[100:103], v[136:139], v[16:19]
    ds_read_b128 v[72:75], v3 offset:14336
    buffer_load_dwordx4 v[192:195], v2, s[8:11], s88 offen sc1
    v_mfma_f32_16x16x32_bf16 v[44:47], v[100:103], v[140:143], v[44:47]
    ds_read_b128 v[76:79], v3 offset:15360
    buffer_load_dwordx4 v[196:199], v2, s[8:11], s88 offen offset:1024 sc1
    s_add_u32 s88, s88, 2048
    v_mfma_f32_16x16x32_bf16 v[20:23], v[104:107], v[136:139], v[20:23]
    ds_read_b128 v[80:83], v3 offset:16384
    buffer_load_dwordx4 v[200:203], v2, s[8:11], s88 offen sc1
    v_mfma_f32_16x16x32_bf16 v[48:51], v[104:107], v[140:143], v[48:51]
    ds_read_b128 v[84:87], v3 offset:17408
    buffer_load_dwordx4 v[204:207], v2, s[8:11], s88 offen offset:1024 sc1
    s_add_u32 s88, s88, 2048
    v_mfma_f32_16x16x32_bf16 v[24:27], v[108:111], v[136:139], v[24:27]
    ds_read_b128 v[88:91], v3 offset:18432
    v_mfma_f32_16x16x32_bf16 v[52:55], v[108:111], v[140:143], v[52:55]
    ds_read_b128 v[92:95], v3 offset:19456
    v_mfma_f32_16x16x32_bf16 v[28:31], v[112:115], v[136:139], v[28:31]
    ds_read_b128 v[96:99], v3 offset:20480
    v_mfma_f32_16x16x32_bf16 v[56:59], v[112:115], v[140:143], v[56:59]
    v_mfma_f32_16x16x32_bf16 v[32:35], v[116:119], v[136:139], v[32:35]
    v_mfma_f32_16x16x32_bf16 v[60:63], v[116:119], v[140:143], v[60:63]
    v_mfma_f32_16x16x32_bf16 v[36:39], v[120:123], v[136:139], v[36:39]
    s_waitcnt vmcnt(14)
    v_mfma_f32_16x16x32_bf16 v[64:67], v[120:123], v[140:143], v[64:67]
    v_swap_b32 v146, v148
    v_mfma_f32_16x16x32_bf16 v[40:43], v[124:127], v[136:139], v[40:43]
    v_swap_b32 v147, v149
    v_mfma_f32_16x16x32_bf16 v[68:71], v[124:127], v[140:143], v[68:71]
    s_waitcnt lgkmcnt(0)
    v_mfma_f32_16x16x32_bf16 v[16:19], v[72:75], v[144:147], v[16:19]
    ds_read_b128 v[100:103], v3 offset:21504
    buffer_load_dwordx4 v[128:131], v2, s[8:11], s88 offen sc1
    v_mfma_f32_16x16x32_bf16 v[44:47], v[72:75], v[148:151], v[44:47]
    ds_read_b128 v[104:107], v3 offset:22528
    buffer_load_dwordx4 v[132:135], v2, s[8:11], s88 offen offset:1024 sc1
    s_add_u32 s88, s88, 2048
    v_mfma_f32_16x16x32_bf16 v[20:23], v[76:79], v[144:147], v[20:23]
    ds_read_b128 v[108:111], v3 offset:23552
    buffer_load_dwordx4 v[136:139], v2, s[8:11], s88 offen sc1
    v_mfma_f32_16x16x32_bf16 v[48:51], v[76:79], v[148:151], v[48:51]
    ds_read_b128 v[112:115], v3 offset:24576
    buffer_load_dwordx4 v[140:143], v2, s[8:11], s88 offen offset:1024 sc1
    s_add_u32 s88, s88, 2048
    v_mfma_f32_16x16x32_bf16 v[24:27], v[80:83], v[144:147], v[24:27]
    ds_read_b128 v[116:119], v3 offset:25600
    v_mfma_f32_16x16x32_bf16 v[52:55], v[80:83], v[148:151], v[52:55]
    ds_read_b128 v[120:123], v3 offset:26624
    v_mfma_f32_16x16x32_bf16 v[28:31], v[84:87], v[144:147], v[28:31]
    ds_read_b128 v[124:127], v3 offset:27648
    v_mfma_f32_16x16x32_bf16 v[56:59], v[84:87], v[148:151], v[56:59]
    v_mfma_f32_16x16x32_bf16 v[32:35], v[88:91], v[144:147], v[32:35]
    v_mfma_f32_16x16x32_bf16 v[60:63], v[88:91], v[148:151], v[60:63]
    v_mfma_f32_16x16x32_bf16 v[36:39], v[92:95], v[144:147], v[36:39]
    s_waitcnt vmcnt(16)
    v_mfma_f32_16x16x32_bf16 v[64:67], v[92:95], v[148:151], v[64:67]
    v_swap_b32 v154, v156
    v_mfma_f32_16x16x32_bf16 v[40:43], v[96:99], v[144:147], v[40:43]
    v_swap_b32 v155, v157
    v_mfma_f32_16x16x32_bf16 v[68:71], v[96:99], v[148:151], v[68:71]
    s_waitcnt lgkmcnt(0)
    v_mfma_f32_16x16x32_bf16 v[16:19], v[100:103], v[152:155], v[16:19]
    ds_read_b128 v[72:75], v3 offset:28672
    buffer_load_dwordx4 v[144:147], v2, s[8:11], s88 offen sc1
    v_mfma_f32_16x16x32_bf16 v[44:47], v[100:103], v[156:159], v[44:47]
    ds_read_b128 v[76:79], v3 offset:29696
    buffer_load_dwordx4 v[148:151], v2, s[8:11], s88 offen offset:1024 sc1
    s_add_u32 s88, s88, 2048
    v_mfma_f32_16x16x32_bf16 v[20:23], v[104:107], v[152:155], v[20:23]
    ds_read_b128 v[80:83], v3 offset:30720
    v_mfma_f32_16x16x32_bf16 v[48:51], v[104:107], v[156:159], v[48:51]
    ds_read_b128 v[84:87], v3 offset:31744
    v_mfma_f32_16x16x32_bf16 v[24:27], v[108:111], v[152:155], v[24:27]
    ds_read_b128 v[88:91], v3 offset:32768
    v_mfma_f32_16x16x32_bf16 v[52:55], v[108:111], v[156:159], v[52:55]
    ds_read_b128 v[92:95], v3 offset:33792
    v_mfma_f32_16x16x32_bf16 v[28:31], v[112:115], v[152:155], v[28:31]
    ds_read_b128 v[96:99], v3 offset:34816
    v_mfma_f32_16x16x32_bf16 v[56:59], v[112:115], v[156:159], v[56:59]
    v_mfma_f32_16x16x32_bf16 v[32:35], v[116:119], v[152:155], v[32:35]
    v_mfma_f32_16x16x32_bf16 v[60:63], v[116:119], v[156:159], v[60:63]
    v_mfma_f32_16x16x32_bf16 v[36:39], v[120:123], v[152:155], v[36:39]
    s_waitcnt vmcnt(16)
    v_mfma_f32_16x16x32_bf16 v[64:67], v[120:123], v[156:159], v[64:67]
    v_swap_b32 v162, v164
    v_mfma_f32_16x16x32_bf16 v[40:43], v[124:127], v[152:155], v[40:43]
    v_swap_b32 v163, v165
    v_mfma_f32_16x16x32_bf16 v[68:71], v[124:127], v[156:159], v[68:71]
    s_waitcnt lgkmcnt(0)
    v_mfma_f32_16x16x32_bf16 v[16:19], v[72:75], v[160:163], v[16:19]
    ds_read_b128 v[100:103], v3 offset:35840
    buffer_load_dwordx4 v[152:155], v2, s[8:11], s88 offen sc1
    v_mfma_f32_16x16x32_bf16 v[44:47], v[72:75], v[164:167], v[44:47]
    ds_read_b128 v[104:107], v3 offset:36864
    buffer_load_dwordx4 v[156:159], v2, s[8:11], s88 offen offset:1024 sc1
    s_add_u32 s88, s88, 2048
    v_mfma_f32_16x16x32_bf16 v[20:23], v[76:79], v[160:163], v[20:23]
    ds_read_b128 v[108:111], v3 offset:37888
    v_mfma_f32_16x16x32_bf16 v[48:51], v[76:79], v[164:167], v[48:51]
    ds_read_b128 v[112:115], v3 offset:38912
    v_mfma_f32_16x16x32_bf16 v[24:27], v[80:83], v[160:163], v[24:27]
    ds_read_b128 v[116:119], v3 offset:39936
    v_mfma_f32_16x16x32_bf16 v[52:55], v[80:83], v[164:167], v[52:55]
    ds_read_b128 v[120:123], v3 offset:40960
    v_mfma_f32_16x16x32_bf16 v[28:31], v[84:87], v[160:163], v[28:31]
    ds_read_b128 v[124:127], v3 offset:41984
    v_mfma_f32_16x16x32_bf16 v[56:59], v[84:87], v[164:167], v[56:59]
    v_and_b32 v8, 15, v1
    v_lshrrev_b32 v7, 4, v1
    v_mfma_f32_16x16x32_bf16 v[32:35], v[88:91], v[160:163], v[32:35]
    v_lshlrev_b32 v7, 8, v7
    v_lshl_add_u32 v8, v8, 4, v7
    v_mfma_f32_16x16x32_bf16 v[60:63], v[88:91], v[164:167], v[60:63]
    v_mfma_f32_16x16x32_bf16 v[36:39], v[92:95], v[160:163], v[36:39]
    s_waitcnt vmcnt(16)
    v_mfma_f32_16x16x32_bf16 v[64:67], v[92:95], v[164:167], v[64:67]
    v_swap_b32 v170, v172
    v_mfma_f32_16x16x32_bf16 v[40:43], v[96:99], v[160:163], v[40:43]
    v_swap_b32 v171, v173
    v_mfma_f32_16x16x32_bf16 v[68:71], v[96:99], v[164:167], v[68:71]
    s_waitcnt lgkmcnt(0)
    v_mfma_f32_16x16x32_bf16 v[16:19], v[100:103], v[168:171], v[16:19]
    ds_read_b128 v[72:75], v3 offset:43008
    buffer_load_dwordx4 v[160:163], v2, s[8:11], s88 offen sc1
    v_mfma_f32_16x16x32_bf16 v[44:47], v[100:103], v[172:175], v[44:47]
    ds_read_b128 v[76:79], v3 offset:44032
    buffer_load_dwordx4 v[164:167], v2, s[8:11], s88 offen offset:1024 sc1
    s_add_u32 s88, s88, 2048
    v_mfma_f32_16x16x32_bf16 v[20:23], v[104:107], v[168:171], v[20:23]
    ds_read_b128 v[80:83], v3 offset:45056
    v_mfma_f32_16x16x32_bf16 v[48:51], v[104:107], v[172:175], v[48:51]
    ds_read_b128 v[84:87], v3 offset:46080
    v_mfma_f32_16x16x32_bf16 v[24:27], v[108:111], v[168:171], v[24:27]
    ds_read_b128 v[88:91], v3 offset:47104
    buffer_load_dwordx4 a[0:3], v2, s[8:11], s86 offen offset:0 sc1
    v_mfma_f32_16x16x32_bf16 v[52:55], v[108:111], v[172:175], v[52:55]
    ds_read_b128 v[92:95], v3 offset:48128
    buffer_load_dwordx4 v[208:211], v8, s[8:11], s89 offen offset:0 sc1
    v_mfma_f32_16x16x32_bf16 v[28:31], v[112:115], v[168:171], v[28:31]
    ds_read_b128 v[96:99], v3 offset:49152
    buffer_load_dwordx4 a[4:7], v2, s[8:11], s86 offen offset:1024 sc1
    buffer_load_dwordx4 v[212:215], v8, s[8:11], s89 offen offset:1024 sc1
    v_mfma_f32_16x16x32_bf16 v[56:59], v[112:115], v[172:175], v[56:59]
    buffer_load_dwordx4 v[216:219], v8, s[8:11], s89 offen offset:2048 sc1
    v_mfma_f32_16x16x32_bf16 v[32:35], v[116:119], v[168:171], v[32:35]
    buffer_load_dwordx4 a[8:11], v2, s[8:11], s87 offen offset:0 sc1
    buffer_load_dwordx4 v[220:223], v8, s[8:11], s89 offen offset:3072 sc1
    v_mfma_f32_16x16x32_bf16 v[60:63], v[116:119], v[172:175], v[60:63]
    buffer_load_dwordx4 a[12:15], v2, s[8:11], s87 offen offset:1024 sc1
    v_mfma_f32_16x16x32_bf16 v[36:39], v[120:123], v[168:171], v[36:39]
    s_waitcnt vmcnt(24)
    v_mfma_f32_16x16x32_bf16 v[64:67], v[120:123], v[172:175], v[64:67]
    v_swap_b32 v178, v180
    v_mfma_f32_16x16x32_bf16 v[40:43], v[124:127], v[168:171], v[40:43]
    v_swap_b32 v179, v181
    v_mfma_f32_16x16x32_bf16 v[68:71], v[124:127], v[172:175], v[68:71]
    s_waitcnt lgkmcnt(0)
    v_mfma_f32_16x16x32_bf16 v[16:19], v[72:75], v[176:179], v[16:19]
    ds_read_b128 v[100:103], v3 offset:50176
    buffer_load_dwordx4 v[168:171], v2, s[8:11], s88 offen sc1
    v_mfma_f32_16x16x32_bf16 v[44:47], v[72:75], v[180:183], v[44:47]
    ds_read_b128 v[104:107], v3 offset:51200
    buffer_load_dwordx4 v[172:175], v2, s[8:11], s88 offen offset:1024 sc1
    s_add_u32 s88, s88, 2048
    v_mfma_f32_16x16x32_bf16 v[20:23], v[76:79], v[176:179], v[20:23]
    ds_read_b128 v[108:111], v3 offset:52224
    v_mfma_f32_16x16x32_bf16 v[48:51], v[76:79], v[180:183], v[48:51]
    ds_read_b128 v[112:115], v3 offset:53248
    v_mfma_f32_16x16x32_bf16 v[24:27], v[80:83], v[176:179], v[24:27]
    ds_read_b128 v[116:119], v3 offset:54272
    buffer_load_dwordx4 a[16:19], v2, s[8:11], s87 offen offset:2048 sc1
    s_add_u32 s86, s86, 5120
    s_add_u32 s87, s87, 5120
    v_mfma_f32_16x16x32_bf16 v[52:55], v[80:83], v[180:183], v[52:55]
    ds_read_b128 v[120:123], v3 offset:55296
    v_mfma_f32_16x16x32_bf16 v[28:31], v[84:87], v[176:179], v[28:31]
    ds_read_b128 v[124:127], v3 offset:56320
    buffer_load_dwordx4 a[20:23], v2, s[8:11], s86 offen offset:0 sc1
    v_mfma_f32_16x16x32_bf16 v[56:59], v[84:87], v[180:183], v[56:59]
    v_mfma_f32_16x16x32_bf16 v[32:35], v[88:91], v[176:179], v[32:35]
    buffer_load_dwordx4 a[24:27], v2, s[8:11], s86 offen offset:1024 sc1
    v_mfma_f32_16x16x32_bf16 v[60:63], v[88:91], v[180:183], v[60:63]
    buffer_load_dwordx4 a[28:31], v2, s[8:11], s87 offen offset:0 sc1
    v_mfma_f32_16x16x32_bf16 v[36:39], v[92:95], v[176:179], v[36:39]
    s_waitcnt vmcnt(28)
    v_mfma_f32_16x16x32_bf16 v[64:67], v[92:95], v[180:183], v[64:67]
    v_swap_b32 v186, v188
    v_mfma_f32_16x16x32_bf16 v[40:43], v[96:99], v[176:179], v[40:43]
    v_swap_b32 v187, v189
    v_mfma_f32_16x16x32_bf16 v[68:71], v[96:99], v[180:183], v[68:71]
    s_waitcnt lgkmcnt(0)
    v_mfma_f32_16x16x32_bf16 v[16:19], v[100:103], v[184:187], v[16:19]
    ds_read_b128 v[72:75], v3 offset:57344
    buffer_load_dwordx4 v[176:179], v2, s[8:11], s88 offen sc1
    v_mfma_f32_16x16x32_bf16 v[44:47], v[100:103], v[188:191], v[44:47]
    ds_read_b128 v[76:79], v3 offset:58368
    buffer_load_dwordx4 v[180:183], v2, s[8:11], s88 offen offset:1024 sc1
    s_add_u32 s88, s88, 2048
    v_mfma_f32_16x16x32_bf16 v[20:23], v[104:107], v[184:187], v[20:23]
    ds_read_b128 v[80:83], v3 offset:59392
    v_mfma_f32_16x16x32_bf16 v[48:51], v[104:107], v[188:191], v[48:51]
    ds_read_b128 v[84:87], v3 offset:60416
    v_mfma_f32_16x16x32_bf16 v[24:27], v[108:111], v[184:187], v[24:27]
    ds_read_b128 v[88:91], v3 offset:61440
    buffer_load_dwordx4 a[32:35], v2, s[8:11], s87 offen offset:1024 sc1
    v_mfma_f32_16x16x32_bf16 v[52:55], v[108:111], v[188:191], v[52:55]
    ds_read_b128 v[92:95], v3 offset:62464
    v_mfma_f32_16x16x32_bf16 v[28:31], v[112:115], v[184:187], v[28:31]
    ds_read_b128 v[96:99], v3 offset:63488
    buffer_load_dwordx4 a[36:39], v2, s[8:11], s87 offen offset:2048 sc1
    s_add_u32 s86, s86, 5120
    s_add_u32 s87, s87, 5120
    v_mfma_f32_16x16x32_bf16 v[56:59], v[112:115], v[188:191], v[56:59]
    v_mfma_f32_16x16x32_bf16 v[32:35], v[116:119], v[184:187], v[32:35]
    buffer_load_dwordx4 a[40:43], v2, s[8:11], s86 offen offset:0 sc1
    v_mfma_f32_16x16x32_bf16 v[60:63], v[116:119], v[188:191], v[60:63]
    buffer_load_dwordx4 a[44:47], v2, s[8:11], s86 offen offset:1024 sc1
    v_mfma_f32_16x16x32_bf16 v[36:39], v[120:123], v[184:187], v[36:39]
    s_waitcnt vmcnt(32)
    v_mfma_f32_16x16x32_bf16 v[64:67], v[120:123], v[188:191], v[64:67]
    v_swap_b32 v194, v196
    v_mfma_f32_16x16x32_bf16 v[40:43], v[124:127], v[184:187], v[40:43]
    v_swap_b32 v195, v197
    v_mfma_f32_16x16x32_bf16 v[68:71], v[124:127], v[188:191], v[68:71]
    s_waitcnt vmcnt(12)
    s_waitcnt lgkmcnt(0)
    v_mfma_f32_16x16x32_bf16 v[16:19], v[72:75], v[192:195], v[16:19]
    ds_read_b128 v[100:103], v4 offset:0
    buffer_load_dwordx4 v[184:187], v2, s[8:11], s88 offen sc1
    v_mfma_f32_16x16x32_bf16 v[44:47], v[72:75], v[196:199], v[44:47]
    ds_read_b128 v[104:107], v4 offset:1024
    buffer_load_dwordx4 v[188:191], v2, s[8:11], s88 offen offset:1024 sc1
    s_add_u32 s88, s88, 2048
    v_max3_u32 v11, v208, v209, v210
    v_mfma_f32_16x16x32_bf16 v[20:23], v[76:79], v[192:195], v[20:23]
    ds_read_b128 v[108:111], v4 offset:2048
    v_max3_u32 v11, v11, v211, v212
    v_mfma_f32_16x16x32_bf16 v[48:51], v[76:79], v[196:199], v[48:51]
    ds_read_b128 v[112:115], v4 offset:3072
    v_max3_u32 v11, v11, v213, v214
    v_mfma_f32_16x16x32_bf16 v[24:27], v[80:83], v[192:195], v[24:27]
    ds_read_b128 v[116:119], v4 offset:4096
    buffer_load_dwordx4 a[48:51], v2, s[8:11], s87 offen offset:0 sc1
    v_max3_u32 v11, v11, v215, v216
    v_mfma_f32_16x16x32_bf16 v[52:55], v[80:83], v[196:199], v[52:55]
    ds_read_b128 v[120:123], v4 offset:5120
    v_max3_u32 v11, v11, v217, v218
    v_mfma_f32_16x16x32_bf16 v[28:31], v[84:87], v[192:195], v[28:31]
    ds_read_b128 v[124:127], v4 offset:6144
    buffer_load_dwordx4 a[52:55], v2, s[8:11], s87 offen offset:1024 sc1
    v_max3_u32 v11, v11, v219, v220
    v_mfma_f32_16x16x32_bf16 v[56:59], v[84:87], v[196:199], v[56:59]
    v_max3_u32 v11, v11, v221, v222
    v_mfma_f32_16x16x32_bf16 v[32:35], v[88:91], v[192:195], v[32:35]
    buffer_load_dwordx4 a[56:59], v2, s[8:11], s87 offen offset:2048 sc1
    s_add_u32 s86, s86, 5120
    s_add_u32 s87, s87, 5120
    v_max_u32 v11, v11, v223
    v_mfma_f32_16x16x32_bf16 v[60:63], v[88:91], v[196:199], v[60:63]
    buffer_load_dwordx4 a[60:63], v2, s[8:11], s86 offen offset:0 sc1
    v_cmp_eq_u32 vcc, -1, v11
    v_mfma_f32_16x16x32_bf16 v[36:39], v[92:95], v[192:195], v[36:39]
    s_waitcnt vmcnt(36)
    v_mfma_f32_16x16x32_bf16 v[64:67], v[92:95], v[196:199], v[64:67]
    v_swap_b32 v202, v204
    v_mfma_f32_16x16x32_bf16 v[40:43], v[96:99], v[192:195], v[40:43]
    v_swap_b32 v203, v205
    v_mfma_f32_16x16x32_bf16 v[68:71], v[96:99], v[196:199], v[68:71]
    s_cbranch_vccnz L_g1l0_gstub
L_g1l0_gok:
    s_waitcnt lgkmcnt(0)
    v_mfma_f32_16x16x32_bf16 v[16:19], v[100:103], v[200:203], v[16:19]
    ds_read_b128 v[72:75], v4 offset:7168
    buffer_load_dwordx4 v[192:195], v2, s[8:11], s88 offen sc1
    v_add_f32 v208, v208, v212
    v_mfma_f32_16x16x32_bf16 v[44:47], v[100:103], v[204:207], v[44:47]
    ds_read_b128 v[76:79], v4 offset:8192
    buffer_load_dwordx4 v[196:199], v2, s[8:11], s88 offen offset:1024 sc1
    s_add_u32 s88, s88, 2048
    v_add_f32 v209, v209, v213
    v_mfma_f32_16x16x32_bf16 v[20:23], v[104:107], v[200:203], v[20:23]
    ds_read_b128 v[80:83], v4 offset:9216
    v_add_f32 v210, v210, v214
    v_mfma_f32_16x16x32_bf16 v[48:51], v[104:107], v[204:207], v[48:51]
    ds_read_b128 v[84:87], v4 offset:10240
    v_add_f32 v211, v211, v215
    v_mfma_f32_16x16x32_bf16 v[24:27], v[108:111], v[200:203], v[24:27]
    ds_read_b128 v[88:91], v4 offset:11264
    buffer_load_dwordx4 a[64:67], v2, s[8:11], s86 offen offset:1024 sc1
    v_add_f32 v208, v208, v216
    v_mfma_f32_16x16x32_bf16 v[52:55], v[108:111], v[204:207], v[52:55]
    ds_read_b128 v[92:95], v4 offset:12288
    v_add_f32 v209, v209, v217
    v_mfma_f32_16x16x32_bf16 v[28:31], v[112:115], v[200:203], v[28:31]
    ds_read_b128 v[96:99], v4 offset:13312
    buffer_load_dwordx4 a[68:71], v2, s[8:11], s87 offen offset:0 sc1
    v_add_f32 v210, v210, v218
    v_mfma_f32_16x16x32_bf16 v[56:59], v[112:115], v[204:207], v[56:59]
    v_add_f32 v211, v211, v219
    v_mfma_f32_16x16x32_bf16 v[32:35], v[116:119], v[200:203], v[32:35]
    buffer_load_dwordx4 a[72:75], v2, s[8:11], s87 offen offset:1024 sc1
    v_add_f32 v208, v208, v220
    v_mfma_f32_16x16x32_bf16 v[60:63], v[116:119], v[204:207], v[60:63]
    buffer_load_dwordx4 a[76:79], v2, s[8:11], s87 offen offset:2048 sc1
    s_add_u32 s86, s86, 5120
    s_add_u32 s87, s87, 5120
    v_add_f32 v209, v209, v221
    v_mfma_f32_16x16x32_bf16 v[36:39], v[120:123], v[200:203], v[36:39]
    s_waitcnt vmcnt(40)
    v_add_f32 v210, v210, v222
    v_mfma_f32_16x16x32_bf16 v[64:67], v[120:123], v[204:207], v[64:67]
    v_swap_b32 v130, v132
    v_add_f32 v211, v211, v223
    v_mfma_f32_16x16x32_bf16 v[40:43], v[124:127], v[200:203], v[40:43]
    v_swap_b32 v131, v133
    v_mov_b32 v6, v208
    v_mfma_f32_16x16x32_bf16 v[68:71], v[124:127], v[204:207], v[68:71]
    s_waitcnt lgkmcnt(0)
    v_mfma_f32_16x16x32_bf16 v[16:19], v[72:75], v[128:131], v[16:19]
    ds_read_b128 v[100:103], v4 offset:14336
    buffer_load_dwordx4 v[200:203], v2, s[8:11], s88 offen sc1
    v_mov_b32 v7, v209
    v_mfma_f32_16x16x32_bf16 v[44:47], v[72:75], v[132:135], v[44:47]
    ds_read_b128 v[104:107], v4 offset:15360
    buffer_load_dwordx4 v[204:207], v2, s[8:11], s88 offen offset:1024 sc1
    s_add_u32 s88, s88, 2048
    v_mov_b32 v8, v210
    v_mfma_f32_16x16x32_bf16 v[20:23], v[76:79], v[128:131], v[20:23]
    ds_read_b128 v[108:111], v4 offset:16384
    v_mov_b32 v9, v211
    v_mfma_f32_16x16x32_bf16 v[48:51], v[76:79], v[132:135], v[48:51]
    ds_read_b128 v[112:115], v4 offset:17408
    s_nop 0
    v_mfma_f32_16x16x32_bf16 v[24:27], v[80:83], v[128:131], v[24:27]
    ds_read_b128 v[116:119], v4 offset:18432
    buffer_load_dwordx4 a[80:83], v2, s[8:11], s86 offen offset:0 sc1
    v_permlane32_swap_b32 v208, v6
    v_mfma_f32_16x16x32_bf16 v[52:55], v[80:83], v[132:135], v[52:55]
    ds_read_b128 v[120:123], v4 offset:19456
    v_permlane32_swap_b32 v209, v7
    v_mfma_f32_16x16x32_bf16 v[28:31], v[84:87], v[128:131], v[28:31]
    ds_read_b128 v[124:127], v4 offset:20480
    buffer_load_dwordx4 a[84:87], v2, s[8:11], s86 offen offset:1024 sc1
    v_permlane32_swap_b32 v210, v8
    v_mfma_f32_16x16x32_bf16 v[56:59], v[84:87], v[132:135], v[56:59]
    v_permlane32_swap_b32 v211, v9
    v_mfma_f32_16x16x32_bf16 v[32:35], v[88:91], v[128:131], v[32:35]
    buffer_load_dwordx4 a[88:91], v2, s[8:11], s87 offen offset:0 sc1
    v_add_f32 v208, v208, v6
    v_mfma_f32_16x16x32_bf16 v[60:63], v[88:91], v[132:135], v[60:63]
    buffer_load_dwordx4 a[92:95], v2, s[8:11], s87 offen offset:1024 sc1
    v_lshrrev_b32 v10, 4, v1
    v_lshlrev_b32 v10, 4, v10
    v_add_f32 v209, v209, v7
    v_mfma_f32_16x16x32_bf16 v[36:39], v[92:95], v[128:131], v[36:39]
    s_waitcnt vmcnt(44)
    v_add_f32 v210, v210, v8
    v_mfma_f32_16x16x32_bf16 v[64:67], v[92:95], v[132:135], v[64:67]
    v_swap_b32 v138, v140
    v_add_f32 v211, v211, v9
    v_mfma_f32_16x16x32_bf16 v[40:43], v[96:99], v[128:131], v[40:43]
    v_swap_b32 v139, v141
    v_mov_b32 v6, v208
    v_mfma_f32_16x16x32_bf16 v[68:71], v[96:99], v[132:135], v[68:71]
    s_waitcnt lgkmcnt(0)
    v_mfma_f32_16x16x32_bf16 v[16:19], v[100:103], v[136:139], v[16:19]
    ds_read_b128 v[72:75], v4 offset:21504
    v_mov_b32 v7, v209
    v_mfma_f32_16x16x32_bf16 v[44:47], v[100:103], v[140:143], v[44:47]
    ds_read_b128 v[76:79], v4 offset:22528
    v_mov_b32 v8, v210
    v_mfma_f32_16x16x32_bf16 v[20:23], v[104:107], v[136:139], v[20:23]
    ds_read_b128 v[80:83], v4 offset:23552
    v_mov_b32 v9, v211
    v_mfma_f32_16x16x32_bf16 v[48:51], v[104:107], v[140:143], v[48:51]
    ds_read_b128 v[84:87], v4 offset:24576
    s_nop 0
    v_mfma_f32_16x16x32_bf16 v[24:27], v[108:111], v[136:139], v[24:27]
    ds_read_b128 v[88:91], v4 offset:25600
    buffer_load_dwordx4 a[96:99], v2, s[8:11], s87 offen offset:2048 sc1
    s_add_u32 s86, s86, 5120
    s_add_u32 s87, s87, 5120
    v_permlane16_swap_b32 v208, v6
    v_mfma_f32_16x16x32_bf16 v[52:55], v[108:111], v[140:143], v[52:55]
    ds_read_b128 v[92:95], v4 offset:26624
    v_permlane16_swap_b32 v209, v7
    v_mfma_f32_16x16x32_bf16 v[28:31], v[112:115], v[136:139], v[28:31]
    ds_read_b128 v[96:99], v4 offset:27648
    buffer_load_dwordx4 a[100:103], v2, s[8:11], s86 offen offset:0 sc1
    v_mfma_f32_16x16x32_bf16 v[56:59], v[112:115], v[140:143], v[56:59]
    buffer_load_dwordx4 v[128:131], v10, s[8:11], s64 offen offset:0 sc1
    v_permlane16_swap_b32 v210, v8
    v_mfma_f32_16x16x32_bf16 v[32:35], v[116:119], v[136:139], v[32:35]
    buffer_load_dwordx4 a[104:107], v2, s[8:11], s86 offen offset:1024 sc1
    buffer_load_dwordx4 v[132:135], v10, s[8:11], s64 offen offset:64 sc1
    v_permlane16_swap_b32 v211, v9
    v_mfma_f32_16x16x32_bf16 v[60:63], v[116:119], v[140:143], v[60:63]
    buffer_load_dwordx4 a[108:111], v2, s[8:11], s87 offen offset:0 sc1
    v_add_f32 v208, v208, v6
    v_mfma_f32_16x16x32_bf16 v[36:39], v[120:123], v[136:139], v[36:39]
    s_waitcnt vmcnt(48)
    v_add_f32 v209, v209, v7
    v_mfma_f32_16x16x32_bf16 v[64:67], v[120:123], v[140:143], v[64:67]
    v_swap_b32 v146, v148
    v_add_f32 v210, v210, v8
    v_mfma_f32_16x16x32_bf16 v[40:43], v[124:127], v[136:139], v[40:43]
    v_swap_b32 v147, v149
    v_add_f32 v211, v211, v9
    v_mfma_f32_16x16x32_bf16 v[68:71], v[124:127], v[140:143], v[68:71]
    s_waitcnt lgkmcnt(0)
    v_mfma_f32_16x16x32_bf16 v[16:19], v[72:75], v[144:147], v[16:19]
    ds_read_b128 v[100:103], v5 offset:0
    v_mul_f32 v224, 0x3acccccd, v208
    v_mfma_f32_16x16x32_bf16 v[44:47], v[72:75], v[148:151], v[44:47]
    ds_read_b128 v[104:107], v5 offset:7168
    v_mul_f32 v209, 0x3acccccd, v209
    v_mfma_f32_16x16x32_bf16 v[20:23], v[76:79], v[144:147], v[20:23]
    ds_read_b128 v[108:111], v5 offset:14336
    v_mul_f32 v226, 0x3acccccd, v210
    v_mfma_f32_16x16x32_bf16 v[48:51], v[76:79], v[148:151], v[48:51]
    ds_read_b128 v[112:115], v5 offset:21504
    v_mul_f32 v211, 0x3acccccd, v211
    v_mfma_f32_16x16x32_bf16 v[24:27], v[80:83], v[144:147], v[24:27]
    ds_read_b128 v[116:119], v5 offset:28672
    buffer_load_dwordx4 a[112:115], v2, s[8:11], s87 offen offset:1024 sc1
    v_fma_f32 v209, -v224, v224, v209
    v_mfma_f32_16x16x32_bf16 v[52:55], v[80:83], v[148:151], v[52:55]
    ds_read_b128 v[120:123], v5 offset:35840
    v_fma_f32 v211, -v226, v226, v211
    v_mfma_f32_16x16x32_bf16 v[28:31], v[84:87], v[144:147], v[28:31]
    ds_read_b128 v[124:127], v5 offset:43008
    buffer_load_dwordx4 a[116:119], v2, s[8:11], s87 offen offset:2048 sc1
    s_add_u32 s86, s86, 5120
    s_add_u32 s87, s87, 5120
    v_mfma_f32_16x16x32_bf16 v[56:59], v[84:87], v[148:151], v[56:59]
    buffer_load_dwordx4 v[136:139], v10, s[8:11], s64 offen offset:128 sc1
    v_max_f32 v209, 0, v209
    v_mfma_f32_16x16x32_bf16 v[32:35], v[88:91], v[144:147], v[32:35]
    buffer_load_dwordx4 a[120:123], v2, s[8:11], s86 offen offset:0 sc1
    buffer_load_dwordx4 v[140:143], v10, s[8:11], s64 offen offset:192 sc1
    v_add_f32 v209, 0x3727c5ac, v209
    v_mfma_f32_16x16x32_bf16 v[60:63], v[88:91], v[148:151], v[60:63]
    buffer_load_dwordx4 a[124:127], v2, s[8:11], s86 offen offset:1024 sc1
    v_max_f32 v211, 0, v211
    v_mfma_f32_16x16x32_bf16 v[36:39], v[92:95], v[144:147], v[36:39]
    v_add_f32 v211, 0x3727c5ac, v211
    s_waitcnt vmcnt(34)
    v_swap_b32 v154, v156
    v_swap_b32 v155, v157
    v_mfma_f32_16x16x32_bf16 v[64:67], v[92:95], v[148:151], v[64:67]
    v_rsq_f32 v225, v209
    v_swap_b32 v162, v164
    v_swap_b32 v163, v165
    v_mfma_f32_16x16x32_bf16 v[40:43], v[96:99], v[144:147], v[40:43]
    v_rsq_f32 v227, v211
    v_swap_b32 v170, v172
    v_swap_b32 v171, v173
    v_mfma_f32_16x16x32_bf16 v[68:71], v[96:99], v[148:151], v[68:71]
    v_swap_b32 v178, v180
    v_swap_b32 v179, v181
    s_waitcnt lgkmcnt(0)
    v_mfma_f32_16x16x32_bf16 v[16:19], v[100:103], v[152:155], v[16:19]
    ds_read_b128 v[72:75], v5 offset:1024
    v_mfma_f32_16x16x32_bf16 v[44:47], v[100:103], v[156:159], v[44:47]
    ds_read_b128 v[76:79], v5 offset:8192
    ds_read_b128 v[100:103], v5 offset:2048
    v_mfma_f32_16x16x32_bf16 v[16:19], v[104:107], v[160:163], v[16:19]
    ds_read_b128 v[80:83], v5 offset:15360
    v_mfma_f32_16x16x32_bf16 v[44:47], v[104:107], v[164:167], v[44:47]
    s_waitcnt vmcnt(16)
    v_swap_b32 v186, v188
    v_swap_b32 v187, v189
    ds_read_b128 v[84:87], v5 offset:22528
    ds_read_b128 v[104:107], v5 offset:9216
    v_mfma_f32_16x16x32_bf16 v[16:19], v[108:111], v[168:171], v[16:19]
    v_swap_b32 v194, v196
    v_swap_b32 v195, v197
    ds_read_b128 v[88:91], v5 offset:29696
    v_mfma_f32_16x16x32_bf16 v[44:47], v[108:111], v[172:175], v[44:47]
    v_swap_b32 v202, v204
    v_swap_b32 v203, v205
    ds_read_b128 v[92:95], v5 offset:36864
    ds_read_b128 v[108:111], v5 offset:16384
    v_mfma_f32_16x16x32_bf16 v[16:19], v[112:115], v[176:179], v[16:19]
    ds_read_b128 v[96:99], v5 offset:44032
    v_mfma_f32_16x16x32_bf16 v[44:47], v[112:115], v[180:183], v[44:47]
    buffer_load_dwordx4 v[144:147], v10, s[8:11], s64 offen offset:256 sc1
    ds_read_b128 v[112:115], v5 offset:23552
    v_mfma_f32_16x16x32_bf16 v[16:19], v[116:119], v[184:187], v[16:19]
    buffer_load_dwordx4 v[148:151], v10, s[8:11], s64 offen offset:320 sc1
    v_mfma_f32_16x16x32_bf16 v[44:47], v[116:119], v[188:191], v[44:47]
    buffer_load_dwordx4 v[208:211], v10, s[8:11], s64 offen offset:384 sc1
    ds_read_b128 v[116:119], v5 offset:30720
    v_mfma_f32_16x16x32_bf16 v[16:19], v[120:123], v[192:195], v[16:19]
    buffer_load_dwordx4 a[128:131], v2, s[8:11], s87 offen offset:0 sc1
    v_mfma_f32_16x16x32_bf16 v[44:47], v[120:123], v[196:199], v[44:47]
    ds_read_b128 v[120:123], v5 offset:37888
    buffer_load_dwordx4 a[132:135], v2, s[8:11], s87 offen offset:1024 sc1
    v_mfma_f32_16x16x32_bf16 v[16:19], v[124:127], v[200:203], v[16:19]
    buffer_load_dwordx4 a[136:139], v2, s[8:11], s87 offen offset:2048 sc1
    s_add_u32 s86, s86, 5120
    s_add_u32 s87, s87, 5120
    v_mfma_f32_16x16x32_bf16 v[44:47], v[124:127], v[204:207], v[44:47]
    ds_read_b128 v[124:127], v5 offset:45056
    buffer_load_dwordx4 a[140:143], v2, s[8:11], s86 offen offset:0 sc1
    s_waitcnt lgkmcnt(4)
    v_mfma_f32_16x16x32_bf16 v[20:23], v[72:75], v[152:155], v[20:23]
    v_mfma_f32_16x16x32_bf16 v[48:51], v[72:75], v[156:159], v[48:51]
    ds_read_b128 v[72:75], v5 offset:3072
    v_mfma_f32_16x16x32_bf16 v[20:23], v[76:79], v[160:163], v[20:23]
    s_waitcnt vmcnt(14)
    v_mfma_f32_16x16x32_bf16 v[48:51], v[76:79], v[164:167], v[48:51]
    ds_read_b128 v[76:79], v5 offset:10240
    v_fma_f32 v16, -v224, v128, v16
    v_fma_f32 v17, -v224, v129, v17
    v_fma_f32 v18, -v224, v130, v18
    v_mfma_f32_16x16x32_bf16 v[20:23], v[80:83], v[168:171], v[20:23]
    v_fma_f32 v19, -v224, v131, v19
    v_mul_f32 v16, v225, v16
    v_mfma_f32_16x16x32_bf16 v[48:51], v[80:83], v[172:175], v[48:51]
    ds_read_b128 v[80:83], v5 offset:17408
    v_mul_f32 v17, v225, v17
    v_mul_f32 v18, v225, v18
    v_mfma_f32_16x16x32_bf16 v[20:23], v[84:87], v[176:179], v[20:23]
    v_mul_f32 v19, v225, v19
    v_cvt_pk_bf16_f32 v228, v16, v17
    v_cvt_pk_bf16_f32 v229, v18, v19
    v_mfma_f32_16x16x32_bf16 v[48:51], v[84:87], v[180:183], v[48:51]
    ds_read_b128 v[84:87], v5 offset:24576
    v_pk_max_i16 v228, v228, 0
    v_pk_max_i16 v229, v229, 0
    v_mfma_f32_16x16x32_bf16 v[20:23], v[88:91], v[184:187], v[20:23]
    v_fma_f32 v44, -v226, v128, v44
    v_fma_f32 v45, -v226, v129, v45
    v_mfma_f32_16x16x32_bf16 v[48:51], v[88:91], v[188:191], v[48:51]
    ds_read_b128 v[88:91], v5 offset:31744
    v_fma_f32 v46, -v226, v130, v46
    v_fma_f32 v47, -v226, v131, v47
    v_mfma_f32_16x16x32_bf16 v[20:23], v[92:95], v[192:195], v[20:23]
    buffer_load_dwordx4 a[144:147], v2, s[8:11], s86 offen offset:1024 sc1
    v_mul_f32 v44, v227, v44
    v_mul_f32 v45, v227, v45
    v_mul_f32 v46, v227, v46
    v_mfma_f32_16x16x32_bf16 v[48:51], v[92:95], v[196:199], v[48:51]
    ds_read_b128 v[92:95], v5 offset:38912
    buffer_load_dwordx4 a[148:151], v2, s[8:11], s87 offen offset:0 sc1
    v_mul_f32 v47, v227, v47
    v_cvt_pk_bf16_f32 v230, v44, v45
    v_mfma_f32_16x16x32_bf16 v[20:23], v[96:99], v[200:203], v[20:23]
    buffer_load_dwordx4 a[152:155], v2, s[8:11], s87 offen offset:1024 sc1
    v_cvt_pk_bf16_f32 v231, v46, v47
    v_pk_max_i16 v230, v230, 0
    v_mfma_f32_16x16x32_bf16 v[48:51], v[96:99], v[204:207], v[48:51]
    ds_read_b128 v[96:99], v5 offset:46080
    buffer_load_dwordx4 a[156:159], v2, s[8:11], s87 offen offset:2048 sc1
    s_add_u32 s86, s86, 5120
    s_add_u32 s87, s87, 5120
    v_pk_max_i16 v231, v231, 0
    buffer_store_dwordx4 v[228:231], v2, s[8:11], s62 offen offset:0 sc1
    s_waitcnt lgkmcnt(7)
    v_mfma_f32_16x16x32_bf16 v[24:27], v[100:103], v[152:155], v[24:27]
    v_mfma_f32_16x16x32_bf16 v[52:55], v[100:103], v[156:159], v[52:55]
    ds_read_b128 v[100:103], v5 offset:4096
    v_mfma_f32_16x16x32_bf16 v[24:27], v[104:107], v[160:163], v[24:27]
    s_waitcnt vmcnt(18)
    v_mfma_f32_16x16x32_bf16 v[52:55], v[104:107], v[164:167], v[52:55]
    ds_read_b128 v[104:107], v5 offset:11264
    v_fma_f32 v20, -v224, v132, v20
    v_fma_f32 v21, -v224, v133, v21
    v_fma_f32 v22, -v224, v134, v22
    v_mfma_f32_16x16x32_bf16 v[24:27], v[108:111], v[168:171], v[24:27]
    v_fma_f32 v23, -v224, v135, v23
    v_mul_f32 v20, v225, v20
    v_mfma_f32_16x16x32_bf16 v[52:55], v[108:111], v[172:175], v[52:55]
    ds_read_b128 v[108:111], v5 offset:18432
    v_mul_f32 v21, v225, v21
    v_mul_f32 v22, v225, v22
    v_mfma_f32_16x16x32_bf16 v[24:27], v[112:115], v[176:179], v[24:27]
    v_mul_f32 v23, v225, v23
    v_cvt_pk_bf16_f32 v228, v20, v21
    v_cvt_pk_bf16_f32 v229, v22, v23
    v_mfma_f32_16x16x32_bf16 v[52:55], v[112:115], v[180:183], v[52:55]
    ds_read_b128 v[112:115], v5 offset:25600
    v_pk_max_i16 v228, v228, 0
    v_pk_max_i16 v229, v229, 0
    v_mfma_f32_16x16x32_bf16 v[24:27], v[116:119], v[184:187], v[24:27]
    v_fma_f32 v48, -v226, v132, v48
    v_fma_f32 v49, -v226, v133, v49
    v_mfma_f32_16x16x32_bf16 v[52:55], v[116:119], v[188:191], v[52:55]
    ds_read_b128 v[116:119], v5 offset:32768
    v_fma_f32 v50, -v226, v134, v50
    v_fma_f32 v51, -v226, v135, v51
    v_mfma_f32_16x16x32_bf16 v[24:27], v[120:123], v[192:195], v[24:27]
    buffer_load_dwordx4 a[160:163], v2, s[8:11], s86 offen offset:0 sc1
    v_mul_f32 v48, v227, v48
    v_mul_f32 v49, v227, v49
    v_mul_f32 v50, v227, v50
    v_mfma_f32_16x16x32_bf16 v[52:55], v[120:123], v[196:199], v[52:55]
    ds_read_b128 v[120:123], v5 offset:39936
    buffer_load_dwordx4 a[164:167], v2, s[8:11], s86 offen offset:1024 sc1
    v_mul_f32 v51, v227, v51
    v_cvt_pk_bf16_f32 v230, v48, v49
    v_mfma_f32_16x16x32_bf16 v[24:27], v[124:127], v[200:203], v[24:27]
    buffer_load_dwordx4 a[168:171], v2, s[8:11], s87 offen offset:0 sc1
    v_cvt_pk_bf16_f32 v231, v50, v51
    v_pk_max_i16 v230, v230, 0
    v_mfma_f32_16x16x32_bf16 v[52:55], v[124:127], v[204:207], v[52:55]
    ds_read_b128 v[124:127], v5 offset:47104
    buffer_load_dwordx4 a[172:175], v2, s[8:11], s87 offen offset:1024 sc1
    v_pk_max_i16 v231, v231, 0
    buffer_store_dwordx4 v[228:231], v2, s[8:11], s62 offen offset:1024 sc1
    s_waitcnt lgkmcnt(7)
    v_mfma_f32_16x16x32_bf16 v[28:31], v[72:75], v[152:155], v[28:31]
    v_mfma_f32_16x16x32_bf16 v[56:59], v[72:75], v[156:159], v[56:59]
    ds_read_b128 v[72:75], v5 offset:5120
    v_mfma_f32_16x16x32_bf16 v[28:31], v[76:79], v[160:163], v[28:31]
    s_waitcnt vmcnt(18)
    v_mfma_f32_16x16x32_bf16 v[56:59], v[76:79], v[164:167], v[56:59]
    ds_read_b128 v[76:79], v5 offset:12288
    v_fma_f32 v24, -v224, v136, v24
    v_fma_f32 v25, -v224, v137, v25
    v_fma_f32 v26, -v224, v138, v26
    v_mfma_f32_16x16x32_bf16 v[28:31], v[80:83], v[168:171], v[28:31]
    v_fma_f32 v27, -v224, v139, v27
    v_mul_f32 v24, v225, v24
    v_mfma_f32_16x16x32_bf16 v[56:59], v[80:83], v[172:175], v[56:59]
    ds_read_b128 v[80:83], v5 offset:19456
    v_mul_f32 v25, v225, v25
    v_mul_f32 v26, v225, v26
    v_mfma_f32_16x16x32_bf16 v[28:31], v[84:87], v[176:179], v[28:31]
    v_mul_f32 v27, v225, v27
    v_cvt_pk_bf16_f32 v228, v24, v25
    v_cvt_pk_bf16_f32 v229, v26, v27
    v_mfma_f32_16x16x32_bf16 v[56:59], v[84:87], v[180:183], v[56:59]
    ds_read_b128 v[84:87], v5 offset:26624
    v_pk_max_i16 v228, v228, 0
    v_pk_max_i16 v229, v229, 0
    v_mfma_f32_16x16x32_bf16 v[28:31], v[88:91], v[184:187], v[28:31]
    v_fma_f32 v52, -v226, v136, v52
    v_fma_f32 v53, -v226, v137, v53
    v_mfma_f32_16x16x32_bf16 v[56:59], v[88:91], v[188:191], v[56:59]
    ds_read_b128 v[88:91], v5 offset:33792
    v_fma_f32 v54, -v226, v138, v54
    v_fma_f32 v55, -v226, v139, v55
    v_mfma_f32_16x16x32_bf16 v[28:31], v[92:95], v[192:195], v[28:31]
    buffer_load_dwordx4 a[176:179], v2, s[8:11], s87 offen offset:2048 sc1
    s_add_u32 s86, s86, 5120
    s_add_u32 s87, s87, 5120
    v_mul_f32 v52, v227, v52
    v_mul_f32 v53, v227, v53
    v_mul_f32 v54, v227, v54
    v_mfma_f32_16x16x32_bf16 v[56:59], v[92:95], v[196:199], v[56:59]
    ds_read_b128 v[92:95], v5 offset:40960
    buffer_load_dwordx4 a[180:183], v2, s[8:11], s86 offen offset:0 sc1
    v_mul_f32 v55, v227, v55
    v_cvt_pk_bf16_f32 v230, v52, v53
    v_mfma_f32_16x16x32_bf16 v[28:31], v[96:99], v[200:203], v[28:31]
    buffer_load_dwordx4 a[184:187], v2, s[8:11], s86 offen offset:1024 sc1
    v_cvt_pk_bf16_f32 v231, v54, v55
    v_pk_max_i16 v230, v230, 0
    v_mfma_f32_16x16x32_bf16 v[56:59], v[96:99], v[204:207], v[56:59]
    ds_read_b128 v[96:99], v5 offset:48128
    buffer_load_dwordx4 a[188:191], v2, s[8:11], s87 offen offset:0 sc1
    v_pk_max_i16 v231, v231, 0
    buffer_store_dwordx4 v[228:231], v2, s[8:11], s62 offen offset:2048 sc1
    s_waitcnt lgkmcnt(7)
    v_mfma_f32_16x16x32_bf16 v[32:35], v[100:103], v[152:155], v[32:35]
    v_mfma_f32_16x16x32_bf16 v[60:63], v[100:103], v[156:159], v[60:63]
    ds_read_b128 v[100:103], v5 offset:6144
    v_mfma_f32_16x16x32_bf16 v[32:35], v[104:107], v[160:163], v[32:35]
    s_waitcnt vmcnt(22)
    v_mfma_f32_16x16x32_bf16 v[60:63], v[104:107], v[164:167], v[60:63]
    ds_read_b128 v[104:107], v5 offset:13312
    v_fma_f32 v28, -v224, v140, v28
    v_fma_f32 v29, -v224, v141, v29
    v_fma_f32 v30, -v224, v142, v30
    v_mfma_f32_16x16x32_bf16 v[32:35], v[108:111], v[168:171], v[32:35]
    v_fma_f32 v31, -v224, v143, v31
    v_mul_f32 v28, v225, v28
    v_mfma_f32_16x16x32_bf16 v[60:63], v[108:111], v[172:175], v[60:63]
    ds_read_b128 v[108:111], v5 offset:20480
    v_mul_f32 v29, v225, v29
    v_mul_f32 v30, v225, v30
    v_mfma_f32_16x16x32_bf16 v[32:35], v[112:115], v[176:179], v[32:35]
    v_mul_f32 v31, v225, v31
    v_cvt_pk_bf16_f32 v228, v28, v29
    v_cvt_pk_bf16_f32 v229, v30, v31
    v_mfma_f32_16x16x32_bf16 v[60:63], v[112:115], v[180:183], v[60:63]
    ds_read_b128 v[112:115], v5 offset:27648
    v_pk_max_i16 v228, v228, 0
    v_pk_max_i16 v229, v229, 0
    v_mfma_f32_16x16x32_bf16 v[32:35], v[116:119], v[184:187], v[32:35]
    v_fma_f32 v56, -v226, v140, v56
    v_fma_f32 v57, -v226, v141, v57
    v_mfma_f32_16x16x32_bf16 v[60:63], v[116:119], v[188:191], v[60:63]
    ds_read_b128 v[116:119], v5 offset:34816
    v_fma_f32 v58, -v226, v142, v58
    v_fma_f32 v59, -v226, v143, v59
    v_mfma_f32_16x16x32_bf16 v[32:35], v[120:123], v[192:195], v[32:35]
    buffer_load_dwordx4 a[192:195], v2, s[8:11], s87 offen offset:1024 sc1
    v_mul_f32 v56, v227, v56
    v_mul_f32 v57, v227, v57
    v_mul_f32 v58, v227, v58
    v_mfma_f32_16x16x32_bf16 v[60:63], v[120:123], v[196:199], v[60:63]
    ds_read_b128 v[120:123], v5 offset:41984
    buffer_load_dwordx4 a[196:199], v2, s[8:11], s87 offen offset:2048 sc1
    s_add_u32 s86, s86, 5120
    s_add_u32 s87, s87, 5120
    v_mul_f32 v59, v227, v59
    v_cvt_pk_bf16_f32 v230, v56, v57
    v_mfma_f32_16x16x32_bf16 v[32:35], v[124:127], v[200:203], v[32:35]
    buffer_load_dwordx4 a[200:203], v2, s[8:11], s86 offen offset:0 sc1
    v_cvt_pk_bf16_f32 v231, v58, v59
    v_pk_max_i16 v230, v230, 0
    v_mfma_f32_16x16x32_bf16 v[60:63], v[124:127], v[204:207], v[60:63]
    ds_read_b128 v[124:127], v5 offset:49152
    buffer_load_dwordx4 a[204:207], v2, s[8:11], s86 offen offset:1024 sc1
    v_pk_max_i16 v231, v231, 0
    buffer_store_dwordx4 v[228:231], v2, s[8:11], s63 offen offset:0 sc1
    s_waitcnt lgkmcnt(7)
    v_mfma_f32_16x16x32_bf16 v[36:39], v[72:75], v[152:155], v[36:39]
    v_mfma_f32_16x16x32_bf16 v[64:67], v[72:75], v[156:159], v[64:67]
    v_mfma_f32_16x16x32_bf16 v[36:39], v[76:79], v[160:163], v[36:39]
    s_waitcnt vmcnt(26)
    v_mfma_f32_16x16x32_bf16 v[64:67], v[76:79], v[164:167], v[64:67]
    v_fma_f32 v32, -v224, v144, v32
    v_fma_f32 v33, -v224, v145, v33
    v_fma_f32 v34, -v224, v146, v34
    v_mfma_f32_16x16x32_bf16 v[36:39], v[80:83], v[168:171], v[36:39]
    v_fma_f32 v35, -v224, v147, v35
    v_mul_f32 v32, v225, v32
    v_mfma_f32_16x16x32_bf16 v[64:67], v[80:83], v[172:175], v[64:67]
    v_mul_f32 v33, v225, v33
    v_mul_f32 v34, v225, v34
    v_mfma_f32_16x16x32_bf16 v[36:39], v[84:87], v[176:179], v[36:39]
    v_mul_f32 v35, v225, v35
    v_cvt_pk_bf16_f32 v228, v32, v33
    v_cvt_pk_bf16_f32 v229, v34, v35
    v_mfma_f32_16x16x32_bf16 v[64:67], v[84:87], v[180:183], v[64:67]
    v_pk_max_i16 v228, v228, 0
    v_pk_max_i16 v229, v229, 0
    v_mfma_f32_16x16x32_bf16 v[36:39], v[88:91], v[184:187], v[36:39]
    v_fma_f32 v60, -v226, v144, v60
    v_fma_f32 v61, -v226, v145, v61
    v_mfma_f32_16x16x32_bf16 v[64:67], v[88:91], v[188:191], v[64:67]
    v_fma_f32 v62, -v226, v146, v62
    v_fma_f32 v63, -v226, v147, v63
    v_mfma_f32_16x16x32_bf16 v[36:39], v[92:95], v[192:195], v[36:39]
    v_mul_f32 v60, v227, v60
    v_mul_f32 v61, v227, v61
    v_mul_f32 v62, v227, v62
    v_mfma_f32_16x16x32_bf16 v[64:67], v[92:95], v[196:199], v[64:67]
    v_mul_f32 v63, v227, v63
    v_cvt_pk_bf16_f32 v230, v60, v61
    v_mfma_f32_16x16x32_bf16 v[36:39], v[96:99], v[200:203], v[36:39]
    v_cvt_pk_bf16_f32 v231, v62, v63
    v_pk_max_i16 v230, v230, 0
    v_mfma_f32_16x16x32_bf16 v[64:67], v[96:99], v[204:207], v[64:67]
    v_pk_max_i16 v231, v231, 0
    buffer_store_dwordx4 v[228:231], v2, s[8:11], s63 offen offset:1024 sc1
    s_waitcnt lgkmcnt(0)
    v_mfma_f32_16x16x32_bf16 v[40:43], v[100:103], v[152:155], v[40:43]
    v_mfma_f32_16x16x32_bf16 v[68:71], v[100:103], v[156:159], v[68:71]
    v_mfma_f32_16x16x32_bf16 v[40:43], v[104:107], v[160:163], v[40:43]
    s_waitcnt vmcnt(26)
    v_mfma_f32_16x16x32_bf16 v[68:71], v[104:107], v[164:167], v[68:71]
    v_fma_f32 v36, -v224, v148, v36
    v_fma_f32 v37, -v224, v149, v37
    v_fma_f32 v38, -v224, v150, v38
    v_mfma_f32_16x16x32_bf16 v[40:43], v[108:111], v[168:171], v[40:43]
    v_fma_f32 v39, -v224, v151, v39
    v_mul_f32 v36, v225, v36
    v_mfma_f32_16x16x32_bf16 v[68:71], v[108:111], v[172:175], v[68:71]
    v_mul_f32 v37, v225, v37
    v_mul_f32 v38, v225, v38
    v_mfma_f32_16x16x32_bf16 v[40:43], v[112:115], v[176:179], v[40:43]
    v_mul_f32 v39, v225, v39
    v_cvt_pk_bf16_f32 v228, v36, v37
    v_cvt_pk_bf16_f32 v229, v38, v39
    v_mfma_f32_16x16x32_bf16 v[68:71], v[112:115], v[180:183], v[68:71]
    v_pk_max_i16 v228, v228, 0
    v_pk_max_i16 v229, v229, 0
    v_mfma_f32_16x16x32_bf16 v[40:43], v[116:119], v[184:187], v[40:43]
    v_fma_f32 v64, -v226, v148, v64
    v_fma_f32 v65, -v226, v149, v65
    v_mfma_f32_16x16x32_bf16 v[68:71], v[116:119], v[188:191], v[68:71]
    v_fma_f32 v66, -v226, v150, v66
    v_fma_f32 v67, -v226, v151, v67
    v_mfma_f32_16x16x32_bf16 v[40:43], v[120:123], v[192:195], v[40:43]
    v_mul_f32 v64, v227, v64
    v_mul_f32 v65, v227, v65
    v_mul_f32 v66, v227, v66
    v_mfma_f32_16x16x32_bf16 v[68:71], v[120:123], v[196:199], v[68:71]
    v_mul_f32 v67, v227, v67
    v_cvt_pk_bf16_f32 v230, v64, v65
    v_mfma_f32_16x16x32_bf16 v[40:43], v[124:127], v[200:203], v[40:43]
    v_cvt_pk_bf16_f32 v231, v66, v67
    v_pk_max_i16 v230, v230, 0
    v_mfma_f32_16x16x32_bf16 v[68:71], v[124:127], v[204:207], v[68:71]
    v_pk_max_i16 v231, v231, 0
    buffer_store_dwordx4 v[228:231], v2, s[8:11], s63 offen offset:2048 sc1
    s_waitcnt vmcnt(26)
    s_nop 6
    v_fma_f32 v40, -v224, v208, v40
    v_fma_f32 v41, -v224, v209, v41
    v_fma_f32 v42, -v224, v210, v42
    v_fma_f32 v43, -v224, v211, v43
    v_mul_f32 v40, v225, v40
    v_mul_f32 v41, v225, v41
    v_mul_f32 v42, v225, v42
    v_mul_f32 v43, v225, v43
    v_cvt_pk_bf16_f32 v228, v40, v41
    v_cvt_pk_bf16_f32 v229, v42, v43
    v_pk_max_i16 v228, v228, 0
    v_pk_max_i16 v229, v229, 0
    v_fma_f32 v68, -v226, v208, v68
    v_fma_f32 v69, -v226, v209, v69
    v_fma_f32 v70, -v226, v210, v70
    v_fma_f32 v71, -v226, v211, v71
    v_mul_f32 v68, v227, v68
    v_mul_f32 v69, v227, v69
    v_mul_f32 v70, v227, v70
    v_mul_f32 v71, v227, v71
    v_cvt_pk_bf16_f32 v230, v68, v69
    v_cvt_pk_bf16_f32 v231, v70, v71
    v_pk_max_i16 v230, v230, 0
    v_pk_max_i16 v231, v231, 0
    buffer_store_dwordx4 v[228:231], v2, s[8:11], s63 offen offset:3072 sc1
    s_lshl_b32 s64, s76, 7
    s_add_u32 s64, s64, 2048
    s_waitcnt vmcnt(0)
    s_barrier
    s_cmp_lg_u32 s60, 0
    s_cbranch_scc1 L_arr_56
    s_mov_b64 s[98:99], exec
    s_mov_b64 exec, 1
    v_mov_b32 v4, s64
    v_mov_b32 v5, 1
    buffer_atomic_add v5, v4, s[8:11], 0 offen
    s_mov_b64 exec, s[98:99]
L_arr_56:
    s_mul_i32 s62, s60, 14
    s_cmp_ge_u32 s60, 3
    s_cselect_b32 s63, 1, 0
    s_sub_u32 s62, s62, s63
    s_lshl_b32 s62, s62, 11
    s_add_u32 s62, s62, s81
    s_mul_i32 s63, s84, 110592
    s_add_u32 s90, s62, s63
    s_xor_b32 s63, s84, 1
    s_mul_i32 s63, s63, 110592
    s_add_u32 s91, s62, s63
    buffer_load_dwordx4 a[208:211], v2, s[8:11], s87 offen offset:0 sc1
    buffer_load_dwordx4 a[212:215], v2, s[8:11], s87 offen offset:1024 sc1
    buffer_load_dwordx4 a[216:219], v2, s[8:11], s87 offen offset:2048 sc1
    s_add_u32 s86, s86, 5120
    s_add_u32 s87, s87, 5120
    buffer_load_dwordx4 a[220:223], v2, s[8:11], s86 offen offset:0 sc1
    buffer_load_dwordx4 a[224:227], v2, s[8:11], s86 offen offset:1024 sc1
    buffer_load_dwordx4 a[228:231], v2, s[8:11], s87 offen offset:0 sc1
    buffer_load_dwordx4 a[232:235], v2, s[8:11], s87 offen offset:1024 sc1
    buffer_load_dwordx4 a[236:239], v2, s[8:11], s87 offen offset:2048 sc1
    s_add_u32 s86, s86, 5120
    s_add_u32 s87, s87, 5120
    buffer_load_dwordx4 a[240:243], v2, s[8:11], s86 offen offset:0 sc1
    buffer_load_dwordx4 a[244:247], v2, s[8:11], s86 offen offset:1024 sc1
    buffer_load_dwordx4 a[248:251], v2, s[8:11], s87 offen offset:0 sc1
    buffer_load_dwordx4 a[252:255], v2, s[8:11], s87 offen offset:1024 sc1
    buffer_load_dwordx4 v[232:235], v2, s[8:11], s87 offen offset:2048 sc1
    s_add_u32 s86, s86, 5120
    s_add_u32 s87, s87, 5120
    buffer_load_dwordx4 v[236:239], v2, s[8:11], s86 offen offset:0 sc1
    buffer_load_dwordx4 v[240:243], v2, s[8:11], s86 offen offset:1024 sc1
    buffer_load_dwordx4 v[244:247], v2, s[8:11], s87 offen offset:0 sc1
    buffer_load_dwordx4 v[248:251], v2, s[8:11], s87 offen offset:1024 sc1
    buffer_load_dwordx4 v[252:255], v2, s[8:11], s87 offen offset:2048 sc1
    s_add_u32 s86, s86, 5120
    s_add_u32 s87, s87, 5120
    s_cmp_lg_u32 s60, 0
    s_cbranch_scc1 L_wc_57
    v_mov_b32 v4, s64
    buffer_load_dword v5, v4, s[8:11], 0 offen sc1
    s_waitcnt vmcnt(0)
L_pe_58:
    v_cmp_gt_u32 vcc, 16, v5
    s_nop 1
    s_cbranch_vccz L_pok_59
    s_cmp_eq_u32 s97, 0
    s_cbranch_scc1 L_pok_59
    s_sub_u32 s97, s97, 1
    s_sleep 2
    buffer_load_dword v5, v4, s[8:11], 0 offen sc1
    s_waitcnt vmcnt(0)
    s_branch L_pe_58
L_pok_59:
L_wc_57:
    s_barrier
    s_waitcnt vmcnt(41)
    buffer_load_dwordx4 v[96:99], v2, s[8:11], s90 offen sc1
    buffer_load_dwordx4 v[100:103], v2, s[8:11], s90 offen offset:1024 sc1
    buffer_load_dwordx4 v[104:107], v2, s[8:11], s91 offen sc1
    buffer_load_dwordx4 v[108:111], v2, s[8:11], s91 offen offset:1024 sc1
    s_add_u32 s90, s90, 2048
    s_add_u32 s91, s91, 2048
    buffer_load_dwordx4 v[112:115], v2, s[8:11], s90 offen sc1
    buffer_load_dwordx4 v[116:119], v2, s[8:11], s90 offen offset:1024 sc1
    buffer_load_dwordx4 v[120:123], v2, s[8:11], s91 offen sc1
    buffer_load_dwordx4 v[124:127], v2, s[8:11], s91 offen offset:1024 sc1
    s_add_u32 s90, s90, 2048
    s_add_u32 s91, s91, 2048
    buffer_load_dwordx4 v[128:131], v2, s[8:11], s90 offen sc1
    buffer_load_dwordx4 v[132:135], v2, s[8:11], s90 offen offset:1024 sc1
    buffer_load_dwordx4 v[136:139], v2, s[8:11], s91 offen sc1
    buffer_load_dwordx4 v[140:143], v2, s[8:11], s91 offen offset:1024 sc1
    s_add_u32 s90, s90, 2048
    s_add_u32 s91, s91, 2048
    buffer_load_dwordx4 v[144:147], v2, s[8:11], s90 offen sc1
    buffer_load_dwordx4 v[148:151], v2, s[8:11], s90 offen offset:1024 sc1
    buffer_load_dwordx4 v[152:155], v2, s[8:11], s91 offen sc1
    buffer_load_dwordx4 v[156:159], v2, s[8:11], s91 offen offset:1024 sc1
    s_add_u32 s90, s90, 2048
    s_add_u32 s91, s91, 2048
    s_add_u32 s64, s92, s80
    s_add_u32 s65, s92, 2654208
    buffer_load_dwordx4 v[208:211], v2, s[8:11], s64 offen offset:0 sc1
    buffer_load_dwordx4 v[212:215], v2, s[8:11], s64 offen offset:1024 sc1
    buffer_load_dwordx4 v[216:219], v2, s[8:11], s64 offen offset:2048 sc1
    buffer_load_dwordx4 v[220:223], v2, s[8:11], s65 offen offset:0 sc1
    buffer_load_dwordx4 v[224:227], v2, s[8:11], s65 offen offset:1024 sc1
    buffer_load_dwordx4 v[228:231], v2, s[8:11], s65 offen offset:2048 sc1
    s_waitcnt vmcnt(18)
    v_swap_b32 v98, v100
    v_swap_b32 v99, v101
    v_swap_b32 v106, v108
    v_swap_b32 v107, v109
    s_nop 0
    v_mfma_f32_16x16x32_bf16 v[16:19], a[0:3], v[96:99], 0
    v_mfma_f32_16x16x32_bf16 v[20:23], a[0:3], v[100:103], 0
    v_mfma_f32_16x16x32_bf16 v[56:59], a[0:3], v[104:107], 0
    v_mfma_f32_16x16x32_bf16 v[60:63], a[0:3], v[108:111], 0
    v_mfma_f32_16x16x32_bf16 v[24:27], a[4:7], v[96:99], 0
    v_mfma_f32_16x16x32_bf16 v[28:31], a[4:7], v[100:103], 0
    v_mfma_f32_16x16x32_bf16 v[64:67], a[4:7], v[104:107], 0
    v_mfma_f32_16x16x32_bf16 v[68:71], a[4:7], v[108:111], 0
    v_mfma_f32_16x16x32_bf16 v[32:35], a[8:11], v[96:99], 0
    v_mfma_f32_16x16x32_bf16 v[36:39], a[8:11], v[100:103], 0
    v_mfma_f32_16x16x32_bf16 v[72:75], a[8:11], v[104:107], 0
    v_mfma_f32_16x16x32_bf16 v[76:79], a[8:11], v[108:111], 0
    v_mfma_f32_16x16x32_bf16 v[40:43], a[12:15], v[96:99], 0
    v_mfma_f32_16x16x32_bf16 v[44:47], a[12:15], v[100:103], 0
    s_waitcnt vmcnt(14)
    v_mfma_f32_16x16x32_bf16 v[80:83], a[12:15], v[104:107], 0
    v_swap_b32 v114, v116
    v_mfma_f32_16x16x32_bf16 v[84:87], a[12:15], v[108:111], 0
    v_swap_b32 v115, v117
    v_mfma_f32_16x16x32_bf16 v[48:51], a[16:19], v[96:99], 0
    v_swap_b32 v122, v124
    v_mfma_f32_16x16x32_bf16 v[52:55], a[16:19], v[100:103], 0
    v_swap_b32 v123, v125
    v_mfma_f32_16x16x32_bf16 v[88:91], a[16:19], v[104:107], 0
    v_mfma_f32_16x16x32_bf16 v[92:95], a[16:19], v[108:111], 0
    v_mfma_f32_16x16x32_bf16 v[16:19], a[20:23], v[112:115], v[16:19]
    buffer_load_dwordx4 v[96:99], v2, s[8:11], s90 offen sc1
    v_mfma_f32_16x16x32_bf16 v[20:23], a[20:23], v[116:119], v[20:23]
    buffer_load_dwordx4 v[100:103], v2, s[8:11], s90 offen offset:1024 sc1
    s_add_u32 s90, s90, 2048
    v_mfma_f32_16x16x32_bf16 v[56:59], a[20:23], v[120:123], v[56:59]
    buffer_load_dwordx4 v[104:107], v2, s[8:11], s91 offen sc1
    v_mfma_f32_16x16x32_bf16 v[60:63], a[20:23], v[124:127], v[60:63]
    buffer_load_dwordx4 v[108:111], v2, s[8:11], s91 offen offset:1024 sc1
    s_add_u32 s91, s91, 2048
    v_mfma_f32_16x16x32_bf16 v[24:27], a[24:27], v[112:115], v[24:27]
    v_mfma_f32_16x16x32_bf16 v[28:31], a[24:27], v[116:119], v[28:31]
    v_mfma_f32_16x16x32_bf16 v[64:67], a[24:27], v[120:123], v[64:67]
    v_mfma_f32_16x16x32_bf16 v[68:71], a[24:27], v[124:127], v[68:71]
    v_mfma_f32_16x16x32_bf16 v[32:35], a[28:31], v[112:115], v[32:35]
    v_mfma_f32_16x16x32_bf16 v[36:39], a[28:31], v[116:119], v[36:39]
    v_mfma_f32_16x16x32_bf16 v[72:75], a[28:31], v[120:123], v[72:75]
    v_mfma_f32_16x16x32_bf16 v[76:79], a[28:31], v[124:127], v[76:79]
    v_mfma_f32_16x16x32_bf16 v[40:43], a[32:35], v[112:115], v[40:43]
    v_mfma_f32_16x16x32_bf16 v[44:47], a[32:35], v[116:119], v[44:47]
    s_waitcnt vmcnt(14)
    v_mfma_f32_16x16x32_bf16 v[80:83], a[32:35], v[120:123], v[80:83]
    v_swap_b32 v130, v132
    v_mfma_f32_16x16x32_bf16 v[84:87], a[32:35], v[124:127], v[84:87]
    v_swap_b32 v131, v133
    v_mfma_f32_16x16x32_bf16 v[48:51], a[36:39], v[112:115], v[48:51]
    v_swap_b32 v138, v140
    v_mfma_f32_16x16x32_bf16 v[52:55], a[36:39], v[116:119], v[52:55]
    v_swap_b32 v139, v141
    v_mfma_f32_16x16x32_bf16 v[88:91], a[36:39], v[120:123], v[88:91]
    v_mfma_f32_16x16x32_bf16 v[92:95], a[36:39], v[124:127], v[92:95]
    v_mfma_f32_16x16x32_bf16 v[16:19], a[40:43], v[128:131], v[16:19]
    buffer_load_dwordx4 v[112:115], v2, s[8:11], s90 offen sc1
    v_mfma_f32_16x16x32_bf16 v[20:23], a[40:43], v[132:135], v[20:23]
    buffer_load_dwordx4 v[116:119], v2, s[8:11], s90 offen offset:1024 sc1
    s_add_u32 s90, s90, 2048
    v_mfma_f32_16x16x32_bf16 v[56:59], a[40:43], v[136:139], v[56:59]
    buffer_load_dwordx4 v[120:123], v2, s[8:11], s91 offen sc1
    v_mfma_f32_16x16x32_bf16 v[60:63], a[40:43], v[140:143], v[60:63]
    buffer_load_dwordx4 v[124:127], v2, s[8:11], s91 offen offset:1024 sc1
    s_add_u32 s91, s91, 2048
    v_mfma_f32_16x16x32_bf16 v[24:27], a[44:47], v[128:131], v[24:27]
    v_mfma_f32_16x16x32_bf16 v[28:31], a[44:47], v[132:135], v[28:31]
    v_mfma_f32_16x16x32_bf16 v[64:67], a[44:47], v[136:139], v[64:67]
    v_mfma_f32_16x16x32_bf16 v[68:71], a[44:47], v[140:143], v[68:71]
    v_mfma_f32_16x16x32_bf16 v[32:35], a[48:51], v[128:131], v[32:35]
    v_mfma_f32_16x16x32_bf16 v[36:39], a[48:51], v[132:135], v[36:39]
    v_mfma_f32_16x16x32_bf16 v[72:75], a[48:51], v[136:139], v[72:75]
    v_mfma_f32_16x16x32_bf16 v[76:79], a[48:51], v[140:143], v[76:79]
    v_mfma_f32_16x16x32_bf16 v[40:43], a[52:55], v[128:131], v[40:43]
    v_mfma_f32_16x16x32_bf16 v[44:47], a[52:55], v[132:135], v[44:47]
    s_waitcnt vmcnt(14)
    v_mfma_f32_16x16x32_bf16 v[80:83], a[52:55], v[136:139], v[80:83]
    v_swap_b32 v146, v148
    v_mfma_f32_16x16x32_bf16 v[84:87], a[52:55], v[140:143], v[84:87]
    v_swap_b32 v147, v149
    v_mfma_f32_16x16x32_bf16 v[48:51], a[56:59], v[128:131], v[48:51]
    v_swap_b32 v154, v156
    v_mfma_f32_16x16x32_bf16 v[52:55], a[56:59], v[132:135], v[52:55]
    v_swap_b32 v155, v157
    v_mfma_f32_16x16x32_bf16 v[88:91], a[56:59], v[136:139], v[88:91]
    v_mfma_f32_16x16x32_bf16 v[92:95], a[56:59], v[140:143], v[92:95]
    v_mfma_f32_16x16x32_bf16 v[16:19], a[60:63], v[144:147], v[16:19]
    buffer_load_dwordx4 v[128:131], v2, s[8:11], s90 offen sc1
    v_mfma_f32_16x16x32_bf16 v[20:23], a[60:63], v[148:151], v[20:23]
    buffer_load_dwordx4 v[132:135], v2, s[8:11], s90 offen offset:1024 sc1
    s_add_u32 s90, s90, 2048
    v_mfma_f32_16x16x32_bf16 v[56:59], a[60:63], v[152:155], v[56:59]
    buffer_load_dwordx4 v[136:139], v2, s[8:11], s91 offen sc1
    v_mfma_f32_16x16x32_bf16 v[60:63], a[60:63], v[156:159], v[60:63]
    buffer_load_dwordx4 v[140:143], v2, s[8:11], s91 offen offset:1024 sc1
    s_add_u32 s91, s91, 2048
    v_mfma_f32_16x16x32_bf16 v[24:27], a[64:67], v[144:147], v[24:27]
    v_mfma_f32_16x16x32_bf16 v[28:31], a[64:67], v[148:151], v[28:31]
    v_mfma_f32_16x16x32_bf16 v[64:67], a[64:67], v[152:155], v[64:67]
    v_mfma_f32_16x16x32_bf16 v[68:71], a[64:67], v[156:159], v[68:71]
    v_mfma_f32_16x16x32_bf16 v[32:35], a[68:71], v[144:147], v[32:35]
    v_mfma_f32_16x16x32_bf16 v[36:39], a[68:71], v[148:151], v[36:39]
    v_mfma_f32_16x16x32_bf16 v[72:75], a[68:71], v[152:155], v[72:75]
    v_mfma_f32_16x16x32_bf16 v[76:79], a[68:71], v[156:159], v[76:79]
    v_mfma_f32_16x16x32_bf16 v[40:43], a[72:75], v[144:147], v[40:43]
    v_mfma_f32_16x16x32_bf16 v[44:47], a[72:75], v[148:151], v[44:47]
    s_waitcnt vmcnt(8)
    v_mfma_f32_16x16x32_bf16 v[80:83], a[72:75], v[152:155], v[80:83]
    v_swap_b32 v98, v100
    v_mfma_f32_16x16x32_bf16 v[84:87], a[72:75], v[156:159], v[84:87]
    v_swap_b32 v99, v101
    v_mfma_f32_16x16x32_bf16 v[48:51], a[76:79], v[144:147], v[48:51]
    v_swap_b32 v106, v108
    v_mfma_f32_16x16x32_bf16 v[52:55], a[76:79], v[148:151], v[52:55]
    v_swap_b32 v107, v109
    v_mfma_f32_16x16x32_bf16 v[88:91], a[76:79], v[152:155], v[88:91]
    v_mfma_f32_16x16x32_bf16 v[92:95], a[76:79], v[156:159], v[92:95]
    v_mfma_f32_16x16x32_bf16 v[16:19], a[80:83], v[96:99], v[16:19]
    buffer_load_dwordx4 v[144:147], v2, s[8:11], s90 offen sc1
    v_mfma_f32_16x16x32_bf16 v[20:23], a[80:83], v[100:103], v[20:23]
    buffer_load_dwordx4 v[148:151], v2, s[8:11], s90 offen offset:1024 sc1
    s_add_u32 s90, s90, 2048
    v_mfma_f32_16x16x32_bf16 v[56:59], a[80:83], v[104:107], v[56:59]
    buffer_load_dwordx4 v[152:155], v2, s[8:11], s91 offen sc1
    v_mfma_f32_16x16x32_bf16 v[60:63], a[80:83], v[108:111], v[60:63]
    buffer_load_dwordx4 v[156:159], v2, s[8:11], s91 offen offset:1024 sc1
    s_add_u32 s91, s91, 2048
    v_mfma_f32_16x16x32_bf16 v[24:27], a[84:87], v[96:99], v[24:27]
    v_mfma_f32_16x16x32_bf16 v[28:31], a[84:87], v[100:103], v[28:31]
    v_mfma_f32_16x16x32_bf16 v[64:67], a[84:87], v[104:107], v[64:67]
    v_mfma_f32_16x16x32_bf16 v[68:71], a[84:87], v[108:111], v[68:71]
    v_mfma_f32_16x16x32_bf16 v[32:35], a[88:91], v[96:99], v[32:35]
    v_mfma_f32_16x16x32_bf16 v[36:39], a[88:91], v[100:103], v[36:39]
    v_mfma_f32_16x16x32_bf16 v[72:75], a[88:91], v[104:107], v[72:75]
    v_mfma_f32_16x16x32_bf16 v[76:79], a[88:91], v[108:111], v[76:79]
    v_mfma_f32_16x16x32_bf16 v[40:43], a[92:95], v[96:99], v[40:43]
    v_mfma_f32_16x16x32_bf16 v[44:47], a[92:95], v[100:103], v[44:47]
    s_waitcnt vmcnt(8)
    v_mfma_f32_16x16x32_bf16 v[80:83], a[92:95], v[104:107], v[80:83]
    v_swap_b32 v114, v116
    v_mfma_f32_16x16x32_bf16 v[84:87], a[92:95], v[108:111], v[84:87]
    v_swap_b32 v115, v117
    v_mfma_f32_16x16x32_bf16 v[48:51], a[96:99], v[96:99], v[48:51]
    v_swap_b32 v122, v124
    v_mfma_f32_16x16x32_bf16 v[52:55], a[96:99], v[100:103], v[52:55]
    v_swap_b32 v123, v125
    v_mfma_f32_16x16x32_bf16 v[88:91], a[96:99], v[104:107], v[88:91]
    v_mfma_f32_16x16x32_bf16 v[92:95], a[96:99], v[108:111], v[92:95]
    v_mfma_f32_16x16x32_bf16 v[16:19], a[100:103], v[112:115], v[16:19]
    buffer_load_dwordx4 v[96:99], v2, s[8:11], s90 offen sc1
    v_mfma_f32_16x16x32_bf16 v[20:23], a[100:103], v[116:119], v[20:23]
    buffer_load_dwordx4 v[100:103], v2, s[8:11], s90 offen offset:1024 sc1
    s_add_u32 s90, s90, 2048
    v_mfma_f32_16x16x32_bf16 v[56:59], a[100:103], v[120:123], v[56:59]
    buffer_load_dwordx4 v[104:107], v2, s[8:11], s91 offen sc1
    v_mfma_f32_16x16x32_bf16 v[60:63], a[100:103], v[124:127], v[60:63]
    buffer_load_dwordx4 v[108:111], v2, s[8:11], s91 offen offset:1024 sc1
    s_add_u32 s91, s91, 2048
    v_mfma_f32_16x16x32_bf16 v[24:27], a[104:107], v[112:115], v[24:27]
    v_mfma_f32_16x16x32_bf16 v[28:31], a[104:107], v[116:119], v[28:31]
    v_mfma_f32_16x16x32_bf16 v[64:67], a[104:107], v[120:123], v[64:67]
    v_mfma_f32_16x16x32_bf16 v[68:71], a[104:107], v[124:127], v[68:71]
    v_mfma_f32_16x16x32_bf16 v[32:35], a[108:111], v[112:115], v[32:35]
    v_mfma_f32_16x16x32_bf16 v[36:39], a[108:111], v[116:119], v[36:39]
    v_mfma_f32_16x16x32_bf16 v[72:75], a[108:111], v[120:123], v[72:75]
    v_mfma_f32_16x16x32_bf16 v[76:79], a[108:111], v[124:127], v[76:79]
    v_mfma_f32_16x16x32_bf16 v[40:43], a[112:115], v[112:115], v[40:43]
    v_mfma_f32_16x16x32_bf16 v[44:47], a[112:115], v[116:119], v[44:47]
    s_waitcnt vmcnt(8)
    v_mfma_f32_16x16x32_bf16 v[80:83], a[112:115], v[120:123], v[80:83]
    v_swap_b32 v130, v132
    v_mfma_f32_16x16x32_bf16 v[84:87], a[112:115], v[124:127], v[84:87]
    v_swap_b32 v131, v133
    v_mfma_f32_16x16x32_bf16 v[48:51], a[116:119], v[112:115], v[48:51]
    v_swap_b32 v138, v140
    v_mfma_f32_16x16x32_bf16 v[52:55], a[116:119], v[116:119], v[52:55]
    v_swap_b32 v139, v141
    v_mfma_f32_16x16x32_bf16 v[88:91], a[116:119], v[120:123], v[88:91]
    v_mfma_f32_16x16x32_bf16 v[92:95], a[116:119], v[124:127], v[92:95]
    v_mfma_f32_16x16x32_bf16 v[16:19], a[120:123], v[128:131], v[16:19]
    buffer_load_dwordx4 v[112:115], v2, s[8:11], s90 offen sc1
    v_mfma_f32_16x16x32_bf16 v[20:23], a[120:123], v[132:135], v[20:23]
    buffer_load_dwordx4 v[116:119], v2, s[8:11], s90 offen offset:1024 sc1
    s_add_u32 s90, s90, 2048
    v_mfma_f32_16x16x32_bf16 v[56:59], a[120:123], v[136:139], v[56:59]
    buffer_load_dwordx4 v[120:123], v2, s[8:11], s91 offen sc1
    v_mfma_f32_16x16x32_bf16 v[60:63], a[120:123], v[140:143], v[60:63]
    buffer_load_dwordx4 v[124:127], v2, s[8:11], s91 offen offset:1024 sc1
    s_add_u32 s91, s91, 2048
    v_mfma_f32_16x16x32_bf16 v[24:27], a[124:127], v[128:131], v[24:27]
    v_mfma_f32_16x16x32_bf16 v[28:31], a[124:127], v[132:135], v[28:31]
    v_mfma_f32_16x16x32_bf16 v[64:67], a[124:127], v[136:139], v[64:67]
    v_mfma_f32_16x16x32_bf16 v[68:71], a[124:127], v[140:143], v[68:71]
    v_mfma_f32_16x16x32_bf16 v[32:35], a[128:131], v[128:131], v[32:35]
    v_mfma_f32_16x16x32_bf16 v[36:39], a[128:131], v[132:135], v[36:39]
    v_mfma_f32_16x16x32_bf16 v[72:75], a[128:131], v[136:139], v[72:75]
    v_mfma_f32_16x16x32_bf16 v[76:79], a[128:131], v[140:143], v[76:79]
    v_mfma_f32_16x16x32_bf16 v[40:43], a[132:135], v[128:131], v[40:43]
    v_mfma_f32_16x16x32_bf16 v[44:47], a[132:135], v[132:135], v[44:47]
    s_waitcnt vmcnt(8)
    v_mfma_f32_16x16x32_bf16 v[80:83], a[132:135], v[136:139], v[80:83]
    v_swap_b32 v146, v148
    v_mfma_f32_16x16x32_bf16 v[84:87], a[132:135], v[140:143], v[84:87]
    v_swap_b32 v147, v149
    v_mfma_f32_16x16x32_bf16 v[48:51], a[136:139], v[128:131], v[48:51]
    v_swap_b32 v154, v156
    v_mfma_f32_16x16x32_bf16 v[52:55], a[136:139], v[132:135], v[52:55]
    v_swap_b32 v155, v157
    v_mfma_f32_16x16x32_bf16 v[88:91], a[136:139], v[136:139], v[88:91]
    v_mfma_f32_16x16x32_bf16 v[92:95], a[136:139], v[140:143], v[92:95]
    v_mfma_f32_16x16x32_bf16 v[16:19], a[140:143], v[144:147], v[16:19]
    buffer_load_dwordx4 v[128:131], v2, s[8:11], s90 offen sc1
    v_mfma_f32_16x16x32_bf16 v[20:23], a[140:143], v[148:151], v[20:23]
    buffer_load_dwordx4 v[132:135], v2, s[8:11], s90 offen offset:1024 sc1
    s_add_u32 s90, s90, 2048
    v_mfma_f32_16x16x32_bf16 v[56:59], a[140:143], v[152:155], v[56:59]
    buffer_load_dwordx4 v[136:139], v2, s[8:11], s91 offen sc1
    v_mfma_f32_16x16x32_bf16 v[60:63], a[140:143], v[156:159], v[60:63]
    buffer_load_dwordx4 v[140:143], v2, s[8:11], s91 offen offset:1024 sc1
    s_add_u32 s91, s91, 2048
    v_mfma_f32_16x16x32_bf16 v[24:27], a[144:147], v[144:147], v[24:27]
    v_mfma_f32_16x16x32_bf16 v[28:31], a[144:147], v[148:151], v[28:31]
    v_mfma_f32_16x16x32_bf16 v[64:67], a[144:147], v[152:155], v[64:67]
    v_mfma_f32_16x16x32_bf16 v[68:71], a[144:147], v[156:159], v[68:71]
    v_mfma_f32_16x16x32_bf16 v[32:35], a[148:151], v[144:147], v[32:35]
    v_mfma_f32_16x16x32_bf16 v[36:39], a[148:151], v[148:151], v[36:39]
    v_mfma_f32_16x16x32_bf16 v[72:75], a[148:151], v[152:155], v[72:75]
    v_mfma_f32_16x16x32_bf16 v[76:79], a[148:151], v[156:159], v[76:79]
    v_mfma_f32_16x16x32_bf16 v[40:43], a[152:155], v[144:147], v[40:43]
    v_mfma_f32_16x16x32_bf16 v[44:47], a[152:155], v[148:151], v[44:47]
    s_waitcnt vmcnt(8)
    v_mfma_f32_16x16x32_bf16 v[80:83], a[152:155], v[152:155], v[80:83]
    v_swap_b32 v98, v100
    v_mfma_f32_16x16x32_bf16 v[84:87], a[152:155], v[156:159], v[84:87]
    v_swap_b32 v99, v101
    v_mfma_f32_16x16x32_bf16 v[48:51], a[156:159], v[144:147], v[48:51]
    v_swap_b32 v106, v108
    v_mfma_f32_16x16x32_bf16 v[52:55], a[156:159], v[148:151], v[52:55]
    v_swap_b32 v107, v109
    v_mfma_f32_16x16x32_bf16 v[88:91], a[156:159], v[152:155], v[88:91]
    v_mfma_f32_16x16x32_bf16 v[92:95], a[156:159], v[156:159], v[92:95]
    v_mfma_f32_16x16x32_bf16 v[16:19], a[160:163], v[96:99], v[16:19]
    buffer_load_dwordx4 v[144:147], v2, s[8:11], s90 offen sc1
    v_mfma_f32_16x16x32_bf16 v[20:23], a[160:163], v[100:103], v[20:23]
    buffer_load_dwordx4 v[148:151], v2, s[8:11], s90 offen offset:1024 sc1
    s_add_u32 s90, s90, 2048
    v_mfma_f32_16x16x32_bf16 v[56:59], a[160:163], v[104:107], v[56:59]
    buffer_load_dwordx4 v[152:155], v2, s[8:11], s91 offen sc1
    v_mfma_f32_16x16x32_bf16 v[60:63], a[160:163], v[108:111], v[60:63]
    buffer_load_dwordx4 v[156:159], v2, s[8:11], s91 offen offset:1024 sc1
    s_add_u32 s91, s91, 2048
    v_mfma_f32_16x16x32_bf16 v[24:27], a[164:167], v[96:99], v[24:27]
    v_mfma_f32_16x16x32_bf16 v[28:31], a[164:167], v[100:103], v[28:31]
    v_mfma_f32_16x16x32_bf16 v[64:67], a[164:167], v[104:107], v[64:67]
    v_mfma_f32_16x16x32_bf16 v[68:71], a[164:167], v[108:111], v[68:71]
    v_mfma_f32_16x16x32_bf16 v[32:35], a[168:171], v[96:99], v[32:35]
    v_mfma_f32_16x16x32_bf16 v[36:39], a[168:171], v[100:103], v[36:39]
    v_mfma_f32_16x16x32_bf16 v[72:75], a[168:171], v[104:107], v[72:75]
    v_mfma_f32_16x16x32_bf16 v[76:79], a[168:171], v[108:111], v[76:79]
    v_mfma_f32_16x16x32_bf16 v[40:43], a[172:175], v[96:99], v[40:43]
    v_mfma_f32_16x16x32_bf16 v[44:47], a[172:175], v[100:103], v[44:47]
    s_waitcnt vmcnt(8)
    v_mfma_f32_16x16x32_bf16 v[80:83], a[172:175], v[104:107], v[80:83]
    v_swap_b32 v114, v116
    v_mfma_f32_16x16x32_bf16 v[84:87], a[172:175], v[108:111], v[84:87]
    v_swap_b32 v115, v117
    v_mfma_f32_16x16x32_bf16 v[48:51], a[176:179], v[96:99], v[48:51]
    v_swap_b32 v122, v124
    v_mfma_f32_16x16x32_bf16 v[52:55], a[176:179], v[100:103], v[52:55]
    v_swap_b32 v123, v125
    v_mfma_f32_16x16x32_bf16 v[88:91], a[176:179], v[104:107], v[88:91]
    v_mfma_f32_16x16x32_bf16 v[92:95], a[176:179], v[108:111], v[92:95]
    v_mfma_f32_16x16x32_bf16 v[16:19], a[180:183], v[112:115], v[16:19]
    buffer_load_dwordx4 v[96:99], v2, s[8:11], s90 offen sc1
    v_mfma_f32_16x16x32_bf16 v[20:23], a[180:183], v[116:119], v[20:23]
    buffer_load_dwordx4 v[100:103], v2, s[8:11], s90 offen offset:1024 sc1
    s_add_u32 s90, s90, 2048
    v_mfma_f32_16x16x32_bf16 v[56:59], a[180:183], v[120:123], v[56:59]
    buffer_load_dwordx4 v[104:107], v2, s[8:11], s91 offen sc1
    v_mfma_f32_16x16x32_bf16 v[60:63], a[180:183], v[124:127], v[60:63]
    buffer_load_dwordx4 v[108:111], v2, s[8:11], s91 offen offset:1024 sc1
    s_add_u32 s91, s91, 2048
    v_mfma_f32_16x16x32_bf16 v[24:27], a[184:187], v[112:115], v[24:27]
    v_mfma_f32_16x16x32_bf16 v[28:31], a[184:187], v[116:119], v[28:31]
    v_mfma_f32_16x16x32_bf16 v[64:67], a[184:187], v[120:123], v[64:67]
    v_mfma_f32_16x16x32_bf16 v[68:71], a[184:187], v[124:127], v[68:71]
    v_mfma_f32_16x16x32_bf16 v[32:35], a[188:191], v[112:115], v[32:35]
    v_mfma_f32_16x16x32_bf16 v[36:39], a[188:191], v[116:119], v[36:39]
    v_mfma_f32_16x16x32_bf16 v[72:75], a[188:191], v[120:123], v[72:75]
    v_mfma_f32_16x16x32_bf16 v[76:79], a[188:191], v[124:127], v[76:79]
    v_mfma_f32_16x16x32_bf16 v[40:43], a[192:195], v[112:115], v[40:43]
    v_mfma_f32_16x16x32_bf16 v[44:47], a[192:195], v[116:119], v[44:47]
    s_waitcnt vmcnt(8)
    v_mfma_f32_16x16x32_bf16 v[80:83], a[192:195], v[120:123], v[80:83]
    v_swap_b32 v130, v132
    v_mfma_f32_16x16x32_bf16 v[84:87], a[192:195], v[124:127], v[84:87]
    v_swap_b32 v131, v133
    v_mfma_f32_16x16x32_bf16 v[48:51], a[196:199], v[112:115], v[48:51]
    v_swap_b32 v138, v140
    v_mfma_f32_16x16x32_bf16 v[52:55], a[196:199], v[116:119], v[52:55]
    v_swap_b32 v139, v141
    v_mfma_f32_16x16x32_bf16 v[88:91], a[196:199], v[120:123], v[88:91]
    v_mfma_f32_16x16x32_bf16 v[92:95], a[196:199], v[124:127], v[92:95]
    v_mfma_f32_16x16x32_bf16 v[16:19], a[200:203], v[128:131], v[16:19]
    buffer_load_dwordx4 v[112:115], v2, s[8:11], s90 offen sc1
    v_mfma_f32_16x16x32_bf16 v[20:23], a[200:203], v[132:135], v[20:23]
    buffer_load_dwordx4 v[116:119], v2, s[8:11], s90 offen offset:1024 sc1
    s_add_u32 s90, s90, 2048
    v_mfma_f32_16x16x32_bf16 v[56:59], a[200:203], v[136:139], v[56:59]
    buffer_load_dwordx4 v[120:123], v2, s[8:11], s91 offen sc1
    v_mfma_f32_16x16x32_bf16 v[60:63], a[200:203], v[140:143], v[60:63]
    buffer_load_dwordx4 v[124:127], v2, s[8:11], s91 offen offset:1024 sc1
    s_add_u32 s91, s91, 2048
    v_mfma_f32_16x16x32_bf16 v[24:27], a[204:207], v[128:131], v[24:27]
    v_mfma_f32_16x16x32_bf16 v[28:31], a[204:207], v[132:135], v[28:31]
    v_mfma_f32_16x16x32_bf16 v[64:67], a[204:207], v[136:139], v[64:67]
    v_mfma_f32_16x16x32_bf16 v[68:71], a[204:207], v[140:143], v[68:71]
    v_mfma_f32_16x16x32_bf16 v[32:35], a[208:211], v[128:131], v[32:35]
    v_mfma_f32_16x16x32_bf16 v[36:39], a[208:211], v[132:135], v[36:39]
    v_mfma_f32_16x16x32_bf16 v[72:75], a[208:211], v[136:139], v[72:75]
    v_mfma_f32_16x16x32_bf16 v[76:79], a[208:211], v[140:143], v[76:79]
    v_mfma_f32_16x16x32_bf16 v[40:43], a[212:215], v[128:131], v[40:43]
    v_mfma_f32_16x16x32_bf16 v[44:47], a[212:215], v[132:135], v[44:47]
    s_waitcnt vmcnt(8)
    v_mfma_f32_16x16x32_bf16 v[80:83], a[212:215], v[136:139], v[80:83]
    v_swap_b32 v146, v148
    v_mfma_f32_16x16x32_bf16 v[84:87], a[212:215], v[140:143], v[84:87]
    v_swap_b32 v147, v149
    v_mfma_f32_16x16x32_bf16 v[48:51], a[216:219], v[128:131], v[48:51]
    v_swap_b32 v154, v156
    v_mfma_f32_16x16x32_bf16 v[52:55], a[216:219], v[132:135], v[52:55]
    v_swap_b32 v155, v157
    v_mfma_f32_16x16x32_bf16 v[88:91], a[216:219], v[136:139], v[88:91]
    v_mfma_f32_16x16x32_bf16 v[92:95], a[216:219], v[140:143], v[92:95]
    v_mfma_f32_16x16x32_bf16 v[16:19], a[220:223], v[144:147], v[16:19]
    v_mfma_f32_16x16x32_bf16 v[20:23], a[220:223], v[148:151], v[20:23]
    v_mfma_f32_16x16x32_bf16 v[56:59], a[220:223], v[152:155], v[56:59]
    v_mfma_f32_16x16x32_bf16 v[60:63], a[220:223], v[156:159], v[60:63]
    v_mfma_f32_16x16x32_bf16 v[24:27], a[224:227], v[144:147], v[24:27]
    v_mfma_f32_16x16x32_bf16 v[28:31], a[224:227], v[148:151], v[28:31]
    v_mfma_f32_16x16x32_bf16 v[64:67], a[224:227], v[152:155], v[64:67]
    v_mfma_f32_16x16x32_bf16 v[68:71], a[224:227], v[156:159], v[68:71]
    v_mfma_f32_16x16x32_bf16 v[32:35], a[228:231], v[144:147], v[32:35]
    v_mfma_f32_16x16x32_bf16 v[36:39], a[228:231], v[148:151], v[36:39]
    v_mfma_f32_16x16x32_bf16 v[72:75], a[228:231], v[152:155], v[72:75]
    v_mfma_f32_16x16x32_bf16 v[76:79], a[228:231], v[156:159], v[76:79]
    v_mfma_f32_16x16x32_bf16 v[40:43], a[232:235], v[144:147], v[40:43]
    v_mfma_f32_16x16x32_bf16 v[44:47], a[232:235], v[148:151], v[44:47]
    s_waitcnt vmcnt(4)
    v_mfma_f32_16x16x32_bf16 v[80:83], a[232:235], v[152:155], v[80:83]
    v_swap_b32 v98, v100
    v_mfma_f32_16x16x32_bf16 v[84:87], a[232:235], v[156:159], v[84:87]
    v_swap_b32 v99, v101
    v_mfma_f32_16x16x32_bf16 v[48:51], a[236:239], v[144:147], v[48:51]
    v_swap_b32 v106, v108
    v_mfma_f32_16x16x32_bf16 v[52:55], a[236:239], v[148:151], v[52:55]
    v_swap_b32 v107, v109
    v_mfma_f32_16x16x32_bf16 v[88:91], a[236:239], v[152:155], v[88:91]
    v_mfma_f32_16x16x32_bf16 v[92:95], a[236:239], v[156:159], v[92:95]
    v_mfma_f32_16x16x32_bf16 v[16:19], a[240:243], v[96:99], v[16:19]
    v_mfma_f32_16x16x32_bf16 v[20:23], a[240:243], v[100:103], v[20:23]
    v_mfma_f32_16x16x32_bf16 v[56:59], a[240:243], v[104:107], v[56:59]
    v_mfma_f32_16x16x32_bf16 v[60:63], a[240:243], v[108:111], v[60:63]
    v_mfma_f32_16x16x32_bf16 v[24:27], a[244:247], v[96:99], v[24:27]
    v_mfma_f32_16x16x32_bf16 v[28:31], a[244:247], v[100:103], v[28:31]
    v_mfma_f32_16x16x32_bf16 v[64:67], a[244:247], v[104:107], v[64:67]
    v_mfma_f32_16x16x32_bf16 v[68:71], a[244:247], v[108:111], v[68:71]
    v_mfma_f32_16x16x32_bf16 v[32:35], a[248:251], v[96:99], v[32:35]
    v_mfma_f32_16x16x32_bf16 v[36:39], a[248:251], v[100:103], v[36:39]
    v_mfma_f32_16x16x32_bf16 v[72:75], a[248:251], v[104:107], v[72:75]
    v_mfma_f32_16x16x32_bf16 v[76:79], a[248:251], v[108:111], v[76:79]
    v_mfma_f32_16x16x32_bf16 v[40:43], a[252:255], v[96:99], v[40:43]
    v_mfma_f32_16x16x32_bf16 v[44:47], a[252:255], v[100:103], v[44:47]
    s_waitcnt vmcnt(0)
    v_mfma_f32_16x16x32_bf16 v[80:83], a[252:255], v[104:107], v[80:83]
    v_swap_b32 v114, v116
    v_mfma_f32_16x16x32_bf16 v[84:87], a[252:255], v[108:111], v[84:87]
    v_swap_b32 v115, v117
    v_mfma_f32_16x16x32_bf16 v[48:51], v[232:235], v[96:99], v[48:51]
    v_swap_b32 v122, v124
    v_mfma_f32_16x16x32_bf16 v[52:55], v[232:235], v[100:103], v[52:55]
    v_swap_b32 v123, v125
    v_mfma_f32_16x16x32_bf16 v[88:91], v[232:235], v[104:107], v[88:91]
    v_mfma_f32_16x16x32_bf16 v[92:95], v[232:235], v[108:111], v[92:95]
    s_cmp_ge_u32 s60, 2
    s_cbranch_scc1 L_g2end_60
    v_mfma_f32_16x16x32_bf16 v[16:19], v[236:239], v[112:115], v[16:19]
    v_mfma_f32_16x16x32_bf16 v[20:23], v[236:239], v[116:119], v[20:23]
    v_mfma_f32_16x16x32_bf16 v[56:59], v[236:239], v[120:123], v[56:59]
    v_mfma_f32_16x16x32_bf16 v[60:63], v[236:239], v[124:127], v[60:63]
    v_mfma_f32_16x16x32_bf16 v[24:27], v[240:243], v[112:115], v[24:27]
    v_mfma_f32_16x16x32_bf16 v[28:31], v[240:243], v[116:119], v[28:31]
    v_mfma_f32_16x16x32_bf16 v[64:67], v[240:243], v[120:123], v[64:67]
    v_mfma_f32_16x16x32_bf16 v[68:71], v[240:243], v[124:127], v[68:71]
    v_mfma_f32_16x16x32_bf16 v[32:35], v[244:247], v[112:115], v[32:35]
    v_mfma_f32_16x16x32_bf16 v[36:39], v[244:247], v[116:119], v[36:39]
    v_mfma_f32_16x16x32_bf16 v[72:75], v[244:247], v[120:123], v[72:75]
    v_mfma_f32_16x16x32_bf16 v[76:79], v[244:247], v[124:127], v[76:79]
    v_mfma_f32_16x16x32_bf16 v[40:43], v[248:251], v[112:115], v[40:43]
    v_mfma_f32_16x16x32_bf16 v[44:47], v[248:251], v[116:119], v[44:47]
    v_mfma_f32_16x16x32_bf16 v[80:83], v[248:251], v[120:123], v[80:83]
    v_mfma_f32_16x16x32_bf16 v[84:87], v[248:251], v[124:127], v[84:87]
    v_mfma_f32_16x16x32_bf16 v[48:51], v[252:255], v[112:115], v[48:51]
    v_mfma_f32_16x16x32_bf16 v[52:55], v[252:255], v[116:119], v[52:55]
    v_mfma_f32_16x16x32_bf16 v[88:91], v[252:255], v[120:123], v[88:91]
    v_mfma_f32_16x16x32_bf16 v[92:95], v[252:255], v[124:127], v[92:95]
L_g2end_60:
    s_waitcnt vmcnt(0)
    s_lshr_b32 s62, s60, 1
    s_mul_i32 s63, s62, 10240
    s_xor_b32 s62, s62, 1
    s_mul_i32 s64, s62, 10240
    s_mul_i32 s65, s85, 6144
    s_sub_u32 s66, 1, s85
    s_lshl_b32 s66, s66, 12
    s_add_u32 s62, s63, s65
    s_add_u32 s62, s62, 143360
    v_add_u32 v3, s62, v2
    s_add_u32 s62, s63, s66
    s_add_u32 s62, s62, 143360
    v_add_u32 v4, s62, v2
    s_add_u32 s62, s64, s65
    s_add_u32 s62, s62, 143360
    v_add_u32 v5, s62, v2
    s_add_u32 s62, s64, s66
    s_add_u32 s62, s62, 143360
    v_add_u32 v6, s62, v2
    ds_write_b128 v4, v[40:43] offset:2048
    ds_write_b128 v4, v[44:47] offset:3072
    ds_write_b128 v4, v[48:51] offset:4096
    ds_write_b128 v4, v[52:55] offset:5120
    s_cmp_eq_u32 s85, 0
    s_cbranch_scc1 L_rw_61
    ds_write_b128 v4, v[32:35] offset:0
    ds_write_b128 v4, v[36:39] offset:1024
L_rw_61:
    s_waitcnt lgkmcnt(0)
    s_barrier
    ds_read_b128 v[96:99], v3 offset:0
    ds_read_b128 v[100:103], v3 offset:1024
    ds_read_b128 v[104:107], v3 offset:2048
    ds_read_b128 v[108:111], v3 offset:3072
    ds_read_b128 v[112:115], v4 offset:0
    ds_read_b128 v[116:119], v4 offset:1024
    s_waitcnt lgkmcnt(0)
    s_barrier
    ds_write_b128 v5, v[56:59] offset:0
    ds_write_b128 v5, v[60:63] offset:1024
    ds_write_b128 v5, v[64:67] offset:2048
    ds_write_b128 v5, v[68:71] offset:3072
    s_cmp_eq_u32 s85, 1
    s_cbranch_scc1 L_rw_62
    ds_write_b128 v6, v[72:75] offset:0
    ds_write_b128 v6, v[76:79] offset:1024
L_rw_62:
    v_pk_add_f32 v[16:17], v[16:17], v[96:97]
    v_pk_add_f32 v[18:19], v[18:19], v[98:99]
    v_pk_add_f32 v[20:21], v[20:21], v[100:101]
    v_pk_add_f32 v[22:23], v[22:23], v[102:103]
    v_pk_add_f32 v[24:25], v[24:25], v[104:105]
    v_pk_add_f32 v[26:27], v[26:27], v[106:107]
    v_pk_add_f32 v[28:29], v[28:29], v[108:109]
    v_pk_add_f32 v[30:31], v[30:31], v[110:111]
    v_pk_add_f32 v[32:33], v[32:33], v[112:113]
    v_pk_add_f32 v[34:35], v[34:35], v[114:115]
    v_pk_add_f32 v[36:37], v[36:37], v[116:117]
    v_pk_add_f32 v[38:39], v[38:39], v[118:119]
    s_waitcnt lgkmcnt(0)
    s_barrier
    ds_read_b128 v[96:99], v3 offset:0
    ds_read_b128 v[100:103], v3 offset:1024
    ds_read_b128 v[104:107], v3 offset:2048
    ds_read_b128 v[108:111], v3 offset:3072
    ds_read_b128 v[112:115], v4 offset:0
    ds_read_b128 v[116:119], v4 offset:1024
    s_waitcnt lgkmcnt(0)
    s_barrier
    ds_write_b128 v6, v[80:83] offset:2048
    ds_write_b128 v6, v[84:87] offset:3072
    ds_write_b128 v6, v[88:91] offset:4096
    ds_write_b128 v6, v[92:95] offset:5120
    s_cmp_eq_u32 s85, 0
    s_cbranch_scc1 L_rw_63
    ds_write_b128 v6, v[72:75] offset:0
    ds_write_b128 v6, v[76:79] offset:1024
L_rw_63:
    v_pk_add_f32 v[16:17], v[16:17], v[96:97]
    v_pk_add_f32 v[18:19], v[18:19], v[98:99]
    v_pk_add_f32 v[20:21], v[20:21], v[100:101]
    v_pk_add_f32 v[22:23], v[22:23], v[102:103]
    v_pk_add_f32 v[24:25], v[24:25], v[104:105]
    v_pk_add_f32 v[26:27], v[26:27], v[106:107]
    v_pk_add_f32 v[28:29], v[28:29], v[108:109]
    v_pk_add_f32 v[30:31], v[30:31], v[110:111]
    v_pk_add_f32 v[32:33], v[32:33], v[112:113]
    v_pk_add_f32 v[34:35], v[34:35], v[114:115]
    v_pk_add_f32 v[36:37], v[36:37], v[116:117]
    v_pk_add_f32 v[38:39], v[38:39], v[118:119]
    s_waitcnt lgkmcnt(0)
    s_barrier
    ds_read_b128 v[96:99], v3 offset:0
    ds_read_b128 v[100:103], v3 offset:1024
    ds_read_b128 v[104:107], v3 offset:2048
    ds_read_b128 v[108:111], v3 offset:3072
    ds_read_b128 v[112:115], v4 offset:0
    ds_read_b128 v[116:119], v4 offset:1024
    s_waitcnt lgkmcnt(0)
    v_pk_add_f32 v[16:17], v[16:17], v[96:97]
    v_pk_add_f32 v[18:19], v[18:19], v[98:99]
    v_pk_add_f32 v[20:21], v[20:21], v[100:101]
    v_pk_add_f32 v[22:23], v[22:23], v[102:103]
    v_pk_add_f32 v[24:25], v[24:25], v[104:105]
    v_pk_add_f32 v[26:27], v[26:27], v[106:107]
    v_pk_add_f32 v[28:29], v[28:29], v[108:109]
    v_pk_add_f32 v[30:31], v[30:31], v[110:111]
    v_pk_add_f32 v[32:33], v[32:33], v[112:113]
    v_pk_add_f32 v[34:35], v[34:35], v[114:115]
    v_pk_add_f32 v[36:37], v[36:37], v[116:117]
    v_pk_add_f32 v[38:39], v[38:39], v[118:119]
    v_lshlrev_b32 v8, 16, v208
    v_and_b32 v9, 0xffff0000, v208
    v_pk_add_f32 v[16:17], v[16:17], v[8:9]
    v_lshlrev_b32 v10, 16, v209
    v_and_b32 v11, 0xffff0000, v209
    v_pk_add_f32 v[18:19], v[18:19], v[10:11]
    v_lshlrev_b32 v8, 16, v210
    v_and_b32 v9, 0xffff0000, v210
    v_pk_add_f32 v[20:21], v[20:21], v[8:9]
    v_lshlrev_b32 v10, 16, v211
    v_and_b32 v11, 0xffff0000, v211
    v_pk_add_f32 v[22:23], v[22:23], v[10:11]
    v_lshlrev_b32 v8, 16, v212
    v_and_b32 v9, 0xffff0000, v212
    v_pk_add_f32 v[24:25], v[24:25], v[8:9]
    v_lshlrev_b32 v10, 16, v213
    v_and_b32 v11, 0xffff0000, v213
    v_pk_add_f32 v[26:27], v[26:27], v[10:11]
    v_lshlrev_b32 v8, 16, v214
    v_and_b32 v9, 0xffff0000, v214
    v_pk_add_f32 v[28:29], v[28:29], v[8:9]
    v_lshlrev_b32 v10, 16, v215
    v_and_b32 v11, 0xffff0000, v215
    v_pk_add_f32 v[30:31], v[30:31], v[10:11]
    v_lshlrev_b32 v8, 16, v216
    v_and_b32 v9, 0xffff0000, v216
    v_pk_add_f32 v[32:33], v[32:33], v[8:9]
    v_lshlrev_b32 v10, 16, v217
    v_and_b32 v11, 0xffff0000, v217
    v_pk_add_f32 v[34:35], v[34:35], v[10:11]
    v_lshlrev_b32 v8, 16, v218
    v_and_b32 v9, 0xffff0000, v218
    v_pk_add_f32 v[36:37], v[36:37], v[8:9]
    v_lshlrev_b32 v10, 16, v219
    v_and_b32 v11, 0xffff0000, v219
    v_pk_add_f32 v[38:39], v[38:39], v[10:11]
    v_mov_b32 v100, v16
    v_mov_b32 v101, v17
    v_pk_mul_f32 v[102:103], v[16:17], v[16:17]
    v_mov_b32 v104, v20
    v_mov_b32 v105, v21
    v_pk_mul_f32 v[106:107], v[20:21], v[20:21]
    v_pk_add_f32 v[100:101], v[100:101], v[18:19]
    v_pk_fma_f32 v[102:103], v[18:19], v[18:19], v[102:103]
    v_pk_add_f32 v[104:105], v[104:105], v[22:23]
    v_pk_fma_f32 v[106:107], v[22:23], v[22:23], v[106:107]
    v_pk_add_f32 v[100:101], v[100:101], v[24:25]
    v_pk_fma_f32 v[102:103], v[24:25], v[24:25], v[102:103]
    v_pk_add_f32 v[104:105], v[104:105], v[28:29]
    v_pk_fma_f32 v[106:107], v[28:29], v[28:29], v[106:107]
    v_pk_add_f32 v[100:101], v[100:101], v[26:27]
    v_pk_fma_f32 v[102:103], v[26:27], v[26:27], v[102:103]
    v_pk_add_f32 v[104:105], v[104:105], v[30:31]
    v_pk_fma_f32 v[106:107], v[30:31], v[30:31], v[106:107]
    s_cmp_eq_u32 s85, 1
    s_cbranch_scc1 L_ps_64
    v_pk_add_f32 v[100:101], v[100:101], v[32:33]
    v_pk_fma_f32 v[102:103], v[32:33], v[32:33], v[102:103]
    v_pk_add_f32 v[104:105], v[104:105], v[36:37]
    v_pk_fma_f32 v[106:107], v[36:37], v[36:37], v[106:107]
    v_pk_add_f32 v[100:101], v[100:101], v[34:35]
    v_pk_fma_f32 v[102:103], v[34:35], v[34:35], v[102:103]
    v_pk_add_f32 v[104:105], v[104:105], v[38:39]
    v_pk_fma_f32 v[106:107], v[38:39], v[38:39], v[106:107]
L_ps_64:
    v_add_f32 v100, v100, v101
    v_add_f32 v101, v102, v103
    v_add_f32 v102, v104, v105
    v_add_f32 v103, v106, v107
    v_mov_b32 v104, v100
    v_mov_b32 v105, v101
    v_mov_b32 v106, v102
    v_mov_b32 v107, v103
    s_nop 0
    v_permlane32_swap_b32 v100, v104
    v_permlane32_swap_b32 v101, v105
    v_permlane32_swap_b32 v102, v106
    v_permlane32_swap_b32 v103, v107
    v_add_f32 v100, v100, v104
    v_add_f32 v101, v101, v105
    v_add_f32 v102, v102, v106
    v_add_f32 v103, v103, v107
    v_mov_b32 v104, v100
    v_mov_b32 v105, v101
    v_mov_b32 v106, v102
    v_mov_b32 v107, v103
    s_nop 1
    v_permlane16_swap_b32 v100, v104
    v_permlane16_swap_b32 v101, v105
    v_permlane16_swap_b32 v102, v106
    v_permlane16_swap_b32 v103, v107
    v_add_f32 v100, v100, v104
    v_add_f32 v101, v101, v105
    v_add_f32 v102, v102, v106
    v_add_f32 v103, v103, v107
    s_lshl_b32 s62, s84, 12
    s_add_u32 s93, s62, 8421376
    s_lshl_b32 s62, s79, 1
    s_add_u32 s62, s62, s85
    s_lshl_b32 s62, s62, 8
    s_add_u32 s62, s62, s93
    s_mov_b64 s[98:99], exec
    s_mov_b64 exec, 0xffff
    buffer_store_dwordx4 v[100:103], v2, s[8:11], s62 offen sc1
    s_mov_b64 exec, s[98:99]
    v_and_b32 v8, 15, v1
    v_lshrrev_b32 v9, 4, v1
    v_lshlrev_b32 v9, 8, v9
    v_lshl_add_u32 v8, v8, 4, v9
    v_lshlrev_b32 v132, 16, v220
    v_and_b32 v133, 0xffff0000, v220
    v_lshlrev_b32 v134, 16, v221
    v_and_b32 v135, 0xffff0000, v221
    v_lshlrev_b32 v136, 16, v222
    v_and_b32 v137, 0xffff0000, v222
    v_lshlrev_b32 v138, 16, v223
    v_and_b32 v139, 0xffff0000, v223
    v_lshlrev_b32 v140, 16, v224
    v_and_b32 v141, 0xffff0000, v224
    v_lshlrev_b32 v142, 16, v225
    v_and_b32 v143, 0xffff0000, v225
    v_lshlrev_b32 v144, 16, v226
    v_and_b32 v145, 0xffff0000, v226
    v_lshlrev_b32 v146, 16, v227
    v_and_b32 v147, 0xffff0000, v227
    v_lshlrev_b32 v148, 16, v228
    v_and_b32 v149, 0xffff0000, v228
    v_lshlrev_b32 v150, 16, v229
    v_and_b32 v151, 0xffff0000, v229
    v_lshlrev_b32 v152, 16, v230
    v_and_b32 v153, 0xffff0000, v230
    v_lshlrev_b32 v154, 16, v231
    v_and_b32 v155, 0xffff0000, v231
    s_sleep 10
L_lv_65:
    buffer_load_dwordx4 v[104:107], v8, s[8:11], s93 offen offset:0 sc1
    buffer_load_dwordx4 v[108:111], v8, s[8:11], s93 offen offset:1024 sc1
    buffer_load_dwordx4 v[112:115], v8, s[8:11], s93 offen offset:2048 sc1
    buffer_load_dwordx4 v[116:119], v8, s[8:11], s93 offen offset:3072 sc1
    s_waitcnt vmcnt(0)
    v_max3_u32 v6, v104, v105, v106
    v_max3_u32 v6, v6, v107, v108
    v_max3_u32 v6, v6, v109, v110
    v_max3_u32 v6, v6, v111, v112
    v_max3_u32 v6, v6, v113, v114
    v_max3_u32 v6, v6, v115, v116
    v_max3_u32 v6, v6, v117, v118
    v_max_u32 v6, v6, v119
    v_cmp_eq_u32 vcc, -1, v6
    s_nop 1
    s_cbranch_vccz L_lvok_66
    s_cmp_eq_u32 s97, 0
    s_cbranch_scc1 L_lvok_66
    s_sub_u32 s97, s97, 1
    s_sleep 1
    s_branch L_lv_65
L_lvok_66:
    v_add_f32 v104, v104, v108
    v_add_f32 v105, v105, v109
    v_add_f32 v106, v106, v110
    v_add_f32 v107, v107, v111
    v_add_f32 v104, v104, v112
    v_add_f32 v105, v105, v113
    v_add_f32 v106, v106, v114
    v_add_f32 v107, v107, v115
    v_add_f32 v104, v104, v116
    v_add_f32 v105, v105, v117
    v_add_f32 v106, v106, v118
    v_add_f32 v107, v107, v119
    v_mov_b32 v100, v104
    v_mov_b32 v101, v105
    v_mov_b32 v102, v106
    v_mov_b32 v103, v107
    s_nop 0
    v_permlane32_swap_b32 v104, v100
    v_permlane32_swap_b32 v105, v101
    v_permlane32_swap_b32 v106, v102
    v_permlane32_swap_b32 v107, v103
    v_add_f32 v104, v104, v100
    v_add_f32 v105, v105, v101
    v_add_f32 v106, v106, v102
    v_add_f32 v107, v107, v103
    v_mov_b32 v100, v104
    v_mov_b32 v101, v105
    v_mov_b32 v102, v106
    v_mov_b32 v103, v107
    s_nop 1
    v_permlane16_swap_b32 v104, v100
    v_permlane16_swap_b32 v105, v101
    v_permlane16_swap_b32 v106, v102
    v_permlane16_swap_b32 v107, v103
    v_add_f32 v104, v104, v100
    v_add_f32 v105, v105, v101
    v_add_f32 v106, v106, v102
    v_add_f32 v107, v107, v103
    v_mul_f32 v124, 0x3acccccd, v104
    v_mul_f32 v105, 0x3acccccd, v105
    v_mul_f32 v126, 0x3acccccd, v106
    v_mul_f32 v107, 0x3acccccd, v107
    v_fma_f32 v105, -v124, v124, v105
    v_fma_f32 v107, -v126, v126, v107
    v_max_f32 v105, 0, v105
    v_add_f32 v105, 0x3727c5ac, v105
    v_max_f32 v107, 0, v107
    v_add_f32 v107, 0x3727c5ac, v107
    v_rsq_f32 v125, v105
    v_rsq_f32 v127, v107
    s_nop 0
    v_mul_f32 v122, v124, v125
    v_mul_f32 v123, v126, v127
    s_add_u32 s62, s92, 8945664
    v_pk_fma_f32 v[8:9], v[16:17], v[124:125], v[122:123] op_sel:[0,1,0] op_sel_hi:[1,1,0] neg_lo:[0,0,1] neg_hi:[0,0,1]
    v_pk_fma_f32 v[10:11], v[18:19], v[124:125], v[122:123] op_sel:[0,1,0] op_sel_hi:[1,1,0] neg_lo:[0,0,1] neg_hi:[0,0,1]
    v_pk_fma_f32 v[16:17], v[8:9], v[132:133], v[16:17]
    v_pk_fma_f32 v[18:19], v[10:11], v[134:135], v[18:19]
    v_cvt_pk_bf16_f32 v156, v16, v17
    v_cvt_pk_bf16_f32 v157, v18, v19
    v_pk_fma_f32 v[8:9], v[20:21], v[126:127], v[122:123] op_sel:[0,1,1] op_sel_hi:[1,1,1] neg_lo:[0,0,1] neg_hi:[0,0,1]
    v_pk_fma_f32 v[10:11], v[22:23], v[126:127], v[122:123] op_sel:[0,1,1] op_sel_hi:[1,1,1] neg_lo:[0,0,1] neg_hi:[0,0,1]
    v_pk_fma_f32 v[20:21], v[8:9], v[136:137], v[20:21]
    v_pk_fma_f32 v[22:23], v[10:11], v[138:139], v[22:23]
    v_cvt_pk_bf16_f32 v158, v20, v21
    v_cvt_pk_bf16_f32 v159, v22, v23
    buffer_store_dwordx4 v[156:159], v2, s[8:11], s62 offen offset:0 sc1
    v_pk_fma_f32 v[8:9], v[24:25], v[124:125], v[122:123] op_sel:[0,1,0] op_sel_hi:[1,1,0] neg_lo:[0,0,1] neg_hi:[0,0,1]
    v_pk_fma_f32 v[10:11], v[26:27], v[124:125], v[122:123] op_sel:[0,1,0] op_sel_hi:[1,1,0] neg_lo:[0,0,1] neg_hi:[0,0,1]
    v_pk_fma_f32 v[24:25], v[8:9], v[140:141], v[24:25]
    v_pk_fma_f32 v[26:27], v[10:11], v[142:143], v[26:27]
    v_cvt_pk_bf16_f32 v160, v24, v25
    v_cvt_pk_bf16_f32 v161, v26, v27
    v_pk_fma_f32 v[8:9], v[28:29], v[126:127], v[122:123] op_sel:[0,1,1] op_sel_hi:[1,1,1] neg_lo:[0,0,1] neg_hi:[0,0,1]
    v_pk_fma_f32 v[10:11], v[30:31], v[126:127], v[122:123] op_sel:[0,1,1] op_sel_hi:[1,1,1] neg_lo:[0,0,1] neg_hi:[0,0,1]
    v_pk_fma_f32 v[28:29], v[8:9], v[144:145], v[28:29]
    v_pk_fma_f32 v[30:31], v[10:11], v[146:147], v[30:31]
    v_cvt_pk_bf16_f32 v162, v28, v29
    v_cvt_pk_bf16_f32 v163, v30, v31
    buffer_store_dwordx4 v[160:163], v2, s[8:11], s62 offen offset:1024 sc1
    s_cmp_eq_u32 s85, 1
    s_cbranch_scc1 L_x3_67
    v_pk_fma_f32 v[8:9], v[32:33], v[124:125], v[122:123] op_sel:[0,1,0] op_sel_hi:[1,1,0] neg_lo:[0,0,1] neg_hi:[0,0,1]
    v_pk_fma_f32 v[10:11], v[34:35], v[124:125], v[122:123] op_sel:[0,1,0] op_sel_hi:[1,1,0] neg_lo:[0,0,1] neg_hi:[0,0,1]
    v_pk_fma_f32 v[32:33], v[8:9], v[148:149], v[32:33]
    v_pk_fma_f32 v[34:35], v[10:11], v[150:151], v[34:35]
    v_cvt_pk_bf16_f32 v164, v32, v33
    v_cvt_pk_bf16_f32 v165, v34, v35
    v_pk_fma_f32 v[8:9], v[36:37], v[126:127], v[122:123] op_sel:[0,1,1] op_sel_hi:[1,1,1] neg_lo:[0,0,1] neg_hi:[0,0,1]
    v_pk_fma_f32 v[10:11], v[38:39], v[126:127], v[122:123] op_sel:[0,1,1] op_sel_hi:[1,1,1] neg_lo:[0,0,1] neg_hi:[0,0,1]
    v_pk_fma_f32 v[36:37], v[8:9], v[152:153], v[36:37]
    v_pk_fma_f32 v[38:39], v[10:11], v[154:155], v[38:39]
    v_cvt_pk_bf16_f32 v166, v36, v37
    v_cvt_pk_bf16_f32 v167, v38, v39
    buffer_store_dwordx4 v[164:167], v2, s[8:11], s62 offen offset:2048 sc1
L_x3_67:
    s_lshl_b32 s64, s76, 7
    s_add_u32 s64, s64, 4096
    s_waitcnt vmcnt(0)
    s_barrier
    s_cmp_lg_u32 s60, 0
    s_cbranch_scc1 L_arr_68
    s_mov_b64 s[98:99], exec
    s_mov_b64 exec, 1
    v_mov_b32 v4, s64
    v_mov_b32 v5, 1
    buffer_atomic_add v5, v4, s[8:11], 0 offen
    s_mov_b64 exec, s[98:99]
L_arr_68:
    s_mov_b32 s82, 1
    s_mov_b32 s80, 8945664
    s_mov_b32 s81, 16179200
    s_mul_i32 s88, s83, 40960
    s_add_u32 s88, s88, s80
    s_lshl_b32 s62, s77, 11
    s_add_u32 s90, s62, s88
    s_add_u32 s91, s90, 32768
    s_cmp_lt_u32 s77, 4
    s_cselect_b32 s91, s91, 0x20000000
    s_lshl_b32 s64, s76, 7
    s_add_u32 s64, s64, 4096
    s_cmp_lg_u32 s60, 0
    s_cbranch_scc1 L_wc_69
    v_mov_b32 v4, s64
    s_sleep 8
    buffer_load_dword v5, v4, s[8:11], 0 offen sc1
    s_waitcnt vmcnt(0)
L_pe_70:
    v_cmp_gt_u32 vcc, 16, v5
    s_nop 1
    s_cbranch_vccz L_pok_71
    s_cmp_eq_u32 s97, 0
    s_cbranch_scc1 L_pok_71
    s_sub_u32 s97, s97, 1
    s_sleep 2
    buffer_load_dword v5, v4, s[8:11], 0 offen sc1
    s_waitcnt vmcnt(0)
    s_branch L_pe_70
L_pok_71:
L_wc_69:
    s_barrier
    buffer_load_dwordx4 v[208:211], v2, s[8:11], s90 offen sc1
    buffer_load_dwordx4 v[212:215], v2, s[8:11], s90 offen offset:1024 sc1
    buffer_load_dwordx4 v[216:219], v2, s[8:11], s91 offen sc1
    buffer_load_dwordx4 v[220:223], v2, s[8:11], s91 offen offset:1024 sc1
    buffer_load_dwordx4 v[128:131], v2, s[8:11], s88 offen sc1
    buffer_load_dwordx4 v[132:135], v2, s[8:11], s88 offen offset:1024 sc1
    s_add_u32 s88, s88, 2048
    buffer_load_dwordx4 v[136:139], v2, s[8:11], s88 offen sc1
    buffer_load_dwordx4 v[140:143], v2, s[8:11], s88 offen offset:1024 sc1
    s_add_u32 s88, s88, 2048
    buffer_load_dwordx4 v[144:147], v2, s[8:11], s88 offen sc1
    buffer_load_dwordx4 v[148:151], v2, s[8:11], s88 offen offset:1024 sc1
    s_add_u32 s88, s88, 2048
    buffer_load_dwordx4 v[152:155], v2, s[8:11], s88 offen sc1
    buffer_load_dwordx4 v[156:159], v2, s[8:11], s88 offen offset:1024 sc1
    s_add_u32 s88, s88, 2048
    buffer_load_dwordx4 v[160:163], v2, s[8:11], s88 offen sc1
    buffer_load_dwordx4 v[164:167], v2, s[8:11], s88 offen offset:1024 sc1
    s_add_u32 s88, s88, 2048
    buffer_load_dwordx4 v[168:171], v2, s[8:11], s88 offen sc1
    buffer_load_dwordx4 v[172:175], v2, s[8:11], s88 offen offset:1024 sc1
    s_add_u32 s88, s88, 2048
    v_mov_b32 v3, v2
    v_add_u32 v4, 64512, v2
    v_add_u32 v5, 93184, v2
    ds_read_b128 v[72:75], v3 offset:0
    ds_read_b128 v[76:79], v3 offset:1024
    ds_read_b128 v[80:83], v3 offset:2048
    ds_read_b128 v[84:87], v3 offset:3072
    ds_read_b128 v[88:91], v3 offset:4096
    ds_read_b128 v[92:95], v3 offset:5120
    ds_read_b128 v[96:99], v3 offset:6144
    s_mul_i32 s62, s82, 262144
    s_lshl_b32 s63, s83, 12
    s_add_u32 s62, s62, s63
    s_add_u32 s89, s62, 7897088
    s_lshl_b32 s63, s77, 8
    s_add_u32 s93, s89, s63
    v_mov_b32 v16, 0x3f803f80
    v_mov_b32 v17, 0x3f803f80
    v_mov_b32 v18, 0x3f803f80
    v_mov_b32 v19, 0x3f803f80
    v_and_b32 v6, 15, v1
    v_lshrrev_b32 v7, 4, v1
    v_lshrrev_b32 v8, 2, v6
    v_cmp_eq_u32 vcc, v7, v8
    v_lshlrev_b32 v9, 4, v6
    v_mov_b32 v10, 0x20000000
    v_cndmask_b32 v229, v10, v9, vcc
    v_and_b32 v6, 3, v6
    v_cmp_eq_u32 s[62:63], 1, v6
    v_cmp_eq_u32 s[64:65], 2, v6
    v_cmp_eq_u32 s[66:67], 3, v6
    s_waitcnt vmcnt(12)
    v_swap_b32 v210, v212
    v_swap_b32 v211, v213
    v_swap_b32 v218, v220
    v_swap_b32 v219, v221
    s_nop 0
    v_mfma_f32_16x16x32_bf16 v[20:23], v[16:19], v[208:211], 0
    v_mfma_f32_16x16x32_bf16 v[24:27], v[208:211], v[208:211], 0
    v_mfma_f32_16x16x32_bf16 v[28:31], v[16:19], v[212:215], 0
    v_mfma_f32_16x16x32_bf16 v[32:35], v[212:215], v[212:215], 0
    v_mfma_f32_16x16x32_bf16 v[20:23], v[16:19], v[216:219], v[20:23]
    v_mfma_f32_16x16x32_bf16 v[24:27], v[216:219], v[216:219], v[24:27]
    v_mfma_f32_16x16x32_bf16 v[28:31], v[16:19], v[220:223], v[28:31]
    v_mfma_f32_16x16x32_bf16 v[32:35], v[220:223], v[220:223], v[32:35]
    s_nop 7
    v_mov_b32 v224, v20
    v_mov_b32 v226, v28
    v_cndmask_b32 v225, v24, v25, s[62:63]
    v_cndmask_b32 v225, v225, v26, s[64:65]
    v_cndmask_b32 v225, v225, v27, s[66:67]
    v_cndmask_b32 v227, v32, v33, s[62:63]
    v_cndmask_b32 v227, v227, v34, s[64:65]
    v_cndmask_b32 v227, v227, v35, s[66:67]
    buffer_store_dwordx4 v[224:227], v229, s[8:11], s93 offen sc1
    s_mul_i32 s62, s83, 110592
    s_mul_i32 s63, s77, 7168
    s_add_u32 s62, s62, s63
    s_add_u32 s62, s62, s81
    s_add_u32 s63, s62, 3072
    s_cmp_eq_u32 s77, 15
    s_cselect_b32 s63, 0x20000000, s63
    v_lshrrev_b32 v9, 4, v1
    v_lshlrev_b32 v9, 4, v9
    s_mul_i32 s64, s77, 448
    s_add_u32 s64, s64, 11649024
    s_waitcnt vmcnt(10)
    v_swap_b32 v130, v132
    v_swap_b32 v131, v133
    s_nop 0
    s_waitcnt lgkmcnt(0)
    v_mfma_f32_16x16x32_bf16 v[16:19], v[72:75], v[128:131], 0
    ds_read_b128 v[100:103], v3 offset:7168
    buffer_load_dwordx4 v[176:179], v2, s[8:11], s88 offen sc1
    v_mfma_f32_16x16x32_bf16 v[44:47], v[72:75], v[132:135], 0
    ds_read_b128 v[104:107], v3 offset:8192
    buffer_load_dwordx4 v[180:183], v2, s[8:11], s88 offen offset:1024 sc1
    s_add_u32 s88, s88, 2048
    v_mfma_f32_16x16x32_bf16 v[20:23], v[76:79], v[128:131], 0
    ds_read_b128 v[108:111], v3 offset:9216
    buffer_load_dwordx4 v[184:187], v2, s[8:11], s88 offen sc1
    v_mfma_f32_16x16x32_bf16 v[48:51], v[76:79], v[132:135], 0
    ds_read_b128 v[112:115], v3 offset:10240
    buffer_load_dwordx4 v[188:191], v2, s[8:11], s88 offen offset:1024 sc1
    s_add_u32 s88, s88, 2048
    v_mfma_f32_16x16x32_bf16 v[24:27], v[80:83], v[128:131], 0
    ds_read_b128 v[116:119], v3 offset:11264
    v_mfma_f32_16x16x32_bf16 v[52:55], v[80:83], v[132:135], 0
    ds_read_b128 v[120:123], v3 offset:12288
    v_mfma_f32_16x16x32_bf16 v[28:31], v[84:87], v[128:131], 0
    ds_read_b128 v[124:127], v3 offset:13312
    v_mfma_f32_16x16x32_bf16 v[56:59], v[84:87], v[132:135], 0
    v_mfma_f32_16x16x32_bf16 v[32:35], v[88:91], v[128:131], 0
    v_mfma_f32_16x16x32_bf16 v[60:63], v[88:91], v[132:135], 0
    v_mfma_f32_16x16x32_bf16 v[36:39], v[92:95], v[128:131], 0
    s_waitcnt vmcnt(12)
    v_mfma_f32_16x16x32_bf16 v[64:67], v[92:95], v[132:135], 0
    v_swap_b32 v138, v140
    v_mfma_f32_16x16x32_bf16 v[40:43], v[96:99], v[128:131], 0
    v_swap_b32 v139, v141
    v_mfma_f32_16x16x32_bf16 v[68:71], v[96:99], v[132:135], 0
    s_waitcnt lgkmcnt(0)
    v_mfma_f32_16x16x32_bf16 v[16:19], v[100:103], v[136:139], v[16:19]
    ds_read_b128 v[72:75], v3 offset:14336
    buffer_load_dwordx4 v[192:195], v2, s[8:11], s88 offen sc1
    v_mfma_f32_16x16x32_bf16 v[44:47], v[100:103], v[140:143], v[44:47]
    ds_read_b128 v[76:79], v3 offset:15360
    buffer_load_dwordx4 v[196:199], v2, s[8:11], s88 offen offset:1024 sc1
    s_add_u32 s88, s88, 2048
    v_mfma_f32_16x16x32_bf16 v[20:23], v[104:107], v[136:139], v[20:23]
    ds_read_b128 v[80:83], v3 offset:16384
    buffer_load_dwordx4 v[200:203], v2, s[8:11], s88 offen sc1
    v_mfma_f32_16x16x32_bf16 v[48:51], v[104:107], v[140:143], v[48:51]
    ds_read_b128 v[84:87], v3 offset:17408
    buffer_load_dwordx4 v[204:207], v2, s[8:11], s88 offen offset:1024 sc1
    s_add_u32 s88, s88, 2048
    v_mfma_f32_16x16x32_bf16 v[24:27], v[108:111], v[136:139], v[24:27]
    ds_read_b128 v[88:91], v3 offset:18432
    v_mfma_f32_16x16x32_bf16 v[52:55], v[108:111], v[140:143], v[52:55]
    ds_read_b128 v[92:95], v3 offset:19456
    v_mfma_f32_16x16x32_bf16 v[28:31], v[112:115], v[136:139], v[28:31]
    ds_read_b128 v[96:99], v3 offset:20480
    v_mfma_f32_16x16x32_bf16 v[56:59], v[112:115], v[140:143], v[56:59]
    v_mfma_f32_16x16x32_bf16 v[32:35], v[116:119], v[136:139], v[32:35]
    v_mfma_f32_16x16x32_bf16 v[60:63], v[116:119], v[140:143], v[60:63]
    v_mfma_f32_16x16x32_bf16 v[36:39], v[120:123], v[136:139], v[36:39]
    s_waitcnt vmcnt(14)
    v_mfma_f32_16x16x32_bf16 v[64:67], v[120:123], v[140:143], v[64:67]
    v_swap_b32 v146, v148
    v_mfma_f32_16x16x32_bf16 v[40:43], v[124:127], v[136:139], v[40:43]
    v_swap_b32 v147, v149
    v_mfma_f32_16x16x32_bf16 v[68:71], v[124:127], v[140:143], v[68:71]
    s_waitcnt lgkmcnt(0)
    v_mfma_f32_16x16x32_bf16 v[16:19], v[72:75], v[144:147], v[16:19]
    ds_read_b128 v[100:103], v3 offset:21504
    buffer_load_dwordx4 v[128:131], v2, s[8:11], s88 offen sc1
    v_mfma_f32_16x16x32_bf16 v[44:47], v[72:75], v[148:151], v[44:47]
    ds_read_b128 v[104:107], v3 offset:22528
    buffer_load_dwordx4 v[132:135], v2, s[8:11], s88 offen offset:1024 sc1
    s_add_u32 s88, s88, 2048
    v_mfma_f32_16x16x32_bf16 v[20:23], v[76:79], v[144:147], v[20:23]
    ds_read_b128 v[108:111], v3 offset:23552
    buffer_load_dwordx4 v[136:139], v2, s[8:11], s88 offen sc1
    v_mfma_f32_16x16x32_bf16 v[48:51], v[76:79], v[148:151], v[48:51]
    ds_read_b128 v[112:115], v3 offset:24576
    buffer_load_dwordx4 v[140:143], v2, s[8:11], s88 offen offset:1024 sc1
    s_add_u32 s88, s88, 2048
    v_mfma_f32_16x16x32_bf16 v[24:27], v[80:83], v[144:147], v[24:27]
    ds_read_b128 v[116:119], v3 offset:25600
    v_mfma_f32_16x16x32_bf16 v[52:55], v[80:83], v[148:151], v[52:55]
    ds_read_b128 v[120:123], v3 offset:26624
    v_mfma_f32_16x16x32_bf16 v[28:31], v[84:87], v[144:147], v[28:31]
    ds_read_b128 v[124:127], v3 offset:27648
    v_mfma_f32_16x16x32_bf16 v[56:59], v[84:87], v[148:151], v[56:59]
    v_mfma_f32_16x16x32_bf16 v[32:35], v[88:91], v[144:147], v[32:35]
    v_mfma_f32_16x16x32_bf16 v[60:63], v[88:91], v[148:151], v[60:63]
    v_mfma_f32_16x16x32_bf16 v[36:39], v[92:95], v[144:147], v[36:39]
    s_waitcnt vmcnt(16)
    v_mfma_f32_16x16x32_bf16 v[64:67], v[92:95], v[148:151], v[64:67]
    v_swap_b32 v154, v156
    v_mfma_f32_16x16x32_bf16 v[40:43], v[96:99], v[144:147], v[40:43]
    v_swap_b32 v155, v157
    v_mfma_f32_16x16x32_bf16 v[68:71], v[96:99], v[148:151], v[68:71]
    s_waitcnt lgkmcnt(0)
    v_mfma_f32_16x16x32_bf16 v[16:19], v[100:103], v[152:155], v[16:19]
    ds_read_b128 v[72:75], v3 offset:28672
    buffer_load_dwordx4 v[144:147], v2, s[8:11], s88 offen sc1
    v_mfma_f32_16x16x32_bf16 v[44:47], v[100:103], v[156:159], v[44:47]
    ds_read_b128 v[76:79], v3 offset:29696
    buffer_load_dwordx4 v[148:151], v2, s[8:11], s88 offen offset:1024 sc1
    s_add_u32 s88, s88, 2048
    v_mfma_f32_16x16x32_bf16 v[20:23], v[104:107], v[152:155], v[20:23]
    ds_read_b128 v[80:83], v3 offset:30720
    v_mfma_f32_16x16x32_bf16 v[48:51], v[104:107], v[156:159], v[48:51]
    ds_read_b128 v[84:87], v3 offset:31744
    v_mfma_f32_16x16x32_bf16 v[24:27], v[108:111], v[152:155], v[24:27]
    ds_read_b128 v[88:91], v3 offset:32768
    v_mfma_f32_16x16x32_bf16 v[52:55], v[108:111], v[156:159], v[52:55]
    ds_read_b128 v[92:95], v3 offset:33792
    v_mfma_f32_16x16x32_bf16 v[28:31], v[112:115], v[152:155], v[28:31]
    ds_read_b128 v[96:99], v3 offset:34816
    v_mfma_f32_16x16x32_bf16 v[56:59], v[112:115], v[156:159], v[56:59]
    v_mfma_f32_16x16x32_bf16 v[32:35], v[116:119], v[152:155], v[32:35]
    v_mfma_f32_16x16x32_bf16 v[60:63], v[116:119], v[156:159], v[60:63]
    v_mfma_f32_16x16x32_bf16 v[36:39], v[120:123], v[152:155], v[36:39]
    s_waitcnt vmcnt(16)
    v_mfma_f32_16x16x32_bf16 v[64:67], v[120:123], v[156:159], v[64:67]
    v_swap_b32 v162, v164
    v_mfma_f32_16x16x32_bf16 v[40:43], v[124:127], v[152:155], v[40:43]
    v_swap_b32 v163, v165
    v_mfma_f32_16x16x32_bf16 v[68:71], v[124:127], v[156:159], v[68:71]
    s_waitcnt lgkmcnt(0)
    v_mfma_f32_16x16x32_bf16 v[16:19], v[72:75], v[160:163], v[16:19]
    ds_read_b128 v[100:103], v3 offset:35840
    buffer_load_dwordx4 v[152:155], v2, s[8:11], s88 offen sc1
    v_mfma_f32_16x16x32_bf16 v[44:47], v[72:75], v[164:167], v[44:47]
    ds_read_b128 v[104:107], v3 offset:36864
    buffer_load_dwordx4 v[156:159], v2, s[8:11], s88 offen offset:1024 sc1
    s_add_u32 s88, s88, 2048
    v_mfma_f32_16x16x32_bf16 v[20:23], v[76:79], v[160:163], v[20:23]
    ds_read_b128 v[108:111], v3 offset:37888
    v_mfma_f32_16x16x32_bf16 v[48:51], v[76:79], v[164:167], v[48:51]
    ds_read_b128 v[112:115], v3 offset:38912
    v_mfma_f32_16x16x32_bf16 v[24:27], v[80:83], v[160:163], v[24:27]
    ds_read_b128 v[116:119], v3 offset:39936
    v_mfma_f32_16x16x32_bf16 v[52:55], v[80:83], v[164:167], v[52:55]
    ds_read_b128 v[120:123], v3 offset:40960
    v_mfma_f32_16x16x32_bf16 v[28:31], v[84:87], v[160:163], v[28:31]
    ds_read_b128 v[124:127], v3 offset:41984
    v_mfma_f32_16x16x32_bf16 v[56:59], v[84:87], v[164:167], v[56:59]
    v_and_b32 v8, 15, v1
    v_lshrrev_b32 v7, 4, v1
    v_mfma_f32_16x16x32_bf16 v[32:35], v[88:91], v[160:163], v[32:35]
    v_lshlrev_b32 v7, 8, v7
    v_lshl_add_u32 v8, v8, 4, v7
    v_mfma_f32_16x16x32_bf16 v[60:63], v[88:91], v[164:167], v[60:63]
    v_mfma_f32_16x16x32_bf16 v[36:39], v[92:95], v[160:163], v[36:39]
    s_waitcnt vmcnt(16)
    v_mfma_f32_16x16x32_bf16 v[64:67], v[92:95], v[164:167], v[64:67]
    v_swap_b32 v170, v172
    v_mfma_f32_16x16x32_bf16 v[40:43], v[96:99], v[160:163], v[40:43]
    v_swap_b32 v171, v173
    v_mfma_f32_16x16x32_bf16 v[68:71], v[96:99], v[164:167], v[68:71]
    s_waitcnt lgkmcnt(0)
    v_mfma_f32_16x16x32_bf16 v[16:19], v[100:103], v[168:171], v[16:19]
    ds_read_b128 v[72:75], v3 offset:43008
    buffer_load_dwordx4 v[160:163], v2, s[8:11], s88 offen sc1
    v_mfma_f32_16x16x32_bf16 v[44:47], v[100:103], v[172:175], v[44:47]
    ds_read_b128 v[76:79], v3 offset:44032
    buffer_load_dwordx4 v[164:167], v2, s[8:11], s88 offen offset:1024 sc1
    s_add_u32 s88, s88, 2048
    v_mfma_f32_16x16x32_bf16 v[20:23], v[104:107], v[168:171], v[20:23]
    ds_read_b128 v[80:83], v3 offset:45056
    v_mfma_f32_16x16x32_bf16 v[48:51], v[104:107], v[172:175], v[48:51]
    ds_read_b128 v[84:87], v3 offset:46080
    v_mfma_f32_16x16x32_bf16 v[24:27], v[108:111], v[168:171], v[24:27]
    ds_read_b128 v[88:91], v3 offset:47104
    v_mfma_f32_16x16x32_bf16 v[52:55], v[108:111], v[172:175], v[52:55]
    ds_read_b128 v[92:95], v3 offset:48128
    buffer_load_dwordx4 v[208:211], v8, s[8:11], s89 offen offset:0 sc1
    v_mfma_f32_16x16x32_bf16 v[28:31], v[112:115], v[168:171], v[28:31]
    ds_read_b128 v[96:99], v3 offset:49152
    buffer_load_dwordx4 v[212:215], v8, s[8:11], s89 offen offset:1024 sc1
    v_mfma_f32_16x16x32_bf16 v[56:59], v[112:115], v[172:175], v[56:59]
    buffer_load_dwordx4 v[216:219], v8, s[8:11], s89 offen offset:2048 sc1
    v_mfma_f32_16x16x32_bf16 v[32:35], v[116:119], v[168:171], v[32:35]
    buffer_load_dwordx4 v[220:223], v8, s[8:11], s89 offen offset:3072 sc1
    v_mfma_f32_16x16x32_bf16 v[60:63], v[116:119], v[172:175], v[60:63]
    v_mfma_f32_16x16x32_bf16 v[36:39], v[120:123], v[168:171], v[36:39]
    s_waitcnt vmcnt(20)
    v_mfma_f32_16x16x32_bf16 v[64:67], v[120:123], v[172:175], v[64:67]
    v_swap_b32 v178, v180
    v_mfma_f32_16x16x32_bf16 v[40:43], v[124:127], v[168:171], v[40:43]
    v_swap_b32 v179, v181
    v_mfma_f32_16x16x32_bf16 v[68:71], v[124:127], v[172:175], v[68:71]
    s_waitcnt lgkmcnt(0)
    v_mfma_f32_16x16x32_bf16 v[16:19], v[72:75], v[176:179], v[16:19]
    ds_read_b128 v[100:103], v3 offset:50176
    buffer_load_dwordx4 v[168:171], v2, s[8:11], s88 offen sc1
    v_mfma_f32_16x16x32_bf16 v[44:47], v[72:75], v[180:183], v[44:47]
    ds_read_b128 v[104:107], v3 offset:51200
    buffer_load_dwordx4 v[172:175], v2, s[8:11], s88 offen offset:1024 sc1
    s_add_u32 s88, s88, 2048
    v_mfma_f32_16x16x32_bf16 v[20:23], v[76:79], v[176:179], v[20:23]
    ds_read_b128 v[108:111], v3 offset:52224
    v_mfma_f32_16x16x32_bf16 v[48:51], v[76:79], v[180:183], v[48:51]
    ds_read_b128 v[112:115], v3 offset:53248
    v_mfma_f32_16x16x32_bf16 v[24:27], v[80:83], v[176:179], v[24:27]
    ds_read_b128 v[116:119], v3 offset:54272
    v_mfma_f32_16x16x32_bf16 v[52:55], v[80:83], v[180:183], v[52:55]
    ds_read_b128 v[120:123], v3 offset:55296
    v_mfma_f32_16x16x32_bf16 v[28:31], v[84:87], v[176:179], v[28:31]
    ds_read_b128 v[124:127], v3 offset:56320
    v_mfma_f32_16x16x32_bf16 v[56:59], v[84:87], v[180:183], v[56:59]
    v_mfma_f32_16x16x32_bf16 v[32:35], v[88:91], v[176:179], v[32:35]
    v_mfma_f32_16x16x32_bf16 v[60:63], v[88:91], v[180:183], v[60:63]
    v_mfma_f32_16x16x32_bf16 v[36:39], v[92:95], v[176:179], v[36:39]
    s_waitcnt vmcnt(20)
    v_mfma_f32_16x16x32_bf16 v[64:67], v[92:95], v[180:183], v[64:67]
    v_swap_b32 v186, v188
    v_mfma_f32_16x16x32_bf16 v[40:43], v[96:99], v[176:179], v[40:43]
    v_swap_b32 v187, v189
    v_mfma_f32_16x16x32_bf16 v[68:71], v[96:99], v[180:183], v[68:71]
    s_waitcnt lgkmcnt(0)
    v_mfma_f32_16x16x32_bf16 v[16:19], v[100:103], v[184:187], v[16:19]
    ds_read_b128 v[72:75], v3 offset:57344
    buffer_load_dwordx4 v[176:179], v2, s[8:11], s88 offen sc1
    v_mfma_f32_16x16x32_bf16 v[44:47], v[100:103], v[188:191], v[44:47]
    ds_read_b128 v[76:79], v3 offset:58368
    buffer_load_dwordx4 v[180:183], v2, s[8:11], s88 offen offset:1024 sc1
    s_add_u32 s88, s88, 2048
    v_mfma_f32_16x16x32_bf16 v[20:23], v[104:107], v[184:187], v[20:23]
    ds_read_b128 v[80:83], v3 offset:59392
    v_mfma_f32_16x16x32_bf16 v[48:51], v[104:107], v[188:191], v[48:51]
    ds_read_b128 v[84:87], v3 offset:60416
    v_mfma_f32_16x16x32_bf16 v[24:27], v[108:111], v[184:187], v[24:27]
    ds_read_b128 v[88:91], v3 offset:61440
    v_mfma_f32_16x16x32_bf16 v[52:55], v[108:111], v[188:191], v[52:55]
    ds_read_b128 v[92:95], v3 offset:62464
    v_mfma_f32_16x16x32_bf16 v[28:31], v[112:115], v[184:187], v[28:31]
    ds_read_b128 v[96:99], v3 offset:63488
    v_mfma_f32_16x16x32_bf16 v[56:59], v[112:115], v[188:191], v[56:59]
    v_mfma_f32_16x16x32_bf16 v[32:35], v[116:119], v[184:187], v[32:35]
    v_mfma_f32_16x16x32_bf16 v[60:63], v[116:119], v[188:191], v[60:63]
    v_mfma_f32_16x16x32_bf16 v[36:39], v[120:123], v[184:187], v[36:39]
    s_waitcnt vmcnt(20)
    v_mfma_f32_16x16x32_bf16 v[64:67], v[120:123], v[188:191], v[64:67]
    v_swap_b32 v194, v196
    v_mfma_f32_16x16x32_bf16 v[40:43], v[124:127], v[184:187], v[40:43]
    v_swap_b32 v195, v197
    v_mfma_f32_16x16x32_bf16 v[68:71], v[124:127], v[188:191], v[68:71]
    s_waitcnt vmcnt(4)
    s_waitcnt lgkmcnt(0)
    v_mfma_f32_16x16x32_bf16 v[16:19], v[72:75], v[192:195], v[16:19]
    ds_read_b128 v[100:103], v4 offset:0
    buffer_load_dwordx4 v[184:187], v2, s[8:11], s88 offen sc1
    v_mfma_f32_16x16x32_bf16 v[44:47], v[72:75], v[196:199], v[44:47]
    ds_read_b128 v[104:107], v4 offset:1024
    buffer_load_dwordx4 v[188:191], v2, s[8:11], s88 offen offset:1024 sc1
    s_add_u32 s88, s88, 2048
    v_max3_u32 v11, v208, v209, v210
    v_mfma_f32_16x16x32_bf16 v[20:23], v[76:79], v[192:195], v[20:23]
    ds_read_b128 v[108:111], v4 offset:2048
    v_max3_u32 v11, v11, v211, v212
    v_mfma_f32_16x16x32_bf16 v[48:51], v[76:79], v[196:199], v[48:51]
    ds_read_b128 v[112:115], v4 offset:3072
    v_max3_u32 v11, v11, v213, v214
    v_mfma_f32_16x16x32_bf16 v[24:27], v[80:83], v[192:195], v[24:27]
    ds_read_b128 v[116:119], v4 offset:4096
    v_max3_u32 v11, v11, v215, v216
    v_mfma_f32_16x16x32_bf16 v[52:55], v[80:83], v[196:199], v[52:55]
    ds_read_b128 v[120:123], v4 offset:5120
    v_max3_u32 v11, v11, v217, v218
    v_mfma_f32_16x16x32_bf16 v[28:31], v[84:87], v[192:195], v[28:31]
    ds_read_b128 v[124:127], v4 offset:6144
    v_max3_u32 v11, v11, v219, v220
    v_mfma_f32_16x16x32_bf16 v[56:59], v[84:87], v[196:199], v[56:59]
    v_max3_u32 v11, v11, v221, v222
    v_mfma_f32_16x16x32_bf16 v[32:35], v[88:91], v[192:195], v[32:35]
    v_max_u32 v11, v11, v223
    v_mfma_f32_16x16x32_bf16 v[60:63], v[88:91], v[196:199], v[60:63]
    v_cmp_eq_u32 vcc, -1, v11
    v_mfma_f32_16x16x32_bf16 v[36:39], v[92:95], v[192:195], v[36:39]
    s_waitcnt vmcnt(20)
    v_mfma_f32_16x16x32_bf16 v[64:67], v[92:95], v[196:199], v[64:67]
    v_swap_b32 v202, v204
    v_mfma_f32_16x16x32_bf16 v[40:43], v[96:99], v[192:195], v[40:43]
    v_swap_b32 v203, v205
    v_mfma_f32_16x16x32_bf16 v[68:71], v[96:99], v[196:199], v[68:71]
    s_cbranch_vccnz L_g1l1_gstub
L_g1l1_gok:
    s_waitcnt lgkmcnt(0)
    v_mfma_f32_16x16x32_bf16 v[16:19], v[100:103], v[200:203], v[16:19]
    ds_read_b128 v[72:75], v4 offset:7168
    buffer_load_dwordx4 v[192:195], v2, s[8:11], s88 offen sc1
    v_add_f32 v208, v208, v212
    v_mfma_f32_16x16x32_bf16 v[44:47], v[100:103], v[204:207], v[44:47]
    ds_read_b128 v[76:79], v4 offset:8192
    buffer_load_dwordx4 v[196:199], v2, s[8:11], s88 offen offset:1024 sc1
    s_add_u32 s88, s88, 2048
    v_add_f32 v209, v209, v213
    v_mfma_f32_16x16x32_bf16 v[20:23], v[104:107], v[200:203], v[20:23]
    ds_read_b128 v[80:83], v4 offset:9216
    v_add_f32 v210, v210, v214
    v_mfma_f32_16x16x32_bf16 v[48:51], v[104:107], v[204:207], v[48:51]
    ds_read_b128 v[84:87], v4 offset:10240
    v_add_f32 v211, v211, v215
    v_mfma_f32_16x16x32_bf16 v[24:27], v[108:111], v[200:203], v[24:27]
    ds_read_b128 v[88:91], v4 offset:11264
    v_add_f32 v208, v208, v216
    v_mfma_f32_16x16x32_bf16 v[52:55], v[108:111], v[204:207], v[52:55]
    ds_read_b128 v[92:95], v4 offset:12288
    v_add_f32 v209, v209, v217
    v_mfma_f32_16x16x32_bf16 v[28:31], v[112:115], v[200:203], v[28:31]
    ds_read_b128 v[96:99], v4 offset:13312
    v_add_f32 v210, v210, v218
    v_mfma_f32_16x16x32_bf16 v[56:59], v[112:115], v[204:207], v[56:59]
    v_add_f32 v211, v211, v219
    v_mfma_f32_16x16x32_bf16 v[32:35], v[116:119], v[200:203], v[32:35]
    v_add_f32 v208, v208, v220
    v_mfma_f32_16x16x32_bf16 v[60:63], v[116:119], v[204:207], v[60:63]
    v_add_f32 v209, v209, v221
    v_mfma_f32_16x16x32_bf16 v[36:39], v[120:123], v[200:203], v[36:39]
    s_waitcnt vmcnt(20)
    v_add_f32 v210, v210, v222
    v_mfma_f32_16x16x32_bf16 v[64:67], v[120:123], v[204:207], v[64:67]
    v_swap_b32 v130, v132
    v_add_f32 v211, v211, v223
    v_mfma_f32_16x16x32_bf16 v[40:43], v[124:127], v[200:203], v[40:43]
    v_swap_b32 v131, v133
    v_mov_b32 v6, v208
    v_mfma_f32_16x16x32_bf16 v[68:71], v[124:127], v[204:207], v[68:71]
    s_waitcnt lgkmcnt(0)
    v_mfma_f32_16x16x32_bf16 v[16:19], v[72:75], v[128:131], v[16:19]
    ds_read_b128 v[100:103], v4 offset:14336
    buffer_load_dwordx4 v[200:203], v2, s[8:11], s88 offen sc1
    v_mov_b32 v7, v209
    v_mfma_f32_16x16x32_bf16 v[44:47], v[72:75], v[132:135], v[44:47]
    ds_read_b128 v[104:107], v4 offset:15360
    buffer_load_dwordx4 v[204:207], v2, s[8:11], s88 offen offset:1024 sc1
    s_add_u32 s88, s88, 2048
    v_mov_b32 v8, v210
    v_mfma_f32_16x16x32_bf16 v[20:23], v[76:79], v[128:131], v[20:23]
    ds_read_b128 v[108:111], v4 offset:16384
    v_mov_b32 v9, v211
    v_mfma_f32_16x16x32_bf16 v[48:51], v[76:79], v[132:135], v[48:51]
    ds_read_b128 v[112:115], v4 offset:17408
    s_nop 0
    v_mfma_f32_16x16x32_bf16 v[24:27], v[80:83], v[128:131], v[24:27]
    ds_read_b128 v[116:119], v4 offset:18432
    v_permlane32_swap_b32 v208, v6
    v_mfma_f32_16x16x32_bf16 v[52:55], v[80:83], v[132:135], v[52:55]
    ds_read_b128 v[120:123], v4 offset:19456
    v_permlane32_swap_b32 v209, v7
    v_mfma_f32_16x16x32_bf16 v[28:31], v[84:87], v[128:131], v[28:31]
    ds_read_b128 v[124:127], v4 offset:20480
    v_permlane32_swap_b32 v210, v8
    v_mfma_f32_16x16x32_bf16 v[56:59], v[84:87], v[132:135], v[56:59]
    v_permlane32_swap_b32 v211, v9
    v_mfma_f32_16x16x32_bf16 v[32:35], v[88:91], v[128:131], v[32:35]
    v_add_f32 v208, v208, v6
    v_mfma_f32_16x16x32_bf16 v[60:63], v[88:91], v[132:135], v[60:63]
    v_lshrrev_b32 v10, 4, v1
    v_lshlrev_b32 v10, 4, v10
    v_add_f32 v209, v209, v7
    v_mfma_f32_16x16x32_bf16 v[36:39], v[92:95], v[128:131], v[36:39]
    s_waitcnt vmcnt(20)
    v_add_f32 v210, v210, v8
    v_mfma_f32_16x16x32_bf16 v[64:67], v[92:95], v[132:135], v[64:67]
    v_swap_b32 v138, v140
    v_add_f32 v211, v211, v9
    v_mfma_f32_16x16x32_bf16 v[40:43], v[96:99], v[128:131], v[40:43]
    v_swap_b32 v139, v141
    v_mov_b32 v6, v208
    v_mfma_f32_16x16x32_bf16 v[68:71], v[96:99], v[132:135], v[68:71]
    s_waitcnt lgkmcnt(0)
    v_mfma_f32_16x16x32_bf16 v[16:19], v[100:103], v[136:139], v[16:19]
    ds_read_b128 v[72:75], v4 offset:21504
    v_mov_b32 v7, v209
    v_mfma_f32_16x16x32_bf16 v[44:47], v[100:103], v[140:143], v[44:47]
    ds_read_b128 v[76:79], v4 offset:22528
    v_mov_b32 v8, v210
    v_mfma_f32_16x16x32_bf16 v[20:23], v[104:107], v[136:139], v[20:23]
    ds_read_b128 v[80:83], v4 offset:23552
    v_mov_b32 v9, v211
    v_mfma_f32_16x16x32_bf16 v[48:51], v[104:107], v[140:143], v[48:51]
    ds_read_b128 v[84:87], v4 offset:24576
    s_nop 0
    v_mfma_f32_16x16x32_bf16 v[24:27], v[108:111], v[136:139], v[24:27]
    ds_read_b128 v[88:91], v4 offset:25600
    v_permlane16_swap_b32 v208, v6
    v_mfma_f32_16x16x32_bf16 v[52:55], v[108:111], v[140:143], v[52:55]
    ds_read_b128 v[92:95], v4 offset:26624
    v_permlane16_swap_b32 v209, v7
    v_mfma_f32_16x16x32_bf16 v[28:31], v[112:115], v[136:139], v[28:31]
    ds_read_b128 v[96:99], v4 offset:27648
    v_mfma_f32_16x16x32_bf16 v[56:59], v[112:115], v[140:143], v[56:59]
    buffer_load_dwordx4 v[128:131], v10, s[8:11], s64 offen offset:0 sc1
    v_permlane16_swap_b32 v210, v8
    v_mfma_f32_16x16x32_bf16 v[32:35], v[116:119], v[136:139], v[32:35]
    buffer_load_dwordx4 v[132:135], v10, s[8:11], s64 offen offset:64 sc1
    v_permlane16_swap_b32 v211, v9
    v_mfma_f32_16x16x32_bf16 v[60:63], v[116:119], v[140:143], v[60:63]
    v_add_f32 v208, v208, v6
    v_mfma_f32_16x16x32_bf16 v[36:39], v[120:123], v[136:139], v[36:39]
    s_waitcnt vmcnt(20)
    v_add_f32 v209, v209, v7
    v_mfma_f32_16x16x32_bf16 v[64:67], v[120:123], v[140:143], v[64:67]
    v_swap_b32 v146, v148
    v_add_f32 v210, v210, v8
    v_mfma_f32_16x16x32_bf16 v[40:43], v[124:127], v[136:139], v[40:43]
    v_swap_b32 v147, v149
    v_add_f32 v211, v211, v9
    v_mfma_f32_16x16x32_bf16 v[68:71], v[124:127], v[140:143], v[68:71]
    s_waitcnt lgkmcnt(0)
    v_mfma_f32_16x16x32_bf16 v[16:19], v[72:75], v[144:147], v[16:19]
    ds_read_b128 v[100:103], v5 offset:0
    v_mul_f32 v224, 0x3acccccd, v208
    v_mfma_f32_16x16x32_bf16 v[44:47], v[72:75], v[148:151], v[44:47]
    ds_read_b128 v[104:107], v5 offset:7168
    v_mul_f32 v209, 0x3acccccd, v209
    v_mfma_f32_16x16x32_bf16 v[20:23], v[76:79], v[144:147], v[20:23]
    ds_read_b128 v[108:111], v5 offset:14336
    v_mul_f32 v226, 0x3acccccd, v210
    v_mfma_f32_16x16x32_bf16 v[48:51], v[76:79], v[148:151], v[48:51]
    ds_read_b128 v[112:115], v5 offset:21504
    v_mul_f32 v211, 0x3acccccd, v211
    v_mfma_f32_16x16x32_bf16 v[24:27], v[80:83], v[144:147], v[24:27]
    ds_read_b128 v[116:119], v5 offset:28672
    v_fma_f32 v209, -v224, v224, v209
    v_mfma_f32_16x16x32_bf16 v[52:55], v[80:83], v[148:151], v[52:55]
    ds_read_b128 v[120:123], v5 offset:35840
    v_fma_f32 v211, -v226, v226, v211
    v_mfma_f32_16x16x32_bf16 v[28:31], v[84:87], v[144:147], v[28:31]
    ds_read_b128 v[124:127], v5 offset:43008
    v_mfma_f32_16x16x32_bf16 v[56:59], v[84:87], v[148:151], v[56:59]
    buffer_load_dwordx4 v[136:139], v10, s[8:11], s64 offen offset:128 sc1
    v_max_f32 v209, 0, v209
    v_mfma_f32_16x16x32_bf16 v[32:35], v[88:91], v[144:147], v[32:35]
    buffer_load_dwordx4 v[140:143], v10, s[8:11], s64 offen offset:192 sc1
    v_add_f32 v209, 0x3727c5ac, v209
    v_mfma_f32_16x16x32_bf16 v[60:63], v[88:91], v[148:151], v[60:63]
    v_max_f32 v211, 0, v211
    v_mfma_f32_16x16x32_bf16 v[36:39], v[92:95], v[144:147], v[36:39]
    v_add_f32 v211, 0x3727c5ac, v211
    s_waitcnt vmcnt(10)
    v_swap_b32 v154, v156
    v_swap_b32 v155, v157
    v_mfma_f32_16x16x32_bf16 v[64:67], v[92:95], v[148:151], v[64:67]
    v_rsq_f32 v225, v209
    v_swap_b32 v162, v164
    v_swap_b32 v163, v165
    v_mfma_f32_16x16x32_bf16 v[40:43], v[96:99], v[144:147], v[40:43]
    v_rsq_f32 v227, v211
    v_swap_b32 v170, v172
    v_swap_b32 v171, v173
    v_mfma_f32_16x16x32_bf16 v[68:71], v[96:99], v[148:151], v[68:71]
    v_swap_b32 v178, v180
    v_swap_b32 v179, v181
    s_waitcnt lgkmcnt(0)
    v_mfma_f32_16x16x32_bf16 v[16:19], v[100:103], v[152:155], v[16:19]
    ds_read_b128 v[72:75], v5 offset:1024
    v_mfma_f32_16x16x32_bf16 v[44:47], v[100:103], v[156:159], v[44:47]
    ds_read_b128 v[76:79], v5 offset:8192
    ds_read_b128 v[100:103], v5 offset:2048
    v_mfma_f32_16x16x32_bf16 v[16:19], v[104:107], v[160:163], v[16:19]
    ds_read_b128 v[80:83], v5 offset:15360
    v_mfma_f32_16x16x32_bf16 v[44:47], v[104:107], v[164:167], v[44:47]
    s_waitcnt vmcnt(4)
    v_swap_b32 v186, v188
    v_swap_b32 v187, v189
    ds_read_b128 v[84:87], v5 offset:22528
    ds_read_b128 v[104:107], v5 offset:9216
    v_mfma_f32_16x16x32_bf16 v[16:19], v[108:111], v[168:171], v[16:19]
    v_swap_b32 v194, v196
    v_swap_b32 v195, v197
    ds_read_b128 v[88:91], v5 offset:29696
    v_mfma_f32_16x16x32_bf16 v[44:47], v[108:111], v[172:175], v[44:47]
    v_swap_b32 v202, v204
    v_swap_b32 v203, v205
    ds_read_b128 v[92:95], v5 offset:36864
    ds_read_b128 v[108:111], v5 offset:16384
    v_mfma_f32_16x16x32_bf16 v[16:19], v[112:115], v[176:179], v[16:19]
    ds_read_b128 v[96:99], v5 offset:44032
    v_mfma_f32_16x16x32_bf16 v[44:47], v[112:115], v[180:183], v[44:47]
    buffer_load_dwordx4 v[144:147], v10, s[8:11], s64 offen offset:256 sc1
    ds_read_b128 v[112:115], v5 offset:23552
    v_mfma_f32_16x16x32_bf16 v[16:19], v[116:119], v[184:187], v[16:19]
    buffer_load_dwordx4 v[148:151], v10, s[8:11], s64 offen offset:320 sc1
    v_mfma_f32_16x16x32_bf16 v[44:47], v[116:119], v[188:191], v[44:47]
    buffer_load_dwordx4 v[208:211], v10, s[8:11], s64 offen offset:384 sc1
    ds_read_b128 v[116:119], v5 offset:30720
    v_mfma_f32_16x16x32_bf16 v[16:19], v[120:123], v[192:195], v[16:19]
    v_mfma_f32_16x16x32_bf16 v[44:47], v[120:123], v[196:199], v[44:47]
    ds_read_b128 v[120:123], v5 offset:37888
    v_mfma_f32_16x16x32_bf16 v[16:19], v[124:127], v[200:203], v[16:19]
    v_mfma_f32_16x16x32_bf16 v[44:47], v[124:127], v[204:207], v[44:47]
    ds_read_b128 v[124:127], v5 offset:45056
    s_waitcnt lgkmcnt(4)
    v_mfma_f32_16x16x32_bf16 v[20:23], v[72:75], v[152:155], v[20:23]
    v_mfma_f32_16x16x32_bf16 v[48:51], v[72:75], v[156:159], v[48:51]
    ds_read_b128 v[72:75], v5 offset:3072
    v_mfma_f32_16x16x32_bf16 v[20:23], v[76:79], v[160:163], v[20:23]
    s_waitcnt vmcnt(6)
    v_mfma_f32_16x16x32_bf16 v[48:51], v[76:79], v[164:167], v[48:51]
    ds_read_b128 v[76:79], v5 offset:10240
    v_fma_f32 v16, -v224, v128, v16
    v_fma_f32 v17, -v224, v129, v17
    v_fma_f32 v18, -v224, v130, v18
    v_mfma_f32_16x16x32_bf16 v[20:23], v[80:83], v[168:171], v[20:23]
    v_fma_f32 v19, -v224, v131, v19
    v_mul_f32 v16, v225, v16
    v_mfma_f32_16x16x32_bf16 v[48:51], v[80:83], v[172:175], v[48:51]
    ds_read_b128 v[80:83], v5 offset:17408
    v_mul_f32 v17, v225, v17
    v_mul_f32 v18, v225, v18
    v_mfma_f32_16x16x32_bf16 v[20:23], v[84:87], v[176:179], v[20:23]
    v_mul_f32 v19, v225, v19
    v_cvt_pk_bf16_f32 v228, v16, v17
    v_cvt_pk_bf16_f32 v229, v18, v19
    v_mfma_f32_16x16x32_bf16 v[48:51], v[84:87], v[180:183], v[48:51]
    ds_read_b128 v[84:87], v5 offset:24576
    v_pk_max_i16 v228, v228, 0
    v_pk_max_i16 v229, v229, 0
    v_mfma_f32_16x16x32_bf16 v[20:23], v[88:91], v[184:187], v[20:23]
    v_fma_f32 v44, -v226, v128, v44
    v_fma_f32 v45, -v226, v129, v45
    v_mfma_f32_16x16x32_bf16 v[48:51], v[88:91], v[188:191], v[48:51]
    ds_read_b128 v[88:91], v5 offset:31744
    v_fma_f32 v46, -v226, v130, v46
    v_fma_f32 v47, -v226, v131, v47
    v_mfma_f32_16x16x32_bf16 v[20:23], v[92:95], v[192:195], v[20:23]
    v_mul_f32 v44, v227, v44
    v_mul_f32 v45, v227, v45
    v_mul_f32 v46, v227, v46
    v_mfma_f32_16x16x32_bf16 v[48:51], v[92:95], v[196:199], v[48:51]
    ds_read_b128 v[92:95], v5 offset:38912
    v_mul_f32 v47, v227, v47
    v_cvt_pk_bf16_f32 v230, v44, v45
    v_mfma_f32_16x16x32_bf16 v[20:23], v[96:99], v[200:203], v[20:23]
    v_cvt_pk_bf16_f32 v231, v46, v47
    v_pk_max_i16 v230, v230, 0
    v_mfma_f32_16x16x32_bf16 v[48:51], v[96:99], v[204:207], v[48:51]
    ds_read_b128 v[96:99], v5 offset:46080
    v_pk_max_i16 v231, v231, 0
    buffer_store_dwordx4 v[228:231], v2, s[8:11], s62 offen offset:0 sc1
    s_waitcnt lgkmcnt(7)
    v_mfma_f32_16x16x32_bf16 v[24:27], v[100:103], v[152:155], v[24:27]
    v_mfma_f32_16x16x32_bf16 v[52:55], v[100:103], v[156:159], v[52:55]
    ds_read_b128 v[100:103], v5 offset:4096
    v_mfma_f32_16x16x32_bf16 v[24:27], v[104:107], v[160:163], v[24:27]
    s_waitcnt vmcnt(6)
    v_mfma_f32_16x16x32_bf16 v[52:55], v[104:107], v[164:167], v[52:55]
    ds_read_b128 v[104:107], v5 offset:11264
    v_fma_f32 v20, -v224, v132, v20
    v_fma_f32 v21, -v224, v133, v21
    v_fma_f32 v22, -v224, v134, v22
    v_mfma_f32_16x16x32_bf16 v[24:27], v[108:111], v[168:171], v[24:27]
    v_fma_f32 v23, -v224, v135, v23
    v_mul_f32 v20, v225, v20
    v_mfma_f32_16x16x32_bf16 v[52:55], v[108:111], v[172:175], v[52:55]
    ds_read_b128 v[108:111], v5 offset:18432
    v_mul_f32 v21, v225, v21
    v_mul_f32 v22, v225, v22
    v_mfma_f32_16x16x32_bf16 v[24:27], v[112:115], v[176:179], v[24:27]
    v_mul_f32 v23, v225, v23
    v_cvt_pk_bf16_f32 v228, v20, v21
    v_cvt_pk_bf16_f32 v229, v22, v23
    v_mfma_f32_16x16x32_bf16 v[52:55], v[112:115], v[180:183], v[52:55]
    ds_read_b128 v[112:115], v5 offset:25600
    v_pk_max_i16 v228, v228, 0
    v_pk_max_i16 v229, v229, 0
    v_mfma_f32_16x16x32_bf16 v[24:27], v[116:119], v[184:187], v[24:27]
    v_fma_f32 v48, -v226, v132, v48
    v_fma_f32 v49, -v226, v133, v49
    v_mfma_f32_16x16x32_bf16 v[52:55], v[116:119], v[188:191], v[52:55]
    ds_read_b128 v[116:119], v5 offset:32768
    v_fma_f32 v50, -v226, v134, v50
    v_fma_f32 v51, -v226, v135, v51
    v_mfma_f32_16x16x32_bf16 v[24:27], v[120:123], v[192:195], v[24:27]
    v_mul_f32 v48, v227, v48
    v_mul_f32 v49, v227, v49
    v_mul_f32 v50, v227, v50
    v_mfma_f32_16x16x32_bf16 v[52:55], v[120:123], v[196:199], v[52:55]
    ds_read_b128 v[120:123], v5 offset:39936
    v_mul_f32 v51, v227, v51
    v_cvt_pk_bf16_f32 v230, v48, v49
    v_mfma_f32_16x16x32_bf16 v[24:27], v[124:127], v[200:203], v[24:27]
    v_cvt_pk_bf16_f32 v231, v50, v51
    v_pk_max_i16 v230, v230, 0
    v_mfma_f32_16x16x32_bf16 v[52:55], v[124:127], v[204:207], v[52:55]
    ds_read_b128 v[124:127], v5 offset:47104
    v_pk_max_i16 v231, v231, 0
    buffer_store_dwordx4 v[228:231], v2, s[8:11], s62 offen offset:1024 sc1
    s_waitcnt lgkmcnt(7)
    v_mfma_f32_16x16x32_bf16 v[28:31], v[72:75], v[152:155], v[28:31]
    v_mfma_f32_16x16x32_bf16 v[56:59], v[72:75], v[156:159], v[56:59]
    ds_read_b128 v[72:75], v5 offset:5120
    v_mfma_f32_16x16x32_bf16 v[28:31], v[76:79], v[160:163], v[28:31]
    s_waitcnt vmcnt(6)
    v_mfma_f32_16x16x32_bf16 v[56:59], v[76:79], v[164:167], v[56:59]
    ds_read_b128 v[76:79], v5 offset:12288
    v_fma_f32 v24, -v224, v136, v24
    v_fma_f32 v25, -v224, v137, v25
    v_fma_f32 v26, -v224, v138, v26
    v_mfma_f32_16x16x32_bf16 v[28:31], v[80:83], v[168:171], v[28:31]
    v_fma_f32 v27, -v224, v139, v27
    v_mul_f32 v24, v225, v24
    v_mfma_f32_16x16x32_bf16 v[56:59], v[80:83], v[172:175], v[56:59]
    ds_read_b128 v[80:83], v5 offset:19456
    v_mul_f32 v25, v225, v25
    v_mul_f32 v26, v225, v26
    v_mfma_f32_16x16x32_bf16 v[28:31], v[84:87], v[176:179], v[28:31]
    v_mul_f32 v27, v225, v27
    v_cvt_pk_bf16_f32 v228, v24, v25
    v_cvt_pk_bf16_f32 v229, v26, v27
    v_mfma_f32_16x16x32_bf16 v[56:59], v[84:87], v[180:183], v[56:59]
    ds_read_b128 v[84:87], v5 offset:26624
    v_pk_max_i16 v228, v228, 0
    v_pk_max_i16 v229, v229, 0
    v_mfma_f32_16x16x32_bf16 v[28:31], v[88:91], v[184:187], v[28:31]
    v_fma_f32 v52, -v226, v136, v52
    v_fma_f32 v53, -v226, v137, v53
    v_mfma_f32_16x16x32_bf16 v[56:59], v[88:91], v[188:191], v[56:59]
    ds_read_b128 v[88:91], v5 offset:33792
    v_fma_f32 v54, -v226, v138, v54
    v_fma_f32 v55, -v226, v139, v55
    v_mfma_f32_16x16x32_bf16 v[28:31], v[92:95], v[192:195], v[28:31]
    v_mul_f32 v52, v227, v52
    v_mul_f32 v53, v227, v53
    v_mul_f32 v54, v227, v54
    v_mfma_f32_16x16x32_bf16 v[56:59], v[92:95], v[196:199], v[56:59]
    ds_read_b128 v[92:95], v5 offset:40960
    v_mul_f32 v55, v227, v55
    v_cvt_pk_bf16_f32 v230, v52, v53
    v_mfma_f32_16x16x32_bf16 v[28:31], v[96:99], v[200:203], v[28:31]
    v_cvt_pk_bf16_f32 v231, v54, v55
    v_pk_max_i16 v230, v230, 0
    v_mfma_f32_16x16x32_bf16 v[56:59], v[96:99], v[204:207], v[56:59]
    ds_read_b128 v[96:99], v5 offset:48128
    v_pk_max_i16 v231, v231, 0
    buffer_store_dwordx4 v[228:231], v2, s[8:11], s62 offen offset:2048 sc1
    s_waitcnt lgkmcnt(7)
    v_mfma_f32_16x16x32_bf16 v[32:35], v[100:103], v[152:155], v[32:35]
    v_mfma_f32_16x16x32_bf16 v[60:63], v[100:103], v[156:159], v[60:63]
    ds_read_b128 v[100:103], v5 offset:6144
    v_mfma_f32_16x16x32_bf16 v[32:35], v[104:107], v[160:163], v[32:35]
    s_waitcnt vmcnt(6)
    v_mfma_f32_16x16x32_bf16 v[60:63], v[104:107], v[164:167], v[60:63]
    ds_read_b128 v[104:107], v5 offset:13312
    v_fma_f32 v28, -v224, v140, v28
    v_fma_f32 v29, -v224, v141, v29
    v_fma_f32 v30, -v224, v142, v30
    v_mfma_f32_16x16x32_bf16 v[32:35], v[108:111], v[168:171], v[32:35]
    v_fma_f32 v31, -v224, v143, v31
    v_mul_f32 v28, v225, v28
    v_mfma_f32_16x16x32_bf16 v[60:63], v[108:111], v[172:175], v[60:63]
    ds_read_b128 v[108:111], v5 offset:20480
    v_mul_f32 v29, v225, v29
    v_mul_f32 v30, v225, v30
    v_mfma_f32_16x16x32_bf16 v[32:35], v[112:115], v[176:179], v[32:35]
    v_mul_f32 v31, v225, v31
    v_cvt_pk_bf16_f32 v228, v28, v29
    v_cvt_pk_bf16_f32 v229, v30, v31
    v_mfma_f32_16x16x32_bf16 v[60:63], v[112:115], v[180:183], v[60:63]
    ds_read_b128 v[112:115], v5 offset:27648
    v_pk_max_i16 v228, v228, 0
    v_pk_max_i16 v229, v229, 0
    v_mfma_f32_16x16x32_bf16 v[32:35], v[116:119], v[184:187], v[32:35]
    v_fma_f32 v56, -v226, v140, v56
    v_fma_f32 v57, -v226, v141, v57
    v_mfma_f32_16x16x32_bf16 v[60:63], v[116:119], v[188:191], v[60:63]
    ds_read_b128 v[116:119], v5 offset:34816
    v_fma_f32 v58, -v226, v142, v58
    v_fma_f32 v59, -v226, v143, v59
    v_mfma_f32_16x16x32_bf16 v[32:35], v[120:123], v[192:195], v[32:35]
    v_mul_f32 v56, v227, v56
    v_mul_f32 v57, v227, v57
    v_mul_f32 v58, v227, v58
    v_mfma_f32_16x16x32_bf16 v[60:63], v[120:123], v[196:199], v[60:63]
    ds_read_b128 v[120:123], v5 offset:41984
    v_mul_f32 v59, v227, v59
    v_cvt_pk_bf16_f32 v230, v56, v57
    v_mfma_f32_16x16x32_bf16 v[32:35], v[124:127], v[200:203], v[32:35]
    v_cvt_pk_bf16_f32 v231, v58, v59
    v_pk_max_i16 v230, v230, 0
    v_mfma_f32_16x16x32_bf16 v[60:63], v[124:127], v[204:207], v[60:63]
    ds_read_b128 v[124:127], v5 offset:49152
    v_pk_max_i16 v231, v231, 0
    buffer_store_dwordx4 v[228:231], v2, s[8:11], s63 offen offset:0 sc1
    s_waitcnt lgkmcnt(7)
    v_mfma_f32_16x16x32_bf16 v[36:39], v[72:75], v[152:155], v[36:39]
    v_mfma_f32_16x16x32_bf16 v[64:67], v[72:75], v[156:159], v[64:67]
    v_mfma_f32_16x16x32_bf16 v[36:39], v[76:79], v[160:163], v[36:39]
    s_waitcnt vmcnt(6)
    v_mfma_f32_16x16x32_bf16 v[64:67], v[76:79], v[164:167], v[64:67]
    v_fma_f32 v32, -v224, v144, v32
    v_fma_f32 v33, -v224, v145, v33
    v_fma_f32 v34, -v224, v146, v34
    v_mfma_f32_16x16x32_bf16 v[36:39], v[80:83], v[168:171], v[36:39]
    v_fma_f32 v35, -v224, v147, v35
    v_mul_f32 v32, v225, v32
    v_mfma_f32_16x16x32_bf16 v[64:67], v[80:83], v[172:175], v[64:67]
    v_mul_f32 v33, v225, v33
    v_mul_f32 v34, v225, v34
    v_mfma_f32_16x16x32_bf16 v[36:39], v[84:87], v[176:179], v[36:39]
    v_mul_f32 v35, v225, v35
    v_cvt_pk_bf16_f32 v228, v32, v33
    v_cvt_pk_bf16_f32 v229, v34, v35
    v_mfma_f32_16x16x32_bf16 v[64:67], v[84:87], v[180:183], v[64:67]
    v_pk_max_i16 v228, v228, 0
    v_pk_max_i16 v229, v229, 0
    v_mfma_f32_16x16x32_bf16 v[36:39], v[88:91], v[184:187], v[36:39]
    v_fma_f32 v60, -v226, v144, v60
    v_fma_f32 v61, -v226, v145, v61
    v_mfma_f32_16x16x32_bf16 v[64:67], v[88:91], v[188:191], v[64:67]
    v_fma_f32 v62, -v226, v146, v62
    v_fma_f32 v63, -v226, v147, v63
    v_mfma_f32_16x16x32_bf16 v[36:39], v[92:95], v[192:195], v[36:39]
    v_mul_f32 v60, v227, v60
    v_mul_f32 v61, v227, v61
    v_mul_f32 v62, v227, v62
    v_mfma_f32_16x16x32_bf16 v[64:67], v[92:95], v[196:199], v[64:67]
    v_mul_f32 v63, v227, v63
    v_cvt_pk_bf16_f32 v230, v60, v61
    v_mfma_f32_16x16x32_bf16 v[36:39], v[96:99], v[200:203], v[36:39]
    v_cvt_pk_bf16_f32 v231, v62, v63
    v_pk_max_i16 v230, v230, 0
    v_mfma_f32_16x16x32_bf16 v[64:67], v[96:99], v[204:207], v[64:67]
    v_pk_max_i16 v231, v231, 0
    buffer_store_dwordx4 v[228:231], v2, s[8:11], s63 offen offset:1024 sc1
    s_waitcnt lgkmcnt(0)
    v_mfma_f32_16x16x32_bf16 v[40:43], v[100:103], v[152:155], v[40:43]
    v_mfma_f32_16x16x32_bf16 v[68:71], v[100:103], v[156:159], v[68:71]
    v_mfma_f32_16x16x32_bf16 v[40:43], v[104:107], v[160:163], v[40:43]
    s_waitcnt vmcnt(6)
    v_mfma_f32_16x16x32_bf16 v[68:71], v[104:107], v[164:167], v[68:71]
    v_fma_f32 v36, -v224, v148, v36
    v_fma_f32 v37, -v224, v149, v37
    v_fma_f32 v38, -v224, v150, v38
    v_mfma_f32_16x16x32_bf16 v[40:43], v[108:111], v[168:171], v[40:43]
    v_fma_f32 v39, -v224, v151, v39
    v_mul_f32 v36, v225, v36
    v_mfma_f32_16x16x32_bf16 v[68:71], v[108:111], v[172:175], v[68:71]
    v_mul_f32 v37, v225, v37
    v_mul_f32 v38, v225, v38
    v_mfma_f32_16x16x32_bf16 v[40:43], v[112:115], v[176:179], v[40:43]
    v_mul_f32 v39, v225, v39
    v_cvt_pk_bf16_f32 v228, v36, v37
    v_cvt_pk_bf16_f32 v229, v38, v39
    v_mfma_f32_16x16x32_bf16 v[68:71], v[112:115], v[180:183], v[68:71]
    v_pk_max_i16 v228, v228, 0
    v_pk_max_i16 v229, v229, 0
    v_mfma_f32_16x16x32_bf16 v[40:43], v[116:119], v[184:187], v[40:43]
    v_fma_f32 v64, -v226, v148, v64
    v_fma_f32 v65, -v226, v149, v65
    v_mfma_f32_16x16x32_bf16 v[68:71], v[116:119], v[188:191], v[68:71]
    v_fma_f32 v66, -v226, v150, v66
    v_fma_f32 v67, -v226, v151, v67
    v_mfma_f32_16x16x32_bf16 v[40:43], v[120:123], v[192:195], v[40:43]
    v_mul_f32 v64, v227, v64
    v_mul_f32 v65, v227, v65
    v_mul_f32 v66, v227, v66
    v_mfma_f32_16x16x32_bf16 v[68:71], v[120:123], v[196:199], v[68:71]
    v_mul_f32 v67, v227, v67
    v_cvt_pk_bf16_f32 v230, v64, v65
    v_mfma_f32_16x16x32_bf16 v[40:43], v[124:127], v[200:203], v[40:43]
    v_cvt_pk_bf16_f32 v231, v66, v67
    v_pk_max_i16 v230, v230, 0
    v_mfma_f32_16x16x32_bf16 v[68:71], v[124:127], v[204:207], v[68:71]
    v_pk_max_i16 v231, v231, 0
    buffer_store_dwordx4 v[228:231], v2, s[8:11], s63 offen offset:2048 sc1
    s_waitcnt vmcnt(6)
    s_nop 6
    v_fma_f32 v40, -v224, v208, v40
    v_fma_f32 v41, -v224, v209, v41
    v_fma_f32 v42, -v224, v210, v42
    v_fma_f32 v43, -v224, v211, v43
    v_mul_f32 v40, v225, v40
    v_mul_f32 v41, v225, v41
    v_mul_f32 v42, v225, v42
    v_mul_f32 v43, v225, v43
    v_cvt_pk_bf16_f32 v228, v40, v41
    v_cvt_pk_bf16_f32 v229, v42, v43
    v_pk_max_i16 v228, v228, 0
    v_pk_max_i16 v229, v229, 0
    v_fma_f32 v68, -v226, v208, v68
    v_fma_f32 v69, -v226, v209, v69
    v_fma_f32 v70, -v226, v210, v70
    v_fma_f32 v71, -v226, v211, v71
    v_mul_f32 v68, v227, v68
    v_mul_f32 v69, v227, v69
    v_mul_f32 v70, v227, v70
    v_mul_f32 v71, v227, v71
    v_cvt_pk_bf16_f32 v230, v68, v69
    v_cvt_pk_bf16_f32 v231, v70, v71
    v_pk_max_i16 v230, v230, 0
    v_pk_max_i16 v231, v231, 0
    buffer_store_dwordx4 v[228:231], v2, s[8:11], s63 offen offset:3072 sc1
    s_lshl_b32 s64, s76, 7
    s_add_u32 s64, s64, 2048
    s_waitcnt vmcnt(0)
    s_barrier
    s_cmp_lg_u32 s60, 0
    s_cbranch_scc1 L_arr_72
    s_mov_b64 s[98:99], exec
    s_mov_b64 exec, 1
    v_mov_b32 v4, s64
    v_mov_b32 v5, 1
    buffer_atomic_add v5, v4, s[8:11], 0 offen
    s_mov_b64 exec, s[98:99]
L_arr_72:
    s_mul_i32 s62, s60, 14
    s_cmp_ge_u32 s60, 3
    s_cselect_b32 s63, 1, 0
    s_sub_u32 s62, s62, s63
    s_lshl_b32 s62, s62, 11
    s_add_u32 s62, s62, s81
    s_mul_i32 s63, s84, 110592
    s_add_u32 s90, s62, s63
    s_xor_b32 s63, s84, 1
    s_mul_i32 s63, s63, 110592
    s_add_u32 s91, s62, s63
    s_cmp_lg_u32 s60, 0
    s_cbranch_scc1 L_wc_73
    v_mov_b32 v4, s64
    s_sleep 8
    buffer_load_dword v5, v4, s[8:11], 0 offen sc1
    s_waitcnt vmcnt(0)
L_pe_74:
    v_cmp_gt_u32 vcc, 32, v5
    s_nop 1
    s_cbranch_vccz L_pok_75
    s_cmp_eq_u32 s97, 0
    s_cbranch_scc1 L_pok_75
    s_sub_u32 s97, s97, 1
    s_sleep 2
    buffer_load_dword v5, v4, s[8:11], 0 offen sc1
    s_waitcnt vmcnt(0)
    s_branch L_pe_74
L_pok_75:
L_wc_73:
    s_barrier
    buffer_load_dwordx4 v[96:99], v2, s[8:11], s90 offen sc1
    buffer_load_dwordx4 v[100:103], v2, s[8:11], s90 offen offset:1024 sc1
    buffer_load_dwordx4 v[104:107], v2, s[8:11], s91 offen sc1
    buffer_load_dwordx4 v[108:111], v2, s[8:11], s91 offen offset:1024 sc1
    s_add_u32 s90, s90, 2048
    s_add_u32 s91, s91, 2048
    buffer_load_dwordx4 v[112:115], v2, s[8:11], s90 offen sc1
    buffer_load_dwordx4 v[116:119], v2, s[8:11], s90 offen offset:1024 sc1
    buffer_load_dwordx4 v[120:123], v2, s[8:11], s91 offen sc1
    buffer_load_dwordx4 v[124:127], v2, s[8:11], s91 offen offset:1024 sc1
    s_add_u32 s90, s90, 2048
    s_add_u32 s91, s91, 2048
    buffer_load_dwordx4 v[128:131], v2, s[8:11], s90 offen sc1
    buffer_load_dwordx4 v[132:135], v2, s[8:11], s90 offen offset:1024 sc1
    buffer_load_dwordx4 v[136:139], v2, s[8:11], s91 offen sc1
    buffer_load_dwordx4 v[140:143], v2, s[8:11], s91 offen offset:1024 sc1
    s_add_u32 s90, s90, 2048
    s_add_u32 s91, s91, 2048
    buffer_load_dwordx4 v[144:147], v2, s[8:11], s90 offen sc1
    buffer_load_dwordx4 v[148:151], v2, s[8:11], s90 offen offset:1024 sc1
    buffer_load_dwordx4 v[152:155], v2, s[8:11], s91 offen sc1
    buffer_load_dwordx4 v[156:159], v2, s[8:11], s91 offen offset:1024 sc1
    s_add_u32 s90, s90, 2048
    s_add_u32 s91, s91, 2048
    s_add_u32 s64, s92, s80
    s_add_u32 s65, s92, 2654208
    buffer_load_dwordx4 v[208:211], v2, s[8:11], s64 offen offset:0 sc1
    buffer_load_dwordx4 v[212:215], v2, s[8:11], s64 offen offset:1024 sc1
    buffer_load_dwordx4 v[216:219], v2, s[8:11], s64 offen offset:2048 sc1
    s_mov_b32 s12, s54
    s_mov_b32 s13, s55
    s_mov_b32 s14, 2621440
    s_mov_b32 s15, 0x20000
    v_and_b32 v204, 15, v1
    v_mul_u32_u24 v204, 2560, v204
    v_lshrrev_b32 v205, 4, v1
    v_lshl_add_u32 v204, v205, 3, v204
    s_mul_i32 s62, s84, 40960
    s_mul_i32 s63, s79, 160
    s_add_u32 s62, s62, s63
    s_mul_i32 s63, s85, 96
    s_add_u32 s93, s62, s63
    s_waitcnt vmcnt(15)
    v_swap_b32 v98, v100
    v_swap_b32 v99, v101
    v_swap_b32 v106, v108
    v_swap_b32 v107, v109
    s_nop 0
    v_mfma_f32_16x16x32_bf16 v[16:19], a[0:3], v[96:99], 0
    v_mfma_f32_16x16x32_bf16 v[20:23], a[0:3], v[100:103], 0
    v_mfma_f32_16x16x32_bf16 v[56:59], a[0:3], v[104:107], 0
    v_mfma_f32_16x16x32_bf16 v[60:63], a[0:3], v[108:111], 0
    v_mfma_f32_16x16x32_bf16 v[24:27], a[4:7], v[96:99], 0
    v_mfma_f32_16x16x32_bf16 v[28:31], a[4:7], v[100:103], 0
    v_mfma_f32_16x16x32_bf16 v[64:67], a[4:7], v[104:107], 0
    v_mfma_f32_16x16x32_bf16 v[68:71], a[4:7], v[108:111], 0
    v_mfma_f32_16x16x32_bf16 v[32:35], a[8:11], v[96:99], 0
    v_mfma_f32_16x16x32_bf16 v[36:39], a[8:11], v[100:103], 0
    v_mfma_f32_16x16x32_bf16 v[72:75], a[8:11], v[104:107], 0
    v_mfma_f32_16x16x32_bf16 v[76:79], a[8:11], v[108:111], 0
    v_mfma_f32_16x16x32_bf16 v[40:43], a[12:15], v[96:99], 0
    v_mfma_f32_16x16x32_bf16 v[44:47], a[12:15], v[100:103], 0
    s_waitcnt vmcnt(11)
    v_mfma_f32_16x16x32_bf16 v[80:83], a[12:15], v[104:107], 0
    v_swap_b32 v114, v116
    v_mfma_f32_16x16x32_bf16 v[84:87], a[12:15], v[108:111], 0
    v_swap_b32 v115, v117
    v_mfma_f32_16x16x32_bf16 v[48:51], a[16:19], v[96:99], 0
    v_swap_b32 v122, v124
    v_mfma_f32_16x16x32_bf16 v[52:55], a[16:19], v[100:103], 0
    v_swap_b32 v123, v125
    v_mfma_f32_16x16x32_bf16 v[88:91], a[16:19], v[104:107], 0
    v_mfma_f32_16x16x32_bf16 v[92:95], a[16:19], v[108:111], 0
    v_mfma_f32_16x16x32_bf16 v[16:19], a[20:23], v[112:115], v[16:19]
    buffer_load_dwordx4 v[96:99], v2, s[8:11], s90 offen sc1
    v_mfma_f32_16x16x32_bf16 v[20:23], a[20:23], v[116:119], v[20:23]
    buffer_load_dwordx4 v[100:103], v2, s[8:11], s90 offen offset:1024 sc1
    s_add_u32 s90, s90, 2048
    v_mfma_f32_16x16x32_bf16 v[56:59], a[20:23], v[120:123], v[56:59]
    buffer_load_dwordx4 v[104:107], v2, s[8:11], s91 offen sc1
    v_mfma_f32_16x16x32_bf16 v[60:63], a[20:23], v[124:127], v[60:63]
    buffer_load_dwordx4 v[108:111], v2, s[8:11], s91 offen offset:1024 sc1
    s_add_u32 s91, s91, 2048
    v_mfma_f32_16x16x32_bf16 v[24:27], a[24:27], v[112:115], v[24:27]
    v_mfma_f32_16x16x32_bf16 v[28:31], a[24:27], v[116:119], v[28:31]
    v_mfma_f32_16x16x32_bf16 v[64:67], a[24:27], v[120:123], v[64:67]
    v_mfma_f32_16x16x32_bf16 v[68:71], a[24:27], v[124:127], v[68:71]
    v_mfma_f32_16x16x32_bf16 v[32:35], a[28:31], v[112:115], v[32:35]
    v_mfma_f32_16x16x32_bf16 v[36:39], a[28:31], v[116:119], v[36:39]
    v_mfma_f32_16x16x32_bf16 v[72:75], a[28:31], v[120:123], v[72:75]
    v_mfma_f32_16x16x32_bf16 v[76:79], a[28:31], v[124:127], v[76:79]
    v_mfma_f32_16x16x32_bf16 v[40:43], a[32:35], v[112:115], v[40:43]
    v_mfma_f32_16x16x32_bf16 v[44:47], a[32:35], v[116:119], v[44:47]
    s_waitcnt vmcnt(11)
    v_mfma_f32_16x16x32_bf16 v[80:83], a[32:35], v[120:123], v[80:83]
    v_swap_b32 v130, v132
    v_mfma_f32_16x16x32_bf16 v[84:87], a[32:35], v[124:127], v[84:87]
    v_swap_b32 v131, v133
    v_mfma_f32_16x16x32_bf16 v[48:51], a[36:39], v[112:115], v[48:51]
    v_swap_b32 v138, v140
    v_mfma_f32_16x16x32_bf16 v[52:55], a[36:39], v[116:119], v[52:55]
    v_swap_b32 v139, v141
    v_mfma_f32_16x16x32_bf16 v[88:91], a[36:39], v[120:123], v[88:91]
    v_mfma_f32_16x16x32_bf16 v[92:95], a[36:39], v[124:127], v[92:95]
    v_mfma_f32_16x16x32_bf16 v[16:19], a[40:43], v[128:131], v[16:19]
    buffer_load_dwordx4 v[112:115], v2, s[8:11], s90 offen sc1
    v_mfma_f32_16x16x32_bf16 v[20:23], a[40:43], v[132:135], v[20:23]
    buffer_load_dwordx4 v[116:119], v2, s[8:11], s90 offen offset:1024 sc1
    s_add_u32 s90, s90, 2048
    v_mfma_f32_16x16x32_bf16 v[56:59], a[40:43], v[136:139], v[56:59]
    buffer_load_dwordx4 v[120:123], v2, s[8:11], s91 offen sc1
    v_mfma_f32_16x16x32_bf16 v[60:63], a[40:43], v[140:143], v[60:63]
    buffer_load_dwordx4 v[124:127], v2, s[8:11], s91 offen offset:1024 sc1
    s_add_u32 s91, s91, 2048
    v_mfma_f32_16x16x32_bf16 v[24:27], a[44:47], v[128:131], v[24:27]
    v_mfma_f32_16x16x32_bf16 v[28:31], a[44:47], v[132:135], v[28:31]
    v_mfma_f32_16x16x32_bf16 v[64:67], a[44:47], v[136:139], v[64:67]
    v_mfma_f32_16x16x32_bf16 v[68:71], a[44:47], v[140:143], v[68:71]
    v_mfma_f32_16x16x32_bf16 v[32:35], a[48:51], v[128:131], v[32:35]
    v_mfma_f32_16x16x32_bf16 v[36:39], a[48:51], v[132:135], v[36:39]
    v_mfma_f32_16x16x32_bf16 v[72:75], a[48:51], v[136:139], v[72:75]
    v_mfma_f32_16x16x32_bf16 v[76:79], a[48:51], v[140:143], v[76:79]
    v_mfma_f32_16x16x32_bf16 v[40:43], a[52:55], v[128:131], v[40:43]
    v_mfma_f32_16x16x32_bf16 v[44:47], a[52:55], v[132:135], v[44:47]
    s_waitcnt vmcnt(11)
    v_mfma_f32_16x16x32_bf16 v[80:83], a[52:55], v[136:139], v[80:83]
    v_swap_b32 v146, v148
    v_mfma_f32_16x16x32_bf16 v[84:87], a[52:55], v[140:143], v[84:87]
    v_swap_b32 v147, v149
    v_mfma_f32_16x16x32_bf16 v[48:51], a[56:59], v[128:131], v[48:51]
    v_swap_b32 v154, v156
    v_mfma_f32_16x16x32_bf16 v[52:55], a[56:59], v[132:135], v[52:55]
    v_swap_b32 v155, v157
    v_mfma_f32_16x16x32_bf16 v[88:91], a[56:59], v[136:139], v[88:91]
    v_mfma_f32_16x16x32_bf16 v[92:95], a[56:59], v[140:143], v[92:95]
    v_mfma_f32_16x16x32_bf16 v[16:19], a[60:63], v[144:147], v[16:19]
    buffer_load_dwordx4 v[128:131], v2, s[8:11], s90 offen sc1
    v_mfma_f32_16x16x32_bf16 v[20:23], a[60:63], v[148:151], v[20:23]
    buffer_load_dwordx4 v[132:135], v2, s[8:11], s90 offen offset:1024 sc1
    s_add_u32 s90, s90, 2048
    v_mfma_f32_16x16x32_bf16 v[56:59], a[60:63], v[152:155], v[56:59]
    buffer_load_dwordx4 v[136:139], v2, s[8:11], s91 offen sc1
    v_mfma_f32_16x16x32_bf16 v[60:63], a[60:63], v[156:159], v[60:63]
    buffer_load_dwordx4 v[140:143], v2, s[8:11], s91 offen offset:1024 sc1
    s_add_u32 s91, s91, 2048
    v_mfma_f32_16x16x32_bf16 v[24:27], a[64:67], v[144:147], v[24:27]
    v_mfma_f32_16x16x32_bf16 v[28:31], a[64:67], v[148:151], v[28:31]
    v_mfma_f32_16x16x32_bf16 v[64:67], a[64:67], v[152:155], v[64:67]
    v_mfma_f32_16x16x32_bf16 v[68:71], a[64:67], v[156:159], v[68:71]
    v_mfma_f32_16x16x32_bf16 v[32:35], a[68:71], v[144:147], v[32:35]
    v_mfma_f32_16x16x32_bf16 v[36:39], a[68:71], v[148:151], v[36:39]
    v_mfma_f32_16x16x32_bf16 v[72:75], a[68:71], v[152:155], v[72:75]
    v_mfma_f32_16x16x32_bf16 v[76:79], a[68:71], v[156:159], v[76:79]
    v_mfma_f32_16x16x32_bf16 v[40:43], a[72:75], v[144:147], v[40:43]
    v_mfma_f32_16x16x32_bf16 v[44:47], a[72:75], v[148:151], v[44:47]
    s_waitcnt vmcnt(8)
    v_mfma_f32_16x16x32_bf16 v[80:83], a[72:75], v[152:155], v[80:83]
    v_swap_b32 v98, v100
    v_mfma_f32_16x16x32_bf16 v[84:87], a[72:75], v[156:159], v[84:87]
    v_swap_b32 v99, v101
    v_mfma_f32_16x16x32_bf16 v[48:51], a[76:79], v[144:147], v[48:51]
    v_swap_b32 v106, v108
    v_mfma_f32_16x16x32_bf16 v[52:55], a[76:79], v[148:151], v[52:55]
    v_swap_b32 v107, v109
    v_mfma_f32_16x16x32_bf16 v[88:91], a[76:79], v[152:155], v[88:91]
    v_mfma_f32_16x16x32_bf16 v[92:95], a[76:79], v[156:159], v[92:95]
    v_mfma_f32_16x16x32_bf16 v[16:19], a[80:83], v[96:99], v[16:19]
    buffer_load_dwordx4 v[144:147], v2, s[8:11], s90 offen sc1
    v_mfma_f32_16x16x32_bf16 v[20:23], a[80:83], v[100:103], v[20:23]
    buffer_load_dwordx4 v[148:151], v2, s[8:11], s90 offen offset:1024 sc1
    s_add_u32 s90, s90, 2048
    v_mfma_f32_16x16x32_bf16 v[56:59], a[80:83], v[104:107], v[56:59]
    buffer_load_dwordx4 v[152:155], v2, s[8:11], s91 offen sc1
    v_mfma_f32_16x16x32_bf16 v[60:63], a[80:83], v[108:111], v[60:63]
    buffer_load_dwordx4 v[156:159], v2, s[8:11], s91 offen offset:1024 sc1
    s_add_u32 s91, s91, 2048
    v_mfma_f32_16x16x32_bf16 v[24:27], a[84:87], v[96:99], v[24:27]
    v_mfma_f32_16x16x32_bf16 v[28:31], a[84:87], v[100:103], v[28:31]
    v_mfma_f32_16x16x32_bf16 v[64:67], a[84:87], v[104:107], v[64:67]
    v_mfma_f32_16x16x32_bf16 v[68:71], a[84:87], v[108:111], v[68:71]
    v_mfma_f32_16x16x32_bf16 v[32:35], a[88:91], v[96:99], v[32:35]
    v_mfma_f32_16x16x32_bf16 v[36:39], a[88:91], v[100:103], v[36:39]
    v_mfma_f32_16x16x32_bf16 v[72:75], a[88:91], v[104:107], v[72:75]
    v_mfma_f32_16x16x32_bf16 v[76:79], a[88:91], v[108:111], v[76:79]
    v_mfma_f32_16x16x32_bf16 v[40:43], a[92:95], v[96:99], v[40:43]
    v_mfma_f32_16x16x32_bf16 v[44:47], a[92:95], v[100:103], v[44:47]
    s_waitcnt vmcnt(8)
    v_mfma_f32_16x16x32_bf16 v[80:83], a[92:95], v[104:107], v[80:83]
    v_swap_b32 v114, v116
    v_mfma_f32_16x16x32_bf16 v[84:87], a[92:95], v[108:111], v[84:87]
    v_swap_b32 v115, v117
    v_mfma_f32_16x16x32_bf16 v[48:51], a[96:99], v[96:99], v[48:51]
    v_swap_b32 v122, v124
    v_mfma_f32_16x16x32_bf16 v[52:55], a[96:99], v[100:103], v[52:55]
    v_swap_b32 v123, v125
    v_mfma_f32_16x16x32_bf16 v[88:91], a[96:99], v[104:107], v[88:91]
    v_mfma_f32_16x16x32_bf16 v[92:95], a[96:99], v[108:111], v[92:95]
    v_mfma_f32_16x16x32_bf16 v[16:19], a[100:103], v[112:115], v[16:19]
    buffer_load_dwordx4 v[96:99], v2, s[8:11], s90 offen sc1
    v_mfma_f32_16x16x32_bf16 v[20:23], a[100:103], v[116:119], v[20:23]
    buffer_load_dwordx4 v[100:103], v2, s[8:11], s90 offen offset:1024 sc1
    s_add_u32 s90, s90, 2048
    v_mfma_f32_16x16x32_bf16 v[56:59], a[100:103], v[120:123], v[56:59]
    buffer_load_dwordx4 v[104:107], v2, s[8:11], s91 offen sc1
    v_mfma_f32_16x16x32_bf16 v[60:63], a[100:103], v[124:127], v[60:63]
    buffer_load_dwordx4 v[108:111], v2, s[8:11], s91 offen offset:1024 sc1
    s_add_u32 s91, s91, 2048
    v_mfma_f32_16x16x32_bf16 v[24:27], a[104:107], v[112:115], v[24:27]
    v_mfma_f32_16x16x32_bf16 v[28:31], a[104:107], v[116:119], v[28:31]
    v_mfma_f32_16x16x32_bf16 v[64:67], a[104:107], v[120:123], v[64:67]
    v_mfma_f32_16x16x32_bf16 v[68:71], a[104:107], v[124:127], v[68:71]
    v_mfma_f32_16x16x32_bf16 v[32:35], a[108:111], v[112:115], v[32:35]
    v_mfma_f32_16x16x32_bf16 v[36:39], a[108:111], v[116:119], v[36:39]
    v_mfma_f32_16x16x32_bf16 v[72:75], a[108:111], v[120:123], v[72:75]
    v_mfma_f32_16x16x32_bf16 v[76:79], a[108:111], v[124:127], v[76:79]
    v_mfma_f32_16x16x32_bf16 v[40:43], a[112:115], v[112:115], v[40:43]
    v_mfma_f32_16x16x32_bf16 v[44:47], a[112:115], v[116:119], v[44:47]
    s_waitcnt vmcnt(8)
    v_mfma_f32_16x16x32_bf16 v[80:83], a[112:115], v[120:123], v[80:83]
    v_swap_b32 v130, v132
    v_mfma_f32_16x16x32_bf16 v[84:87], a[112:115], v[124:127], v[84:87]
    v_swap_b32 v131, v133
    v_mfma_f32_16x16x32_bf16 v[48:51], a[116:119], v[112:115], v[48:51]
    v_swap_b32 v138, v140
    v_mfma_f32_16x16x32_bf16 v[52:55], a[116:119], v[116:119], v[52:55]
    v_swap_b32 v139, v141
    v_mfma_f32_16x16x32_bf16 v[88:91], a[116:119], v[120:123], v[88:91]
    v_mfma_f32_16x16x32_bf16 v[92:95], a[116:119], v[124:127], v[92:95]
    v_mfma_f32_16x16x32_bf16 v[16:19], a[120:123], v[128:131], v[16:19]
    buffer_load_dwordx4 v[112:115], v2, s[8:11], s90 offen sc1
    v_mfma_f32_16x16x32_bf16 v[20:23], a[120:123], v[132:135], v[20:23]
    buffer_load_dwordx4 v[116:119], v2, s[8:11], s90 offen offset:1024 sc1
    s_add_u32 s90, s90, 2048
    v_mfma_f32_16x16x32_bf16 v[56:59], a[120:123], v[136:139], v[56:59]
    buffer_load_dwordx4 v[120:123], v2, s[8:11], s91 offen sc1
    v_mfma_f32_16x16x32_bf16 v[60:63], a[120:123], v[140:143], v[60:63]
    buffer_load_dwordx4 v[124:127], v2, s[8:11], s91 offen offset:1024 sc1
    s_add_u32 s91, s91, 2048
    v_mfma_f32_16x16x32_bf16 v[24:27], a[124:127], v[128:131], v[24:27]
    v_mfma_f32_16x16x32_bf16 v[28:31], a[124:127], v[132:135], v[28:31]
    v_mfma_f32_16x16x32_bf16 v[64:67], a[124:127], v[136:139], v[64:67]
    v_mfma_f32_16x16x32_bf16 v[68:71], a[124:127], v[140:143], v[68:71]
    v_mfma_f32_16x16x32_bf16 v[32:35], a[128:131], v[128:131], v[32:35]
    v_mfma_f32_16x16x32_bf16 v[36:39], a[128:131], v[132:135], v[36:39]
    v_mfma_f32_16x16x32_bf16 v[72:75], a[128:131], v[136:139], v[72:75]
    v_mfma_f32_16x16x32_bf16 v[76:79], a[128:131], v[140:143], v[76:79]
    v_mfma_f32_16x16x32_bf16 v[40:43], a[132:135], v[128:131], v[40:43]
    v_mfma_f32_16x16x32_bf16 v[44:47], a[132:135], v[132:135], v[44:47]
    s_waitcnt vmcnt(8)
    v_mfma_f32_16x16x32_bf16 v[80:83], a[132:135], v[136:139], v[80:83]
    v_swap_b32 v146, v148
    v_mfma_f32_16x16x32_bf16 v[84:87], a[132:135], v[140:143], v[84:87]
    v_swap_b32 v147, v149
    v_mfma_f32_16x16x32_bf16 v[48:51], a[136:139], v[128:131], v[48:51]
    v_swap_b32 v154, v156
    v_mfma_f32_16x16x32_bf16 v[52:55], a[136:139], v[132:135], v[52:55]
    v_swap_b32 v155, v157
    v_mfma_f32_16x16x32_bf16 v[88:91], a[136:139], v[136:139], v[88:91]
    v_mfma_f32_16x16x32_bf16 v[92:95], a[136:139], v[140:143], v[92:95]
    v_mfma_f32_16x16x32_bf16 v[16:19], a[140:143], v[144:147], v[16:19]
    buffer_load_dwordx4 v[128:131], v2, s[8:11], s90 offen sc1
    v_mfma_f32_16x16x32_bf16 v[20:23], a[140:143], v[148:151], v[20:23]
    buffer_load_dwordx4 v[132:135], v2, s[8:11], s90 offen offset:1024 sc1
    s_add_u32 s90, s90, 2048
    v_mfma_f32_16x16x32_bf16 v[56:59], a[140:143], v[152:155], v[56:59]
    buffer_load_dwordx4 v[136:139], v2, s[8:11], s91 offen sc1
    v_mfma_f32_16x16x32_bf16 v[60:63], a[140:143], v[156:159], v[60:63]
    buffer_load_dwordx4 v[140:143], v2, s[8:11], s91 offen offset:1024 sc1
    s_add_u32 s91, s91, 2048
    v_mfma_f32_16x16x32_bf16 v[24:27], a[144:147], v[144:147], v[24:27]
    v_mfma_f32_16x16x32_bf16 v[28:31], a[144:147], v[148:151], v[28:31]
    v_mfma_f32_16x16x32_bf16 v[64:67], a[144:147], v[152:155], v[64:67]
    v_mfma_f32_16x16x32_bf16 v[68:71], a[144:147], v[156:159], v[68:71]
    v_mfma_f32_16x16x32_bf16 v[32:35], a[148:151], v[144:147], v[32:35]
    v_mfma_f32_16x16x32_bf16 v[36:39], a[148:151], v[148:151], v[36:39]
    v_mfma_f32_16x16x32_bf16 v[72:75], a[148:151], v[152:155], v[72:75]
    v_mfma_f32_16x16x32_bf16 v[76:79], a[148:151], v[156:159], v[76:79]
    v_mfma_f32_16x16x32_bf16 v[40:43], a[152:155], v[144:147], v[40:43]
    v_mfma_f32_16x16x32_bf16 v[44:47], a[152:155], v[148:151], v[44:47]
    s_waitcnt vmcnt(8)
    v_mfma_f32_16x16x32_bf16 v[80:83], a[152:155], v[152:155], v[80:83]
    v_swap_b32 v98, v100
    v_mfma_f32_16x16x32_bf16 v[84:87], a[152:155], v[156:159], v[84:87]
    v_swap_b32 v99, v101
    v_mfma_f32_16x16x32_bf16 v[48:51], a[156:159], v[144:147], v[48:51]
    v_swap_b32 v106, v108
    v_mfma_f32_16x16x32_bf16 v[52:55], a[156:159], v[148:151], v[52:55]
    v_swap_b32 v107, v109
    v_mfma_f32_16x16x32_bf16 v[88:91], a[156:159], v[152:155], v[88:91]
    v_mfma_f32_16x16x32_bf16 v[92:95], a[156:159], v[156:159], v[92:95]
    v_mfma_f32_16x16x32_bf16 v[16:19], a[160:163], v[96:99], v[16:19]
    buffer_load_dwordx4 v[144:147], v2, s[8:11], s90 offen sc1
    v_mfma_f32_16x16x32_bf16 v[20:23], a[160:163], v[100:103], v[20:23]
    buffer_load_dwordx4 v[148:151], v2, s[8:11], s90 offen offset:1024 sc1
    s_add_u32 s90, s90, 2048
    v_mfma_f32_16x16x32_bf16 v[56:59], a[160:163], v[104:107], v[56:59]
    buffer_load_dwordx4 v[152:155], v2, s[8:11], s91 offen sc1
    v_mfma_f32_16x16x32_bf16 v[60:63], a[160:163], v[108:111], v[60:63]
    buffer_load_dwordx4 v[156:159], v2, s[8:11], s91 offen offset:1024 sc1
    s_add_u32 s91, s91, 2048
    v_mfma_f32_16x16x32_bf16 v[24:27], a[164:167], v[96:99], v[24:27]
    v_mfma_f32_16x16x32_bf16 v[28:31], a[164:167], v[100:103], v[28:31]
    v_mfma_f32_16x16x32_bf16 v[64:67], a[164:167], v[104:107], v[64:67]
    v_mfma_f32_16x16x32_bf16 v[68:71], a[164:167], v[108:111], v[68:71]
    v_mfma_f32_16x16x32_bf16 v[32:35], a[168:171], v[96:99], v[32:35]
    v_mfma_f32_16x16x32_bf16 v[36:39], a[168:171], v[100:103], v[36:39]
    v_mfma_f32_16x16x32_bf16 v[72:75], a[168:171], v[104:107], v[72:75]
    v_mfma_f32_16x16x32_bf16 v[76:79], a[168:171], v[108:111], v[76:79]
    v_mfma_f32_16x16x32_bf16 v[40:43], a[172:175], v[96:99], v[40:43]
    v_mfma_f32_16x16x32_bf16 v[44:47], a[172:175], v[100:103], v[44:47]
    s_waitcnt vmcnt(8)
    v_mfma_f32_16x16x32_bf16 v[80:83], a[172:175], v[104:107], v[80:83]
    v_swap_b32 v114, v116
    v_mfma_f32_16x16x32_bf16 v[84:87], a[172:175], v[108:111], v[84:87]
    v_swap_b32 v115, v117
    v_mfma_f32_16x16x32_bf16 v[48:51], a[176:179], v[96:99], v[48:51]
    v_swap_b32 v122, v124
    v_mfma_f32_16x16x32_bf16 v[52:55], a[176:179], v[100:103], v[52:55]
    v_swap_b32 v123, v125
    v_mfma_f32_16x16x32_bf16 v[88:91], a[176:179], v[104:107], v[88:91]
    v_mfma_f32_16x16x32_bf16 v[92:95], a[176:179], v[108:111], v[92:95]
    v_mfma_f32_16x16x32_bf16 v[16:19], a[180:183], v[112:115], v[16:19]
    buffer_load_dwordx4 v[96:99], v2, s[8:11], s90 offen sc1
    v_mfma_f32_16x16x32_bf16 v[20:23], a[180:183], v[116:119], v[20:23]
    buffer_load_dwordx4 v[100:103], v2, s[8:11], s90 offen offset:1024 sc1
    s_add_u32 s90, s90, 2048
    v_mfma_f32_16x16x32_bf16 v[56:59], a[180:183], v[120:123], v[56:59]
    buffer_load_dwordx4 v[104:107], v2, s[8:11], s91 offen sc1
    v_mfma_f32_16x16x32_bf16 v[60:63], a[180:183], v[124:127], v[60:63]
    buffer_load_dwordx4 v[108:111], v2, s[8:11], s91 offen offset:1024 sc1
    s_add_u32 s91, s91, 2048
    v_mfma_f32_16x16x32_bf16 v[24:27], a[184:187], v[112:115], v[24:27]
    v_mfma_f32_16x16x32_bf16 v[28:31], a[184:187], v[116:119], v[28:31]
    v_mfma_f32_16x16x32_bf16 v[64:67], a[184:187], v[120:123], v[64:67]
    v_mfma_f32_16x16x32_bf16 v[68:71], a[184:187], v[124:127], v[68:71]
    v_mfma_f32_16x16x32_bf16 v[32:35], a[188:191], v[112:115], v[32:35]
    v_mfma_f32_16x16x32_bf16 v[36:39], a[188:191], v[116:119], v[36:39]
    v_mfma_f32_16x16x32_bf16 v[72:75], a[188:191], v[120:123], v[72:75]
    v_mfma_f32_16x16x32_bf16 v[76:79], a[188:191], v[124:127], v[76:79]
    v_mfma_f32_16x16x32_bf16 v[40:43], a[192:195], v[112:115], v[40:43]
    v_mfma_f32_16x16x32_bf16 v[44:47], a[192:195], v[116:119], v[44:47]
    s_waitcnt vmcnt(8)
    v_mfma_f32_16x16x32_bf16 v[80:83], a[192:195], v[120:123], v[80:83]
    v_swap_b32 v130, v132
    v_mfma_f32_16x16x32_bf16 v[84:87], a[192:195], v[124:127], v[84:87]
    v_swap_b32 v131, v133
    v_mfma_f32_16x16x32_bf16 v[48:51], a[196:199], v[112:115], v[48:51]
    v_swap_b32 v138, v140
    v_mfma_f32_16x16x32_bf16 v[52:55], a[196:199], v[116:119], v[52:55]
    v_swap_b32 v139, v141
    v_mfma_f32_16x16x32_bf16 v[88:91], a[196:199], v[120:123], v[88:91]
    v_mfma_f32_16x16x32_bf16 v[92:95], a[196:199], v[124:127], v[92:95]
    v_mfma_f32_16x16x32_bf16 v[16:19], a[200:203], v[128:131], v[16:19]
    buffer_load_dwordx4 v[112:115], v2, s[8:11], s90 offen sc1
    v_mfma_f32_16x16x32_bf16 v[20:23], a[200:203], v[132:135], v[20:23]
    buffer_load_dwordx4 v[116:119], v2, s[8:11], s90 offen offset:1024 sc1
    s_add_u32 s90, s90, 2048
    v_mfma_f32_16x16x32_bf16 v[56:59], a[200:203], v[136:139], v[56:59]
    buffer_load_dwordx4 v[120:123], v2, s[8:11], s91 offen sc1
    v_mfma_f32_16x16x32_bf16 v[60:63], a[200:203], v[140:143], v[60:63]
    buffer_load_dwordx4 v[124:127], v2, s[8:11], s91 offen offset:1024 sc1
    s_add_u32 s91, s91, 2048
    v_mfma_f32_16x16x32_bf16 v[24:27], a[204:207], v[128:131], v[24:27]
    v_mfma_f32_16x16x32_bf16 v[28:31], a[204:207], v[132:135], v[28:31]
    v_mfma_f32_16x16x32_bf16 v[64:67], a[204:207], v[136:139], v[64:67]
    v_mfma_f32_16x16x32_bf16 v[68:71], a[204:207], v[140:143], v[68:71]
    v_mfma_f32_16x16x32_bf16 v[32:35], a[208:211], v[128:131], v[32:35]
    v_mfma_f32_16x16x32_bf16 v[36:39], a[208:211], v[132:135], v[36:39]
    v_mfma_f32_16x16x32_bf16 v[72:75], a[208:211], v[136:139], v[72:75]
    v_mfma_f32_16x16x32_bf16 v[76:79], a[208:211], v[140:143], v[76:79]
    v_mfma_f32_16x16x32_bf16 v[40:43], a[212:215], v[128:131], v[40:43]
    v_mfma_f32_16x16x32_bf16 v[44:47], a[212:215], v[132:135], v[44:47]
    s_waitcnt vmcnt(8)
    v_mfma_f32_16x16x32_bf16 v[80:83], a[212:215], v[136:139], v[80:83]
    v_swap_b32 v146, v148
    v_mfma_f32_16x16x32_bf16 v[84:87], a[212:215], v[140:143], v[84:87]
    v_swap_b32 v147, v149
    v_mfma_f32_16x16x32_bf16 v[48:51], a[216:219], v[128:131], v[48:51]
    v_swap_b32 v154, v156
    v_mfma_f32_16x16x32_bf16 v[52:55], a[216:219], v[132:135], v[52:55]
    v_swap_b32 v155, v157
    v_mfma_f32_16x16x32_bf16 v[88:91], a[216:219], v[136:139], v[88:91]
    v_mfma_f32_16x16x32_bf16 v[92:95], a[216:219], v[140:143], v[92:95]
    v_mfma_f32_16x16x32_bf16 v[16:19], a[220:223], v[144:147], v[16:19]
    v_mfma_f32_16x16x32_bf16 v[20:23], a[220:223], v[148:151], v[20:23]
    v_mfma_f32_16x16x32_bf16 v[56:59], a[220:223], v[152:155], v[56:59]
    v_mfma_f32_16x16x32_bf16 v[60:63], a[220:223], v[156:159], v[60:63]
    v_mfma_f32_16x16x32_bf16 v[24:27], a[224:227], v[144:147], v[24:27]
    v_mfma_f32_16x16x32_bf16 v[28:31], a[224:227], v[148:151], v[28:31]
    v_mfma_f32_16x16x32_bf16 v[64:67], a[224:227], v[152:155], v[64:67]
    v_mfma_f32_16x16x32_bf16 v[68:71], a[224:227], v[156:159], v[68:71]
    v_mfma_f32_16x16x32_bf16 v[32:35], a[228:231], v[144:147], v[32:35]
    v_mfma_f32_16x16x32_bf16 v[36:39], a[228:231], v[148:151], v[36:39]
    v_mfma_f32_16x16x32_bf16 v[72:75], a[228:231], v[152:155], v[72:75]
    v_mfma_f32_16x16x32_bf16 v[76:79], a[228:231], v[156:159], v[76:79]
    v_mfma_f32_16x16x32_bf16 v[40:43], a[232:235], v[144:147], v[40:43]
    v_mfma_f32_16x16x32_bf16 v[44:47], a[232:235], v[148:151], v[44:47]
    s_waitcnt vmcnt(4)
    v_mfma_f32_16x16x32_bf16 v[80:83], a[232:235], v[152:155], v[80:83]
    v_swap_b32 v98, v100
    v_mfma_f32_16x16x32_bf16 v[84:87], a[232:235], v[156:159], v[84:87]
    v_swap_b32 v99, v101
    v_mfma_f32_16x16x32_bf16 v[48:51], a[236:239], v[144:147], v[48:51]
    v_swap_b32 v106, v108
    v_mfma_f32_16x16x32_bf16 v[52:55], a[236:239], v[148:151], v[52:55]
    v_swap_b32 v107, v109
    v_mfma_f32_16x16x32_bf16 v[88:91], a[236:239], v[152:155], v[88:91]
    v_mfma_f32_16x16x32_bf16 v[92:95], a[236:239], v[156:159], v[92:95]
    v_mfma_f32_16x16x32_bf16 v[16:19], a[240:243], v[96:99], v[16:19]
    v_mfma_f32_16x16x32_bf16 v[20:23], a[240:243], v[100:103], v[20:23]
    v_mfma_f32_16x16x32_bf16 v[56:59], a[240:243], v[104:107], v[56:59]
    v_mfma_f32_16x16x32_bf16 v[60:63], a[240:243], v[108:111], v[60:63]
    v_mfma_f32_16x16x32_bf16 v[24:27], a[244:247], v[96:99], v[24:27]
    v_mfma_f32_16x16x32_bf16 v[28:31], a[244:247], v[100:103], v[28:31]
    v_mfma_f32_16x16x32_bf16 v[64:67], a[244:247], v[104:107], v[64:67]
    v_mfma_f32_16x16x32_bf16 v[68:71], a[244:247], v[108:111], v[68:71]
    v_mfma_f32_16x16x32_bf16 v[32:35], a[248:251], v[96:99], v[32:35]
    v_mfma_f32_16x16x32_bf16 v[36:39], a[248:251], v[100:103], v[36:39]
    v_mfma_f32_16x16x32_bf16 v[72:75], a[248:251], v[104:107], v[72:75]
    v_mfma_f32_16x16x32_bf16 v[76:79], a[248:251], v[108:111], v[76:79]
    v_mfma_f32_16x16x32_bf16 v[40:43], a[252:255], v[96:99], v[40:43]
    v_mfma_f32_16x16x32_bf16 v[44:47], a[252:255], v[100:103], v[44:47]
    s_waitcnt vmcnt(0)
    v_mfma_f32_16x16x32_bf16 v[80:83], a[252:255], v[104:107], v[80:83]
    v_swap_b32 v114, v116
    v_mfma_f32_16x16x32_bf16 v[84:87], a[252:255], v[108:111], v[84:87]
    v_swap_b32 v115, v117
    v_mfma_f32_16x16x32_bf16 v[48:51], v[232:235], v[96:99], v[48:51]
    v_swap_b32 v122, v124
    v_mfma_f32_16x16x32_bf16 v[52:55], v[232:235], v[100:103], v[52:55]
    v_swap_b32 v123, v125
    v_mfma_f32_16x16x32_bf16 v[88:91], v[232:235], v[104:107], v[88:91]
    v_mfma_f32_16x16x32_bf16 v[92:95], v[232:235], v[108:111], v[92:95]
    s_cmp_ge_u32 s60, 2
    s_cbranch_scc1 L_g2end_76
    v_mfma_f32_16x16x32_bf16 v[16:19], v[236:239], v[112:115], v[16:19]
    v_mfma_f32_16x16x32_bf16 v[20:23], v[236:239], v[116:119], v[20:23]
    v_mfma_f32_16x16x32_bf16 v[56:59], v[236:239], v[120:123], v[56:59]
    v_mfma_f32_16x16x32_bf16 v[60:63], v[236:239], v[124:127], v[60:63]
    v_mfma_f32_16x16x32_bf16 v[24:27], v[240:243], v[112:115], v[24:27]
    v_mfma_f32_16x16x32_bf16 v[28:31], v[240:243], v[116:119], v[28:31]
    v_mfma_f32_16x16x32_bf16 v[64:67], v[240:243], v[120:123], v[64:67]
    v_mfma_f32_16x16x32_bf16 v[68:71], v[240:243], v[124:127], v[68:71]
    v_mfma_f32_16x16x32_bf16 v[32:35], v[244:247], v[112:115], v[32:35]
    v_mfma_f32_16x16x32_bf16 v[36:39], v[244:247], v[116:119], v[36:39]
    v_mfma_f32_16x16x32_bf16 v[72:75], v[244:247], v[120:123], v[72:75]
    v_mfma_f32_16x16x32_bf16 v[76:79], v[244:247], v[124:127], v[76:79]
    v_mfma_f32_16x16x32_bf16 v[40:43], v[248:251], v[112:115], v[40:43]
    v_mfma_f32_16x16x32_bf16 v[44:47], v[248:251], v[116:119], v[44:47]
    v_mfma_f32_16x16x32_bf16 v[80:83], v[248:251], v[120:123], v[80:83]
    v_mfma_f32_16x16x32_bf16 v[84:87], v[248:251], v[124:127], v[84:87]
    v_mfma_f32_16x16x32_bf16 v[48:51], v[252:255], v[112:115], v[48:51]
    v_mfma_f32_16x16x32_bf16 v[52:55], v[252:255], v[116:119], v[52:55]
    v_mfma_f32_16x16x32_bf16 v[88:91], v[252:255], v[120:123], v[88:91]
    v_mfma_f32_16x16x32_bf16 v[92:95], v[252:255], v[124:127], v[92:95]
L_g2end_76:
    s_waitcnt vmcnt(0)
    s_lshr_b32 s62, s60, 1
    s_mul_i32 s63, s62, 10240
    s_xor_b32 s62, s62, 1
    s_mul_i32 s64, s62, 10240
    s_mul_i32 s66, s85, 6144
    s_sub_u32 s67, 1, s85
    s_lshl_b32 s67, s67, 12
    s_add_u32 s62, s63, s66
    s_add_u32 s62, s62, 102400
    v_add_u32 v3, s62, v2
    s_add_u32 s62, s63, s67
    s_add_u32 s62, s62, 102400
    v_add_u32 v4, s62, v2
    s_add_u32 s62, s64, s66
    s_add_u32 s62, s62, 102400
    v_add_u32 v5, s62, v2
    s_add_u32 s62, s64, s67
    s_add_u32 s62, s62, 102400
    v_add_u32 v6, s62, v2
    s_sub_u32 s67, 1, s85
    s_mul_i32 s67, s67, 20480
    v_add_u32 v7, s67, v6
    ds_write_b128 v4, v[40:43] offset:43008
    ds_write_b128 v4, v[44:47] offset:44032
    ds_write_b128 v6, v[80:83] offset:2048
    ds_write_b128 v6, v[84:87] offset:3072
    ds_write_b128 v4, v[48:51] offset:45056
    ds_write_b128 v4, v[52:55] offset:46080
    ds_write_b128 v6, v[88:91] offset:4096
    ds_write_b128 v6, v[92:95] offset:5120
    ds_write_b128 v5, v[56:59] offset:20480
    ds_write_b128 v5, v[60:63] offset:21504
    ds_write_b128 v5, v[64:67] offset:22528
    ds_write_b128 v5, v[68:71] offset:23552
    ds_write_b128 v7, v[72:75] offset:0
    ds_write_b128 v7, v[76:79] offset:1024
    s_cmp_eq_u32 s85, 0
    s_cbranch_scc1 L_w2o_77
    ds_write_b128 v4, v[32:35] offset:40960
    ds_write_b128 v4, v[36:39] offset:41984
L_w2o_77:
    s_waitcnt vmcnt(0) lgkmcnt(0)
    s_barrier
    ds_read_b128 v[96:99], v3 offset:40960
    ds_read_b128 v[100:103], v3 offset:41984
    ds_read_b128 v[104:107], v3 offset:43008
    ds_read_b128 v[108:111], v3 offset:44032
    ds_read_b128 v[112:115], v4 offset:40960
    ds_read_b128 v[116:119], v4 offset:41984
    ds_read_b128 v[120:123], v3 offset:20480
    ds_read_b128 v[124:127], v3 offset:21504
    ds_read_b128 v[128:131], v3 offset:22528
    ds_read_b128 v[132:135], v3 offset:23552
    ds_read_b128 v[136:139], v4 offset:20480
    ds_read_b128 v[140:143], v4 offset:21504
    ds_read_b128 v[144:147], v3 offset:0
    ds_read_b128 v[148:151], v3 offset:1024
    ds_read_b128 v[152:155], v3 offset:2048
    ds_read_b128 v[156:159], v3 offset:3072
    ds_read_b128 v[160:163], v4 offset:0
    ds_read_b128 v[164:167], v4 offset:1024
    s_waitcnt lgkmcnt(12)
    v_pk_add_f32 v[16:17], v[16:17], v[96:97]
    v_pk_add_f32 v[18:19], v[18:19], v[98:99]
    v_pk_add_f32 v[20:21], v[20:21], v[100:101]
    v_pk_add_f32 v[22:23], v[22:23], v[102:103]
    v_pk_add_f32 v[24:25], v[24:25], v[104:105]
    v_pk_add_f32 v[26:27], v[26:27], v[106:107]
    v_pk_add_f32 v[28:29], v[28:29], v[108:109]
    v_pk_add_f32 v[30:31], v[30:31], v[110:111]
    v_pk_add_f32 v[32:33], v[32:33], v[112:113]
    v_pk_add_f32 v[34:35], v[34:35], v[114:115]
    v_pk_add_f32 v[36:37], v[36:37], v[116:117]
    v_pk_add_f32 v[38:39], v[38:39], v[118:119]
    s_waitcnt lgkmcnt(6)
    v_pk_add_f32 v[16:17], v[16:17], v[120:121]
    v_pk_add_f32 v[18:19], v[18:19], v[122:123]
    v_pk_add_f32 v[20:21], v[20:21], v[124:125]
    v_pk_add_f32 v[22:23], v[22:23], v[126:127]
    v_pk_add_f32 v[24:25], v[24:25], v[128:129]
    v_pk_add_f32 v[26:27], v[26:27], v[130:131]
    v_pk_add_f32 v[28:29], v[28:29], v[132:133]
    v_pk_add_f32 v[30:31], v[30:31], v[134:135]
    v_pk_add_f32 v[32:33], v[32:33], v[136:137]
    v_pk_add_f32 v[34:35], v[34:35], v[138:139]
    v_pk_add_f32 v[36:37], v[36:37], v[140:141]
    v_pk_add_f32 v[38:39], v[38:39], v[142:143]
    s_waitcnt lgkmcnt(0)
    v_pk_add_f32 v[16:17], v[16:17], v[144:145]
    v_pk_add_f32 v[18:19], v[18:19], v[146:147]
    v_pk_add_f32 v[20:21], v[20:21], v[148:149]
    v_pk_add_f32 v[22:23], v[22:23], v[150:151]
    v_pk_add_f32 v[24:25], v[24:25], v[152:153]
    v_pk_add_f32 v[26:27], v[26:27], v[154:155]
    v_pk_add_f32 v[28:29], v[28:29], v[156:157]
    v_pk_add_f32 v[30:31], v[30:31], v[158:159]
    v_pk_add_f32 v[32:33], v[32:33], v[160:161]
    v_pk_add_f32 v[34:35], v[34:35], v[162:163]
    v_pk_add_f32 v[36:37], v[36:37], v[164:165]
    v_pk_add_f32 v[38:39], v[38:39], v[166:167]
    v_lshlrev_b32 v8, 16, v208
    v_and_b32 v9, 0xffff0000, v208
    v_pk_add_f32 v[16:17], v[16:17], v[8:9]
    v_lshlrev_b32 v10, 16, v209
    v_and_b32 v11, 0xffff0000, v209
    v_pk_add_f32 v[18:19], v[18:19], v[10:11]
    v_lshlrev_b32 v8, 16, v210
    v_and_b32 v9, 0xffff0000, v210
    v_pk_add_f32 v[20:21], v[20:21], v[8:9]
    v_lshlrev_b32 v10, 16, v211
    v_and_b32 v11, 0xffff0000, v211
    v_pk_add_f32 v[22:23], v[22:23], v[10:11]
    v_lshlrev_b32 v8, 16, v212
    v_and_b32 v9, 0xffff0000, v212
    v_pk_add_f32 v[24:25], v[24:25], v[8:9]
    v_lshlrev_b32 v10, 16, v213
    v_and_b32 v11, 0xffff0000, v213
    v_pk_add_f32 v[26:27], v[26:27], v[10:11]
    v_lshlrev_b32 v8, 16, v214
    v_and_b32 v9, 0xffff0000, v214
    v_pk_add_f32 v[28:29], v[28:29], v[8:9]
    v_lshlrev_b32 v10, 16, v215
    v_and_b32 v11, 0xffff0000, v215
    v_pk_add_f32 v[30:31], v[30:31], v[10:11]
    v_lshlrev_b32 v8, 16, v216
    v_and_b32 v9, 0xffff0000, v216
    v_pk_add_f32 v[32:33], v[32:33], v[8:9]
    v_lshlrev_b32 v10, 16, v217
    v_and_b32 v11, 0xffff0000, v217
    v_pk_add_f32 v[34:35], v[34:35], v[10:11]
    v_lshlrev_b32 v8, 16, v218
    v_and_b32 v9, 0xffff0000, v218
    v_pk_add_f32 v[36:37], v[36:37], v[8:9]
    v_lshlrev_b32 v10, 16, v219
    v_and_b32 v11, 0xffff0000, v219
    v_pk_add_f32 v[38:39], v[38:39], v[10:11]
    v_cvt_pk_bf16_f32 v128, v16, v17
    v_cvt_pk_bf16_f32 v129, v18, v19
    v_cvt_pk_bf16_f32 v130, v20, v21
    v_cvt_pk_bf16_f32 v131, v22, v23
    buffer_store_dwordx2 v[128:129], v204, s[12:15], s93 offen offset:0
    buffer_store_dwordx2 v[130:131], v204, s[12:15], s93 offen offset:1280
    v_cvt_pk_bf16_f32 v132, v24, v25
    v_cvt_pk_bf16_f32 v133, v26, v27
    v_cvt_pk_bf16_f32 v134, v28, v29
    v_cvt_pk_bf16_f32 v135, v30, v31
    buffer_store_dwordx2 v[132:133], v204, s[12:15], s93 offen offset:32
    buffer_store_dwordx2 v[134:135], v204, s[12:15], s93 offen offset:1312
    s_cmp_eq_u32 s85, 1
    s_cbranch_scc1 L_out_78
    v_cvt_pk_bf16_f32 v136, v32, v33
    v_cvt_pk_bf16_f32 v137, v34, v35
    v_cvt_pk_bf16_f32 v138, v36, v37
    v_cvt_pk_bf16_f32 v139, v38, v39
    buffer_store_dwordx2 v[136:137], v204, s[12:15], s93 offen offset:64
    buffer_store_dwordx2 v[138:139], v204, s[12:15], s93 offen offset:1344
L_out_78:
L_flush:
L_exit:
    s_endpgm
L_g1l0_gstub:
L_gs_79:
    s_cmp_eq_u32 s97, 0
    s_cbranch_scc1 L_g1l0_gok
    s_sub_u32 s97, s97, 1
    buffer_load_dwordx4 v[208:211], v8, s[8:11], s89 offen offset:0 sc1
    buffer_load_dwordx4 v[212:215], v8, s[8:11], s89 offen offset:1024 sc1
    buffer_load_dwordx4 v[216:219], v8, s[8:11], s89 offen offset:2048 sc1
    buffer_load_dwordx4 v[220:223], v8, s[8:11], s89 offen offset:3072 sc1
    s_waitcnt vmcnt(0)
    v_max3_u32 v11, v208, v209, v210
    v_max3_u32 v11, v11, v211, v212
    v_max3_u32 v11, v11, v213, v214
    v_max3_u32 v11, v11, v215, v216
    v_max3_u32 v11, v11, v217, v218
    v_max3_u32 v11, v11, v219, v220
    v_max3_u32 v11, v11, v221, v222
    v_max_u32 v11, v11, v223
    v_cmp_eq_u32 vcc, -1, v11
    s_nop 1
    s_cbranch_vccnz L_gs_79
    s_branch L_g1l0_gok
L_g1l1_gstub:
L_gs_80:
    s_cmp_eq_u32 s97, 0
    s_cbranch_scc1 L_g1l1_gok
    s_sub_u32 s97, s97, 1
    buffer_load_dwordx4 v[208:211], v8, s[8:11], s89 offen offset:0 sc1
    buffer_load_dwordx4 v[212:215], v8, s[8:11], s89 offen offset:1024 sc1
    buffer_load_dwordx4 v[216:219], v8, s[8:11], s89 offen offset:2048 sc1
    buffer_load_dwordx4 v[220:223], v8, s[8:11], s89 offen offset:3072 sc1
    s_waitcnt vmcnt(0)
    v_max3_u32 v11, v208, v209, v210
    v_max3_u32 v11, v11, v211, v212
    v_max3_u32 v11, v11, v213, v214
    v_max3_u32 v11, v11, v215, v216
    v_max3_u32 v11, v11, v217, v218
    v_max3_u32 v11, v11, v219, v220
    v_max3_u32 v11, v11, v221, v222
    v_max_u32 v11, v11, v223
    v_cmp_eq_u32 vcc, -1, v11
    s_nop 1
    s_cbranch_vccnz L_gs_80
    s_branch L_g1l1_gok
L_code_end:
    s_endpgm

.section .rodata,"a"
.p2align 6
.amdhsa_kernel interleave_layers__ssm_conv_h3__dense_activation_relu__prompt_kernel
  .amdhsa_next_free_vgpr 512
  .amdhsa_next_free_sgpr 102
  .amdhsa_accum_offset 256
  .amdhsa_group_segment_fixed_size 0
  .amdhsa_kernarg_size 96
  .amdhsa_user_sgpr_count 2
  .amdhsa_user_sgpr_kernarg_segment_ptr 1
  .amdhsa_system_sgpr_workgroup_id_x 1
  .amdhsa_float_denorm_mode_32 3
.end_amdhsa_kernel
.text
```
